```python
import torch

def _softmax(x, axis=-1):
    return torch.softmax(x, dim=axis)
def _gelu(x):
    return torch.nn.functional.gelu(x, approximate="tanh")
def _silu(x):
    return torch.nn.functional.silu(x)
def _sigmoid(x):
    return torch.sigmoid(x)
def _layernorm(x, axis=-1, eps=1e-5):
    m = x.mean(dim=axis, keepdim=True)
    v = x.var(dim=axis, keepdim=True, unbiased=False)
    return (x - m) / torch.sqrt(v + eps)
def _scatter_add(tgt, idx, src, axis=0):
    return tgt.clone().index_add_(axis, idx, src)
def _segment_sum(src, seg, n):
    out = torch.zeros((n,) + src.shape[1:], dtype=src.dtype)
    return out.index_add_(0, seg, src)
def _pad(x, pw):
    flat = tuple(v for pair in reversed(pw) for v in pair)
    return torch.nn.functional.pad(x, flat)

kernel_name = 'parallel_sum__ssm_conv_h3__glu_gated_geglu__prompt'

def setup_inputs():

    _w = (lambda a: (lambda t: t.to(torch.bfloat16) if t.is_floating_point() else t)(torch.as_tensor(a)))
    def _A_setup():
        B, S, D = 1, 2048, 640
        ks = 4
        return {
            "q": _w((lambda *s: torch.randn(*s, dtype=torch.bfloat16) * 0.05)(B, S, D)),
            "k": _w((lambda *s: torch.randn(*s, dtype=torch.bfloat16) * 0.2)(B, S, D)),
            "v": _w((lambda *s: torch.randn(*s, dtype=torch.bfloat16) * 0.2)(B, S, D)),
            "shift_k": _w((lambda *s: torch.randn(*s, dtype=torch.bfloat16) * 0.2)(D, ks) * 0.5),
            "ssm_k": _w((lambda *s: torch.randn(*s, dtype=torch.bfloat16) * 0.4)(D, S) * (1.0 / S ** 0.5)),
            "ssm_D": _w((lambda *s: torch.randn(*s, dtype=torch.bfloat16) * 0.2)(D)),
        }
    _A_in = _A_setup()

    def _B_setup():
        B, S, Dm, Df = 1, 2048, 640, 1728
        return {
            "x": _w((lambda *s: torch.randn(*s, dtype=torch.bfloat16) * 0.05)(B, S, Dm)),
            "w_gate": _w((lambda *s: torch.randn(*s, dtype=torch.bfloat16) * 0.4)(Dm, Df) * (Dm ** -0.5)),
            "w_up": _w((lambda *s: torch.randn(*s, dtype=torch.bfloat16) * 0.4)(Dm, Df) * (Dm ** -0.5)),
            "w_down": _w((lambda *s: torch.randn(*s, dtype=torch.bfloat16) * 0.4)(Df, Dm) * (Df ** -0.5)),
        }
    _B_in = _B_setup()

    return {
        "A_q": _A_in["q"],
        "A_k": _A_in["k"],
        "A_v": _A_in["v"],
        "A_shift_k": _A_in["shift_k"],
        "A_ssm_k": _A_in["ssm_k"],
        "A_ssm_D": _A_in["ssm_D"],
        "B_x": _B_in["x"],
        "B_w_gate": _B_in["w_gate"],
        "B_w_up": _B_in["w_up"],
        "B_w_down": _B_in["w_down"],
    }

def reference(A_q, A_k, A_v, A_shift_k, A_ssm_k, A_ssm_D, B_x, B_w_gate, B_w_up, B_w_down):
    def _A_ref(q, k, v, shift_k, ssm_k, ssm_D):
        B, S, D = q.shape
        ks = shift_k.shape[-1]
        k_pad = _pad(k, ((0, 0), (ks - 1, 0), (0, 0)))
        k_shift = torch.zeros_like(k)
        for t in range(ks):
            k_shift = k_shift + k_pad[:, t:t + S, :] * shift_k[:, ks - 1 - t][None, None, :]
        kv = k_shift * v
        L = 2 * S
        kv_pad = _pad(kv, ((0, 0), (0, S), (0, 0)))
        kf_pad = _pad(ssm_k, ((0, 0), (0, S)))
        kv_f = (lambda x, axes=(-2,-1): torch.fft.rfft2(x.float(), dim=axes))(kv_pad[:, None, :, :], axes=(1, 2))
        kf_f = (lambda x, axes=(-2,-1): torch.fft.rfft2(x.float(), dim=axes))(kf_pad[:, None, :], axes=(1, 2))
        kf_f = (lambda x, *d: x.permute(*d))(kf_f, 1, 2, 0)
        y_f = kv_f * kf_f[None, :, :, :]
        y = (lambda x, s, axes=(-2,-1): torch.fft.irfft2(x, s=s, dim=axes).to(torch.bfloat16))(y_f, (1, L), axes=(1, 2))[:, 0, :S, :]
        y = y + kv * ssm_D[None, None, :]
        return q * y

    def _B_ref(x, w_gate, w_up, w_down):
        g = torch.einsum("bsd,df->bsf", x, w_gate)
        u = torch.einsum("bsd,df->bsf", x, w_up)
        h = _gelu(g) * u
        return torch.einsum("bsf,fd->bsd", h, w_down)

    x = A_q
    xn = _layernorm(x, axis=-1)
    return x + _A_ref(xn, A_k, A_v, A_shift_k, A_ssm_k, A_ssm_D) + _B_ref(xn, B_w_gate, B_w_up, B_w_down)
```

```asm
; @launch kernel=k1_kernel grid=(256,1,1) block=(512,1,1) lds=163840
; @launch kernel=k2_kernel grid=(256,1,1) block=(512,1,1) lds=158016
.amdgcn_target "amdgcn-amd-amdhsa--gfx950"
.text
.globl k1_kernel
.p2align 8
.type k1_kernel,@function
k1_kernel:
    s_cmp_ge_u32 s2, 256
    s_cbranch_scc1 K1_END
    s_load_dwordx16 s[16:31], s[0:1], 0
    s_load_dwordx8 s[32:39], s[0:1], 64
    s_load_dwordx2 s[40:41], s[0:1], 96
    v_lshrrev_b32 v1, 6, v0
    v_and_b32 v0, 63, v0
    v_readfirstlane_b32 s3, v1
    s_and_b32 s4, s2, 7
    s_lshr_b32 s5, s2, 3
    s_and_b32 s10, s4, 1
    s_lshl_b32 s10, s10, 2
    s_lshr_b32 s11, s4, 1
    s_add_u32 s10, s10, s11
    s_lshl_b32 s10, s10, 5
    s_add_u32 s10, s10, s5
    s_lshl_b32 s42, s10, 3
    v_lshlrev_b32 v4, 4, v0
    s_cmp_ge_u32 s5, 27
    s_cbranch_scc1 Z1_SPARE
    s_lshr_b32 s7, s4, 1
    s_mul_i32 s7, s7, 27
    s_add_u32 s7, s7, s5
    s_and_b32 s6, s7, 3
    s_lshr_b32 s7, s7, 2
    s_and_b32 s8, s4, 1
    s_lshl_b32 s8, s8, 2
    s_add_u32 s6, s6, s8
    s_and_b32 s8, s3, 1
    s_lshr_b32 s9, s3, 1
    v_and_b32 v2, 15, v0
    v_lshrrev_b32 v3, 4, v0
    v_lshrrev_b32 v20, 3, v0
    v_mul_u32_u24 v21, 1280, v20
    s_lshl_b32 s11, s8, 2
    v_or_b32 v1, s11, v3
    v_and_b32 v22, 7, v0
    v_xor_b32 v1, v1, v22
    v_lshl_add_u32 v5, v1, 4, v21
    s_lshl_b32 s11, s6, 5
    s_add_u32 s11, s11, s3
    s_mul_i32 s72, s11, 10240
    s_add_u32 s73, s72, 81920
    s_add_u32 s74, s72, 163840
    s_add_u32 s75, s72, 245760
    s_lshl_b32 s78, s3, 10
    v_lshlrev_b32 v1, 1, v3
    v_xor_b32 v1, v1, v22
    v_and_b32 v21, 3, v20
    v_lshrrev_b32 v23, 5, v0
    v_lshl_add_u32 v21, v23, 3, v21
    v_mul_u32_u24 v21, 3456, v21
    v_lshl_add_u32 v6, v1, 4, v21
    v_add_u32 v7, 55296, v6
    s_lshr_b32 s10, s3, 2
    s_lshl_b32 s11, s10, 5
    s_lshl_b32 s12, s8, 2
    s_add_u32 s11, s11, s12
    s_mul_i32 s11, s11, 3456
    s_lshl_b32 s12, s7, 7
    s_add_u32 s76, s11, s12
    s_lshl_b32 s79, s3, 11
    v_mul_u32_u24 v20, 3456, v20
    v_lshl_add_u32 v234, v22, 4, v20
    s_lshl_b32 s10, s10, 1
    s_add_u32 s10, s10, s8
    s_lshl_b32 s11, s6, 2
    s_add_u32 s11, s11, s10
    s_mul_i32 s11, s11, 69120
    s_add_u32 s15, s11, s12
    v_mov_b32 v204, 0
    v_mov_b32 v192, 0
    v_mov_b32 v205, 0
    v_mov_b32 v193, 0
    v_mov_b32 v206, 0
    v_mov_b32 v194, 0
    v_mov_b32 v207, 0
    v_mov_b32 v195, 0
    s_waitcnt lgkmcnt(0)
    s_bitcmp0_b32 s3, 1
    s_cselect_b32 s48, s30, s32
    s_cselect_b32 s49, s31, s33
    s_and_b32 s49, s49, 0xffff
    s_mov_b32 s50, 0x21c000
    s_mov_b32 s51, 0x20000
    s_mov_b32 s44, s16
    s_and_b32 s45, s17, 0xffff
    s_mov_b32 s46, 0x280000
    s_mov_b32 s47, 0x20000
    s_add_u32 s77, s76, 0
    s_add_u32 m0, s79, 0
    s_nop 0
    buffer_load_dwordx4 v6, s[48:51], s77 offen lds
    s_add_u32 m0, s78, 16384
    s_nop 0
    buffer_load_dwordx4 v5, s[44:47], s72 offen offset:0 lds
    s_add_u32 m0, s78, 32768
    s_nop 0
    buffer_load_dwordx4 v5, s[44:47], s74 offen offset:0 lds
    s_add_u32 m0, s79, 1024
    s_nop 0
    buffer_load_dwordx4 v7, s[48:51], s77 offen lds
    s_add_u32 m0, s78, 24576
    s_nop 0
    buffer_load_dwordx4 v5, s[44:47], s73 offen offset:0 lds
    s_add_u32 m0, s78, 40960
    s_nop 0
    buffer_load_dwordx4 v5, s[44:47], s75 offen offset:0 lds
    s_add_u32 s12, s42, s3
    s_mul_i32 s12, s12, 1280
    buffer_load_dwordx4 v[200:203], v4, s[44:47], s12 offen
    s_mov_b64 exec, 0xffff
    buffer_load_dwordx4 v[204:207], v4, s[44:47], s12 offen offset:1024
    s_mov_b64 exec, -1
    buffer_load_dwordx4 v[184:187], v234, s[48:51], s15 offen
    s_add_u32 s15, s15, 27648
    buffer_load_dwordx4 v[188:191], v234, s[48:51], s15 offen
    s_add_u32 s15, s15, 27648
    s_mov_b32 exec_hi, 0
    buffer_load_dwordx4 v[192:195], v234, s[48:51], s15 offen
    s_mov_b32 exec_hi, -1
    s_mov_b32 s52, s40
    s_and_b32 s53, s41, 0xffff
    s_mov_b32 s54, 0x1000000
    s_mov_b32 s55, 0x20000
    s_mov_b32 s56, s38
    s_and_b32 s57, s39, 0xffff
    s_mov_b32 s58, 0x100
    s_mov_b32 s59, 0x20000
    v_bfe_u32 v1, v0, 3, 2
    s_lshl_b32 s11, s8, 1
    v_xor_b32 v1, s11, v1
    v_lshlrev_b32 v1, 5, v1
    v_lshrrev_b32 v20, 2, v0
    v_lshl_add_u32 v1, v20, 7, v1
    v_and_b32 v20, 3, v0
    v_lshl_add_u32 v1, v20, 3, v1
    v_xor_b32 v20, 32, v1
    v_add_u32 v8, 0, v1
    v_add_u32 v9, 0, v20
    v_add_u32 v10, 98304, v1
    v_add_u32 v11, 98304, v20
    v_add_u32 v12, 49152, v1
    v_add_u32 v13, 49152, v20
    v_lshrrev_b32 v1, 1, v2
    v_xor_b32 v1, v1, v3
    v_lshlrev_b32 v1, 4, v1
    v_lshl_add_u32 v1, v2, 7, v1
    s_lshl_b32 s11, s9, 13
    v_add_u32 v1, s11, v1
    v_xor_b32 v20, 64, v1
    v_add_u32 v14, 16384, v1
    v_add_u32 v15, 16384, v20
    v_add_u32 v16, 114688, v1
    v_add_u32 v17, 114688, v20
    v_add_u32 v18, 65536, v1
    v_add_u32 v19, 65536, v20
    s_lshl_b32 s11, s6, 4
    s_lshl_b32 s12, s9, 2
    s_add_u32 s11, s11, s12
    s_lshl_b32 s83, s11, 8
    s_add_u32 s83, s83, 0xf20000
    s_mul_i32 s11, s11, 54
    s_lshl_b32 s12, s7, 1
    s_add_u32 s12, s12, s8
    s_add_u32 s11, s11, s12
    s_lshl_b32 s82, s11, 10
    s_lshl_b32 s84, s7, 12
    s_add_u32 s84, s84, 0xf40000
    s_lshl_b32 s11, s6, 9
    s_lshl_b32 s12, s8, 8
    s_add_u32 s11, s11, s12
    s_add_u32 s85, s84, s11
    s_cmp_eq_u32 s3, 7
    s_cselect_b64 s[80:81], -1, 0
    v_mov_b32 v20, 0x3f80
    v_mov_b32 v21, 0x3f800000
    v_cmp_eq_u32 vcc, 0, v2
    s_nop 1
    v_cndmask_b32 v208, 0, v20, vcc
    v_cmp_eq_u32 vcc, 1, v2
    s_nop 1
    v_cndmask_b32 v208, v208, v21, vcc
    v_cmp_eq_u32 vcc, 2, v2
    s_nop 1
    v_cndmask_b32 v209, 0, v20, vcc
    v_cmp_eq_u32 vcc, 3, v2
    s_nop 1
    v_cndmask_b32 v209, v209, v21, vcc
    v_cmp_eq_u32 vcc, 4, v2
    s_nop 1
    v_cndmask_b32 v210, 0, v20, vcc
    v_cmp_eq_u32 vcc, 5, v2
    s_nop 1
    v_cndmask_b32 v210, v210, v21, vcc
    v_cmp_eq_u32 vcc, 6, v2
    s_nop 1
    v_cndmask_b32 v211, 0, v20, vcc
    v_cmp_eq_u32 vcc, 7, v2
    s_nop 1
    v_cndmask_b32 v211, v211, v21, vcc
    s_waitcnt vmcnt(5)
    s_barrier
    ds_read_b64_tr_b16 v[88:89], v8 offset:0
    ds_read_b64_tr_b16 v[90:91], v8 offset:2048
    ds_read_b128 v[92:95], v14 offset:0
    ds_read_b64_tr_b16 v[96:97], v8 offset:4096
    ds_read_b64_tr_b16 v[98:99], v8 offset:6144
    ds_read_b64_tr_b16 v[100:101], v9 offset:0
    ds_read_b64_tr_b16 v[102:103], v9 offset:2048
    ds_read_b64_tr_b16 v[104:105], v9 offset:4096
    ds_read_b64_tr_b16 v[106:107], v9 offset:6144
    ds_read_b128 v[108:111], v14 offset:2048
    ds_read_b128 v[112:115], v14 offset:4096
    s_waitcnt lgkmcnt(8)
    v_mfma_f32_16x16x32_bf16 v[24:27], v[88:91], v[92:95], 0
    s_add_u32 s77, s76, 221184
    s_add_u32 m0, s79, 98304
    s_nop 0
    buffer_load_dwordx4 v6, s[48:51], s77 offen lds
    s_waitcnt lgkmcnt(6)
    v_mfma_f32_16x16x32_bf16 v[28:31], v[96:99], v[92:95], 0
    ds_read_b128 v[116:119], v14 offset:6144
    s_waitcnt vmcnt(4)
    s_mov_b32 s43, 0x3f803f80
    v_mov_b32 v220, 0
    v_mov_b32 v221, 0
    s_add_u32 m0, s78, 114560
    s_nop 0
    buffer_load_dwordx4 v5, s[44:47], s72 offen offset:128 lds
    s_waitcnt lgkmcnt(5)
    v_mfma_f32_16x16x32_bf16 v[32:35], v[100:103], v[92:95], 0
    v_dot2c_f32_bf16 v220, s43, v200
    v_dot2c_f32_bf16 v221, v200, v200
    v_dot2c_f32_bf16 v220, s43, v201
    s_add_u32 m0, s78, 130944
    s_nop 0
    buffer_load_dwordx4 v5, s[44:47], s74 offen offset:128 lds
    s_waitcnt lgkmcnt(3)
    v_mfma_f32_16x16x32_bf16 v[36:39], v[104:107], v[92:95], 0
    v_dot2c_f32_bf16 v221, v201, v201
    v_dot2c_f32_bf16 v220, s43, v202
    v_dot2c_f32_bf16 v221, v202, v202
    s_waitcnt vmcnt(3)
    v_mfma_f32_16x16x32_bf16 v[212:215], v[184:187], v[208:211], 0
    v_mfma_f32_16x16x32_bf16 v[212:215], v[188:191], v[208:211], v[212:215]
    v_mfma_f32_16x16x32_bf16 v[212:215], v[192:195], v[208:211], v[212:215]
    s_lshl_b32 s13, s3, 10
    s_add_u32 s13, s13, 147456
    v_add_u32 v20, s13, v4
    s_add_u32 m0, s79, 99328
    s_nop 0
    buffer_load_dwordx4 v7, s[48:51], s77 offen lds
    s_waitcnt lgkmcnt(2)
    v_mfma_f32_16x16x32_bf16 v[40:43], v[88:91], v[108:111], 0
    v_dot2c_f32_bf16 v220, s43, v203
    v_dot2c_f32_bf16 v221, v203, v203
    v_dot2c_f32_bf16 v220, s43, v204
    v_dot2c_f32_bf16 v221, v204, v204
    s_add_u32 m0, s78, 122752
    s_nop 0
    buffer_load_dwordx4 v5, s[44:47], s73 offen offset:128 lds
    v_mfma_f32_16x16x32_bf16 v[44:47], v[96:99], v[108:111], 0
    ds_read_b64_tr_b16 v[120:121], v8 offset:8192
    ds_read_b64_tr_b16 v[122:123], v8 offset:10240
    ds_read_b128 v[124:127], v15 offset:0
    v_dot2c_f32_bf16 v220, s43, v205
    v_dot2c_f32_bf16 v221, v205, v205
    v_dot2c_f32_bf16 v220, s43, v206
    ds_write_b128 v20, v[212:215]
    s_add_u32 m0, s78, 139136
    s_nop 0
    buffer_load_dwordx4 v5, s[44:47], s75 offen offset:128 lds
    v_mfma_f32_16x16x32_bf16 v[48:51], v[100:103], v[108:111], 0
    ds_read_b64_tr_b16 v[128:129], v8 offset:12288
    ds_read_b64_tr_b16 v[130:131], v8 offset:14336
    v_dot2c_f32_bf16 v221, v206, v206
    v_dot2c_f32_bf16 v220, s43, v207
    v_dot2c_f32_bf16 v221, v207, v207
    v_mfma_f32_16x16x32_bf16 v[52:55], v[104:107], v[108:111], 0
    ds_read_b64_tr_b16 v[132:133], v9 offset:8192
    ds_read_b64_tr_b16 v[134:135], v9 offset:10240
    v_add_f32_dpp v220, v220, v220 quad_perm:[1,0,3,2] row_mask:0xf bank_mask:0xf
    v_add_f32_dpp v221, v221, v221 quad_perm:[1,0,3,2] row_mask:0xf bank_mask:0xf
    s_nop 0
    v_add_f32_dpp v220, v220, v220 quad_perm:[2,3,0,1] row_mask:0xf bank_mask:0xf
    s_waitcnt lgkmcnt(9)
    v_mfma_f32_16x16x32_bf16 v[56:59], v[88:91], v[112:115], 0
    ds_read_b64_tr_b16 v[136:137], v9 offset:12288
    ds_read_b64_tr_b16 v[138:139], v9 offset:14336
    v_add_f32_dpp v221, v221, v221 quad_perm:[2,3,0,1] row_mask:0xf bank_mask:0xf
    v_add_f32_dpp v220, v220, v220 row_half_mirror row_mask:0xf bank_mask:0xf
    s_nop 0
    v_add_f32_dpp v221, v221, v221 row_half_mirror row_mask:0xf bank_mask:0xf
    v_add_f32_dpp v220, v220, v220 row_mirror row_mask:0xf bank_mask:0xf
    s_add_u32 s77, s76, 442368
    s_add_u32 m0, s79, 49152
    s_nop 0
    buffer_load_dwordx4 v6, s[48:51], s77 offen lds
    v_mfma_f32_16x16x32_bf16 v[60:63], v[96:99], v[112:115], 0
    ds_read_b128 v[140:143], v15 offset:2048
    v_add_f32_dpp v221, v221, v221 row_mirror row_mask:0xf bank_mask:0xf
    v_add_f32_dpp v220, v220, v220 row_bcast:15 row_mask:0xa bank_mask:0xf
    s_nop 0
    v_add_f32_dpp v221, v221, v221 row_bcast:15 row_mask:0xa bank_mask:0xf
    v_mfma_f32_16x16x32_bf16 v[64:67], v[100:103], v[112:115], 0
    v_add_f32_dpp v220, v220, v220 row_bcast:31 row_mask:0xc bank_mask:0xf
    v_add_f32_dpp v221, v221, v221 row_bcast:31 row_mask:0xc bank_mask:0xf
    v_mul_f32 v220, 0x3acccccd, v220
    v_mfma_f32_16x16x32_bf16 v[68:71], v[104:107], v[112:115], 0
    v_mul_f32 v221, 0x3acccccd, v221
    v_fma_f32 v221, -v220, v220, v221
    v_max_f32 v221, 0, v221
    v_cvt_pk_bf16_f32 v220, v220, v221
    s_add_u32 m0, s78, 65280
    s_nop 0
    buffer_load_dwordx4 v5, s[44:47], s72 offen offset:256 lds
    s_waitcnt lgkmcnt(11)
    v_mfma_f32_16x16x32_bf16 v[72:75], v[88:91], v[116:119], 0
    v_and_b32 v221, 0xffff0000, v220
    v_add_f32 v221, 0x3727c5ac, v221
    v_cvt_pk_bf16_f32 v221, v221, v221
    v_mfma_f32_16x16x32_bf16 v[76:79], v[96:99], v[116:119], 0
    ds_read_b128 v[144:147], v15 offset:4096
    v_and_b32 v221, 0xffff0000, v221
    v_sqrt_f32 v221, v221
    v_lshlrev_b32 v220, 16, v220
    v_mfma_f32_16x16x32_bf16 v[80:83], v[100:103], v[116:119], 0
    v_cvt_pk_bf16_f32 v221, v221, v221
    v_and_b32 v221, 0xffff0000, v221
    v_rcp_f32 v218, v221
    s_add_u32 m0, s78, 81664
    s_nop 0
    buffer_load_dwordx4 v5, s[44:47], s74 offen offset:256 lds
    v_mfma_f32_16x16x32_bf16 v[84:87], v[104:107], v[116:119], 0
    v_mul_f32 v219, v221, v221
    v_sub_f32 v216, 0, v220
    v_mul_f32 v217, v218, v218
    v_mul_f32 v218, 0xc0135761, v218
    s_waitcnt lgkmcnt(9)
    v_mfma_f32_16x16x32_bf16 v[24:27], v[120:123], v[124:127], v[24:27]
    v_mul_f32 v217, 0x3d372713, v217
    v_mul_f32 v217, v217, v218
    s_lshl_b32 s13, s3, 3
    s_waitcnt lgkmcnt(6)
    v_mfma_f32_16x16x32_bf16 v[28:31], v[128:131], v[124:127], v[28:31]
    ds_read_b128 v[148:151], v15 offset:6144
    s_add_u32 s14, s13, 155776
    s_lshl_b32 s13, s13, 1
    s_add_u32 s13, s13, 155648
    s_add_u32 m0, s79, 50176
    s_nop 0
    buffer_load_dwordx4 v7, s[48:51], s77 offen lds
    s_waitcnt lgkmcnt(5)
    v_mfma_f32_16x16x32_bf16 v[32:35], v[132:135], v[124:127], v[32:35]
    v_mov_b32 v222, s13
    v_mov_b32 v223, s14
    s_mov_b32 exec_lo, 0
    s_mov_b32 exec_hi, 0x80000000
    ds_write_b128 v222, v[216:219]
    ds_write_b64 v223, v[220:221]
    s_mov_b64 exec, -1
    s_waitcnt lgkmcnt(5)
    v_mfma_f32_16x16x32_bf16 v[36:39], v[136:139], v[124:127], v[36:39]
    s_waitcnt lgkmcnt(4)
    v_mfma_f32_16x16x32_bf16 v[40:43], v[120:123], v[140:143], v[40:43]
    s_add_u32 m0, s78, 73472
    s_nop 0
    buffer_load_dwordx4 v5, s[44:47], s73 offen offset:256 lds
    v_mfma_f32_16x16x32_bf16 v[44:47], v[128:131], v[140:143], v[44:47]
    s_waitcnt lgkmcnt(0)
    s_waitcnt vmcnt(5)
    s_barrier
    ds_read_b64_tr_b16 v[152:153], v10 offset:0
    ds_read_b64_tr_b16 v[154:155], v10 offset:2048
    ds_read_b128 v[156:159], v16 offset:0
    v_mfma_f32_16x16x32_bf16 v[48:51], v[132:135], v[140:143], v[48:51]
    ds_read_b64_tr_b16 v[160:161], v10 offset:4096
    ds_read_b64_tr_b16 v[162:163], v10 offset:6144
    s_add_u32 s77, s76, 663552
    s_add_u32 m0, s79, 0
    s_nop 0
    buffer_load_dwordx4 v6, s[48:51], s77 offen lds
    v_mfma_f32_16x16x32_bf16 v[52:55], v[136:139], v[140:143], v[52:55]
    ds_read_b64_tr_b16 v[164:165], v11 offset:0
    ds_read_b64_tr_b16 v[166:167], v11 offset:2048
    s_add_u32 m0, s78, 89856
    s_nop 0
    buffer_load_dwordx4 v5, s[44:47], s75 offen offset:256 lds
    v_lshrrev_b32 v20, 5, v0
    v_lshlrev_b32 v20, 8, v20
    v_and_b32 v21, 7, v0
    v_lshl_add_u32 v20, v21, 4, v20
    v_bfe_u32 v21, v0, 3, 2
    v_lshl_add_u32 v20, v21, 2, v20
    s_lshl_b32 s13, s8, 11
    s_add_u32 s13, s13, 147456
    v_add_u32 v20, s13, v20
    ds_read_b32 v184, v20 offset:0
    ds_read_b32 v185, v20 offset:512
    ds_read_b32 v186, v20 offset:1024
    ds_read_b32 v187, v20 offset:1536
    ds_read_b32 v188, v20 offset:4096
    ds_read_b32 v189, v20 offset:4608
    ds_read_b32 v190, v20 offset:5120
    ds_read_b32 v191, v20 offset:5632
    v_mfma_f32_16x16x32_bf16 v[56:59], v[120:123], v[144:147], v[56:59]
    v_add_u32 v223, 155648, v4
    s_waitcnt lgkmcnt(14)
    ds_read_b128 v[216:219], v223
    v_lshrrev_b32 v222, 1, v4
    v_add_u32 v223, 155776, v222
    s_waitcnt lgkmcnt(14)
    ds_read_b64 v[220:221], v223
    v_mfma_f32_16x16x32_bf16 v[60:63], v[128:131], v[144:147], v[60:63]
    v_lshlrev_b32 v21, 2, v0
    v_mfma_f32_16x16x32_bf16 v[64:67], v[132:135], v[144:147], v[64:67]
    s_add_u32 m0, s78, 16000
    s_nop 0
    buffer_load_dwordx4 v5, s[44:47], s72 offen offset:384 lds
    v_mfma_f32_16x16x32_bf16 v[68:71], v[136:139], v[144:147], v[68:71]
    s_waitcnt lgkmcnt(2)
    ds_read_b64_tr_b16 v[168:169], v11 offset:4096
    ds_read_b64_tr_b16 v[170:171], v11 offset:6144
    ds_read_b128 v[172:175], v16 offset:2048
    v_mfma_f32_16x16x32_bf16 v[72:75], v[120:123], v[148:151], v[72:75]
    v_add_f32 v184, v184, v188
    v_mfma_f32_16x16x32_bf16 v[76:79], v[128:131], v[148:151], v[76:79]
    ds_read_b128 v[176:179], v16 offset:4096
    v_mfma_f32_16x16x32_bf16 v[80:83], v[132:135], v[148:151], v[80:83]
    s_add_u32 m0, s78, 32384
    s_nop 0
    buffer_load_dwordx4 v5, s[44:47], s74 offen offset:384 lds
    v_add_f32 v185, v185, v189
    v_mfma_f32_16x16x32_bf16 v[84:87], v[136:139], v[148:151], v[84:87]
    v_add_f32 v186, v186, v190
    v_mfma_f32_16x16x32_bf16 v[24:27], v[152:155], v[156:159], v[24:27]
    v_mfma_f32_16x16x32_bf16 v[28:31], v[160:163], v[156:159], v[28:31]
    ds_read_b128 v[180:183], v16 offset:6144
    v_add_f32 v187, v187, v191
    v_mfma_f32_16x16x32_bf16 v[32:35], v[164:167], v[156:159], v[32:35]
    s_add_u32 m0, s79, 1024
    s_nop 0
    buffer_load_dwordx4 v7, s[48:51], s77 offen lds
    v_add_f32 v184, v184, v186
    s_waitcnt lgkmcnt(3)
    v_mfma_f32_16x16x32_bf16 v[36:39], v[168:171], v[156:159], v[36:39]
    s_waitcnt lgkmcnt(2)
    v_mfma_f32_16x16x32_bf16 v[40:43], v[152:155], v[172:175], v[40:43]
    v_add_f32 v185, v185, v187
    v_mfma_f32_16x16x32_bf16 v[44:47], v[160:163], v[172:175], v[44:47]
    ds_read_b64_tr_b16 v[92:93], v10 offset:8192
    ds_read_b64_tr_b16 v[94:95], v10 offset:10240
    ds_read_b128 v[108:111], v17 offset:0
    v_add_f32 v184, v184, v185
    v_mfma_f32_16x16x32_bf16 v[48:51], v[164:167], v[172:175], v[48:51]
    ds_read_b64_tr_b16 v[112:113], v10 offset:12288
    ds_read_b64_tr_b16 v[114:115], v10 offset:14336
    s_add_u32 m0, s78, 24192
    s_nop 0
    buffer_load_dwordx4 v5, s[44:47], s73 offen offset:384 lds
    v_mfma_f32_16x16x32_bf16 v[52:55], v[168:171], v[172:175], v[52:55]
    ds_read_b64_tr_b16 v[88:89], v11 offset:8192
    ds_read_b64_tr_b16 v[90:91], v11 offset:10240
    s_cmp_lt_u32 s3, 2
    s_cselect_b64 exec, -1, 0
    buffer_store_dword v184, v21, s[52:55], s85 offen sc1
    s_mov_b64 exec, -1
    s_waitcnt lgkmcnt(8)
    v_mfma_f32_16x16x32_bf16 v[56:59], v[152:155], v[176:179], v[56:59]
    ds_read_b64_tr_b16 v[96:97], v11 offset:12288
    ds_read_b64_tr_b16 v[98:99], v11 offset:14336
    s_lshl_b32 s13, s42, 4
    s_add_u32 s13, s13, 0xf20000
    s_lshl_b32 s14, s42, 3
    s_add_u32 s14, s14, 0xf00000
    s_cmp_eq_u32 s3, 2
    s_cselect_b64 exec, 0xff, 0
    buffer_store_dwordx4 v[216:219], v4, s[52:55], s13 offen sc1
    buffer_store_dwordx2 v[220:221], v222, s[52:55], s14 offen sc1
    s_mov_b64 exec, -1
    v_mfma_f32_16x16x32_bf16 v[60:63], v[160:163], v[176:179], v[60:63]
    ds_read_b128 v[100:103], v17 offset:2048
    v_mfma_f32_16x16x32_bf16 v[64:67], v[164:167], v[176:179], v[64:67]
    s_add_u32 m0, s78, 40576
    s_nop 0
    buffer_load_dwordx4 v5, s[44:47], s75 offen offset:384 lds
    v_mfma_f32_16x16x32_bf16 v[68:71], v[168:171], v[176:179], v[68:71]
    s_waitcnt lgkmcnt(10)
    v_mfma_f32_16x16x32_bf16 v[72:75], v[152:155], v[180:183], v[72:75]
    v_mfma_f32_16x16x32_bf16 v[76:79], v[160:163], v[180:183], v[76:79]
    ds_read_b128 v[104:107], v17 offset:4096
    v_mfma_f32_16x16x32_bf16 v[80:83], v[164:167], v[180:183], v[80:83]
    v_mfma_f32_16x16x32_bf16 v[84:87], v[168:171], v[180:183], v[84:87]
    s_waitcnt lgkmcnt(8)
    v_mfma_f32_16x16x32_bf16 v[24:27], v[92:95], v[108:111], v[24:27]
    s_waitcnt lgkmcnt(6)
    v_mfma_f32_16x16x32_bf16 v[28:31], v[112:115], v[108:111], v[28:31]
    ds_read_b128 v[116:119], v17 offset:6144
    s_waitcnt lgkmcnt(5)
    v_mfma_f32_16x16x32_bf16 v[32:35], v[88:91], v[108:111], v[32:35]
    s_waitcnt lgkmcnt(3)
    v_mfma_f32_16x16x32_bf16 v[36:39], v[96:99], v[108:111], v[36:39]
    s_waitcnt lgkmcnt(2)
    v_mfma_f32_16x16x32_bf16 v[40:43], v[92:95], v[100:103], v[40:43]
    v_mfma_f32_16x16x32_bf16 v[44:47], v[112:115], v[100:103], v[44:47]
    s_waitcnt vmcnt(8)
    s_barrier
    ds_read_b64_tr_b16 v[124:125], v12 offset:0
    ds_read_b64_tr_b16 v[126:127], v12 offset:2048
    ds_read_b128 v[140:143], v18 offset:0
    v_mfma_f32_16x16x32_bf16 v[48:51], v[88:91], v[100:103], v[48:51]
    ds_read_b64_tr_b16 v[144:145], v12 offset:4096
    ds_read_b64_tr_b16 v[146:147], v12 offset:6144
    s_add_u32 s77, s76, 884736
    s_add_u32 m0, s79, 98304
    s_nop 0
    buffer_load_dwordx4 v6, s[48:51], s77 offen lds
    v_mfma_f32_16x16x32_bf16 v[52:55], v[96:99], v[100:103], v[52:55]
    ds_read_b64_tr_b16 v[120:121], v13 offset:0
    ds_read_b64_tr_b16 v[122:123], v13 offset:2048
    s_waitcnt lgkmcnt(8)
    v_mfma_f32_16x16x32_bf16 v[56:59], v[92:95], v[104:107], v[56:59]
    ds_read_b64_tr_b16 v[128:129], v13 offset:4096
    ds_read_b64_tr_b16 v[130:131], v13 offset:6144
    v_mfma_f32_16x16x32_bf16 v[60:63], v[112:115], v[104:107], v[60:63]
    ds_read_b128 v[132:135], v18 offset:2048
    v_mfma_f32_16x16x32_bf16 v[64:67], v[88:91], v[104:107], v[64:67]
    s_add_u32 m0, s78, 114176
    s_nop 0
    buffer_load_dwordx4 v5, s[44:47], s72 offen offset:512 lds
    v_mfma_f32_16x16x32_bf16 v[68:71], v[96:99], v[104:107], v[68:71]
    s_waitcnt lgkmcnt(10)
    v_mfma_f32_16x16x32_bf16 v[72:75], v[92:95], v[116:119], v[72:75]
    v_mfma_f32_16x16x32_bf16 v[76:79], v[112:115], v[116:119], v[76:79]
    ds_read_b128 v[136:139], v18 offset:4096
    v_mfma_f32_16x16x32_bf16 v[80:83], v[88:91], v[116:119], v[80:83]
    s_add_u32 m0, s78, 130560
    s_nop 0
    buffer_load_dwordx4 v5, s[44:47], s74 offen offset:512 lds
    v_mfma_f32_16x16x32_bf16 v[84:87], v[96:99], v[116:119], v[84:87]
    s_waitcnt lgkmcnt(8)
    v_mfma_f32_16x16x32_bf16 v[24:27], v[124:127], v[140:143], v[24:27]
    s_waitcnt lgkmcnt(6)
    v_mfma_f32_16x16x32_bf16 v[28:31], v[144:147], v[140:143], v[28:31]
    ds_read_b128 v[148:151], v18 offset:6144
    s_waitcnt lgkmcnt(5)
    v_mfma_f32_16x16x32_bf16 v[32:35], v[120:123], v[140:143], v[32:35]
    s_add_u32 m0, s79, 99328
    s_nop 0
    buffer_load_dwordx4 v7, s[48:51], s77 offen lds
    s_waitcnt lgkmcnt(3)
    v_mfma_f32_16x16x32_bf16 v[36:39], v[128:131], v[140:143], v[36:39]
    s_waitcnt lgkmcnt(2)
    v_mfma_f32_16x16x32_bf16 v[40:43], v[124:127], v[132:135], v[40:43]
    v_mfma_f32_16x16x32_bf16 v[44:47], v[144:147], v[132:135], v[44:47]
    ds_read_b64_tr_b16 v[156:157], v12 offset:8192
    ds_read_b64_tr_b16 v[158:159], v12 offset:10240
    ds_read_b128 v[172:175], v19 offset:0
    v_mfma_f32_16x16x32_bf16 v[48:51], v[120:123], v[132:135], v[48:51]
    ds_read_b64_tr_b16 v[176:177], v12 offset:12288
    ds_read_b64_tr_b16 v[178:179], v12 offset:14336
    s_add_u32 m0, s78, 122368
    s_nop 0
    buffer_load_dwordx4 v5, s[44:47], s73 offen offset:512 lds
    v_mfma_f32_16x16x32_bf16 v[52:55], v[128:131], v[132:135], v[52:55]
    ds_read_b64_tr_b16 v[152:153], v13 offset:8192
    ds_read_b64_tr_b16 v[154:155], v13 offset:10240
    s_waitcnt lgkmcnt(8)
    v_mfma_f32_16x16x32_bf16 v[56:59], v[124:127], v[136:139], v[56:59]
    ds_read_b64_tr_b16 v[160:161], v13 offset:12288
    ds_read_b64_tr_b16 v[162:163], v13 offset:14336
    v_mfma_f32_16x16x32_bf16 v[60:63], v[144:147], v[136:139], v[60:63]
    ds_read_b128 v[164:167], v19 offset:2048
    v_mfma_f32_16x16x32_bf16 v[64:67], v[120:123], v[136:139], v[64:67]
    s_add_u32 m0, s78, 138752
    s_nop 0
    buffer_load_dwordx4 v5, s[44:47], s75 offen offset:512 lds
    v_mfma_f32_16x16x32_bf16 v[68:71], v[128:131], v[136:139], v[68:71]
    s_waitcnt lgkmcnt(10)
    v_mfma_f32_16x16x32_bf16 v[72:75], v[124:127], v[148:151], v[72:75]
    v_mfma_f32_16x16x32_bf16 v[76:79], v[144:147], v[148:151], v[76:79]
    ds_read_b128 v[168:171], v19 offset:4096
    v_mfma_f32_16x16x32_bf16 v[80:83], v[120:123], v[148:151], v[80:83]
    v_mfma_f32_16x16x32_bf16 v[84:87], v[128:131], v[148:151], v[84:87]
    s_waitcnt lgkmcnt(8)
    v_mfma_f32_16x16x32_bf16 v[24:27], v[156:159], v[172:175], v[24:27]
    s_waitcnt lgkmcnt(6)
    v_mfma_f32_16x16x32_bf16 v[28:31], v[176:179], v[172:175], v[28:31]
    ds_read_b128 v[180:183], v19 offset:6144
    s_waitcnt lgkmcnt(5)
    v_mfma_f32_16x16x32_bf16 v[32:35], v[152:155], v[172:175], v[32:35]
    s_waitcnt lgkmcnt(3)
    v_mfma_f32_16x16x32_bf16 v[36:39], v[160:163], v[172:175], v[36:39]
    s_waitcnt lgkmcnt(2)
    v_mfma_f32_16x16x32_bf16 v[40:43], v[156:159], v[164:167], v[40:43]
    v_mfma_f32_16x16x32_bf16 v[44:47], v[176:179], v[164:167], v[44:47]
    s_waitcnt vmcnt(7)
    s_waitcnt vmcnt(6)
    s_barrier
    s_and_b32 s13, s5, 3
    s_lshl_b32 s13, s13, 6
    v_mov_b32 v20, 1
    s_cmp_eq_u32 s3, 7
    s_cselect_b64 exec, 1, 0
    buffer_atomic_add v20, off, s[56:59], s13
    s_mov_b64 exec, -1
    ds_read_b64_tr_b16 v[108:109], v8 offset:0
    ds_read_b64_tr_b16 v[110:111], v8 offset:2048
    ds_read_b128 v[100:103], v14 offset:0
    v_mfma_f32_16x16x32_bf16 v[48:51], v[152:155], v[164:167], v[48:51]
    ds_read_b64_tr_b16 v[104:105], v8 offset:4096
    ds_read_b64_tr_b16 v[106:107], v8 offset:6144
    s_add_u32 s77, s76, 1105920
    s_add_u32 m0, s79, 49152
    s_nop 0
    buffer_load_dwordx4 v6, s[48:51], s77 offen lds
    v_mfma_f32_16x16x32_bf16 v[52:55], v[160:163], v[164:167], v[52:55]
    ds_read_b64_tr_b16 v[92:93], v9 offset:0
    ds_read_b64_tr_b16 v[94:95], v9 offset:2048
    s_waitcnt lgkmcnt(8)
    v_mfma_f32_16x16x32_bf16 v[56:59], v[156:159], v[168:171], v[56:59]
    ds_read_b64_tr_b16 v[112:113], v9 offset:4096
    ds_read_b64_tr_b16 v[114:115], v9 offset:6144
    v_mfma_f32_16x16x32_bf16 v[60:63], v[176:179], v[168:171], v[60:63]
    ds_read_b128 v[88:91], v14 offset:2048
    v_mfma_f32_16x16x32_bf16 v[64:67], v[152:155], v[168:171], v[64:67]
    s_add_u32 m0, s78, 64896
    s_nop 0
    buffer_load_dwordx4 v5, s[44:47], s72 offen offset:640 lds
    v_mfma_f32_16x16x32_bf16 v[68:71], v[160:163], v[168:171], v[68:71]
    s_waitcnt lgkmcnt(10)
    v_mfma_f32_16x16x32_bf16 v[72:75], v[156:159], v[180:183], v[72:75]
    v_mfma_f32_16x16x32_bf16 v[76:79], v[176:179], v[180:183], v[76:79]
    ds_read_b128 v[96:99], v14 offset:4096
    v_mfma_f32_16x16x32_bf16 v[80:83], v[152:155], v[180:183], v[80:83]
    s_add_u32 m0, s78, 81280
    s_nop 0
    buffer_load_dwordx4 v5, s[44:47], s74 offen offset:640 lds
    v_mfma_f32_16x16x32_bf16 v[84:87], v[160:163], v[180:183], v[84:87]
    s_waitcnt lgkmcnt(8)
    v_mfma_f32_16x16x32_bf16 v[24:27], v[108:111], v[100:103], v[24:27]
    s_waitcnt lgkmcnt(6)
    v_mfma_f32_16x16x32_bf16 v[28:31], v[104:107], v[100:103], v[28:31]
    ds_read_b128 v[116:119], v14 offset:6144
    s_waitcnt lgkmcnt(5)
    v_mfma_f32_16x16x32_bf16 v[32:35], v[92:95], v[100:103], v[32:35]
    s_add_u32 m0, s79, 50176
    s_nop 0
    buffer_load_dwordx4 v7, s[48:51], s77 offen lds
    s_waitcnt lgkmcnt(3)
    v_mfma_f32_16x16x32_bf16 v[36:39], v[112:115], v[100:103], v[36:39]
    s_waitcnt lgkmcnt(2)
    v_mfma_f32_16x16x32_bf16 v[40:43], v[108:111], v[88:91], v[40:43]
    v_mfma_f32_16x16x32_bf16 v[44:47], v[104:107], v[88:91], v[44:47]
    ds_read_b64_tr_b16 v[140:141], v8 offset:8192
    ds_read_b64_tr_b16 v[142:143], v8 offset:10240
    ds_read_b128 v[132:135], v15 offset:0
    v_mfma_f32_16x16x32_bf16 v[48:51], v[92:95], v[88:91], v[48:51]
    ds_read_b64_tr_b16 v[136:137], v8 offset:12288
    ds_read_b64_tr_b16 v[138:139], v8 offset:14336
    s_add_u32 m0, s78, 73088
    s_nop 0
    buffer_load_dwordx4 v5, s[44:47], s73 offen offset:640 lds
    v_mfma_f32_16x16x32_bf16 v[52:55], v[112:115], v[88:91], v[52:55]
    ds_read_b64_tr_b16 v[124:125], v9 offset:8192
    ds_read_b64_tr_b16 v[126:127], v9 offset:10240
    s_waitcnt lgkmcnt(8)
    v_mfma_f32_16x16x32_bf16 v[56:59], v[108:111], v[96:99], v[56:59]
    ds_read_b64_tr_b16 v[144:145], v9 offset:12288
    ds_read_b64_tr_b16 v[146:147], v9 offset:14336
    v_mfma_f32_16x16x32_bf16 v[60:63], v[104:107], v[96:99], v[60:63]
    ds_read_b128 v[120:123], v15 offset:2048
    v_mfma_f32_16x16x32_bf16 v[64:67], v[92:95], v[96:99], v[64:67]
    s_add_u32 m0, s78, 89472
    s_nop 0
    buffer_load_dwordx4 v5, s[44:47], s75 offen offset:640 lds
    v_mfma_f32_16x16x32_bf16 v[68:71], v[112:115], v[96:99], v[68:71]
    s_waitcnt lgkmcnt(10)
    v_mfma_f32_16x16x32_bf16 v[72:75], v[108:111], v[116:119], v[72:75]
    v_mfma_f32_16x16x32_bf16 v[76:79], v[104:107], v[116:119], v[76:79]
    ds_read_b128 v[128:131], v15 offset:4096
    v_mfma_f32_16x16x32_bf16 v[80:83], v[92:95], v[116:119], v[80:83]
    v_mfma_f32_16x16x32_bf16 v[84:87], v[112:115], v[116:119], v[84:87]
    s_waitcnt lgkmcnt(8)
    v_mfma_f32_16x16x32_bf16 v[24:27], v[140:143], v[132:135], v[24:27]
    s_waitcnt lgkmcnt(6)
    v_mfma_f32_16x16x32_bf16 v[28:31], v[136:139], v[132:135], v[28:31]
    ds_read_b128 v[148:151], v15 offset:6144
    s_waitcnt lgkmcnt(5)
    v_mfma_f32_16x16x32_bf16 v[32:35], v[124:127], v[132:135], v[32:35]
    s_waitcnt lgkmcnt(3)
    v_mfma_f32_16x16x32_bf16 v[36:39], v[144:147], v[132:135], v[36:39]
    s_waitcnt lgkmcnt(2)
    v_mfma_f32_16x16x32_bf16 v[40:43], v[140:143], v[120:123], v[40:43]
    v_mfma_f32_16x16x32_bf16 v[44:47], v[136:139], v[120:123], v[44:47]
    s_waitcnt vmcnt(7)
    s_barrier
    ds_read_b64_tr_b16 v[172:173], v10 offset:0
    ds_read_b64_tr_b16 v[174:175], v10 offset:2048
    ds_read_b128 v[164:167], v16 offset:0
    v_mfma_f32_16x16x32_bf16 v[48:51], v[124:127], v[120:123], v[48:51]
    ds_read_b64_tr_b16 v[168:169], v10 offset:4096
    ds_read_b64_tr_b16 v[170:171], v10 offset:6144
    s_add_u32 s77, s76, 1327104
    s_add_u32 m0, s79, 0
    s_nop 0
    buffer_load_dwordx4 v6, s[48:51], s77 offen lds
    v_mfma_f32_16x16x32_bf16 v[52:55], v[144:147], v[120:123], v[52:55]
    ds_read_b64_tr_b16 v[156:157], v11 offset:0
    ds_read_b64_tr_b16 v[158:159], v11 offset:2048
    s_waitcnt lgkmcnt(8)
    v_mfma_f32_16x16x32_bf16 v[56:59], v[140:143], v[128:131], v[56:59]
    ds_read_b64_tr_b16 v[176:177], v11 offset:4096
    ds_read_b64_tr_b16 v[178:179], v11 offset:6144
    v_mfma_f32_16x16x32_bf16 v[60:63], v[136:139], v[128:131], v[60:63]
    ds_read_b128 v[152:155], v16 offset:2048
    v_mfma_f32_16x16x32_bf16 v[64:67], v[124:127], v[128:131], v[64:67]
    s_add_u32 m0, s78, 15616
    s_nop 0
    buffer_load_dwordx4 v5, s[44:47], s72 offen offset:768 lds
    v_mfma_f32_16x16x32_bf16 v[68:71], v[144:147], v[128:131], v[68:71]
    s_waitcnt lgkmcnt(10)
    v_mfma_f32_16x16x32_bf16 v[72:75], v[140:143], v[148:151], v[72:75]
    v_mfma_f32_16x16x32_bf16 v[76:79], v[136:139], v[148:151], v[76:79]
    ds_read_b128 v[160:163], v16 offset:4096
    v_mfma_f32_16x16x32_bf16 v[80:83], v[124:127], v[148:151], v[80:83]
    s_add_u32 m0, s78, 32000
    s_nop 0
    buffer_load_dwordx4 v5, s[44:47], s74 offen offset:768 lds
    v_mfma_f32_16x16x32_bf16 v[84:87], v[144:147], v[148:151], v[84:87]
    s_waitcnt lgkmcnt(8)
    v_mfma_f32_16x16x32_bf16 v[24:27], v[172:175], v[164:167], v[24:27]
    s_waitcnt lgkmcnt(6)
    v_mfma_f32_16x16x32_bf16 v[28:31], v[168:171], v[164:167], v[28:31]
    ds_read_b128 v[180:183], v16 offset:6144
    s_waitcnt lgkmcnt(5)
    v_mfma_f32_16x16x32_bf16 v[32:35], v[156:159], v[164:167], v[32:35]
    s_add_u32 m0, s79, 1024
    s_nop 0
    buffer_load_dwordx4 v7, s[48:51], s77 offen lds
    s_waitcnt lgkmcnt(3)
    v_mfma_f32_16x16x32_bf16 v[36:39], v[176:179], v[164:167], v[36:39]
    s_waitcnt lgkmcnt(2)
    v_mfma_f32_16x16x32_bf16 v[40:43], v[172:175], v[152:155], v[40:43]
    v_mfma_f32_16x16x32_bf16 v[44:47], v[168:171], v[152:155], v[44:47]
    ds_read_b64_tr_b16 v[100:101], v10 offset:8192
    ds_read_b64_tr_b16 v[102:103], v10 offset:10240
    ds_read_b128 v[88:91], v17 offset:0
    v_mfma_f32_16x16x32_bf16 v[48:51], v[156:159], v[152:155], v[48:51]
    ds_read_b64_tr_b16 v[96:97], v10 offset:12288
    ds_read_b64_tr_b16 v[98:99], v10 offset:14336
    s_add_u32 m0, s78, 23808
    s_nop 0
    buffer_load_dwordx4 v5, s[44:47], s73 offen offset:768 lds
    v_mfma_f32_16x16x32_bf16 v[52:55], v[176:179], v[152:155], v[52:55]
    ds_read_b64_tr_b16 v[108:109], v11 offset:8192
    ds_read_b64_tr_b16 v[110:111], v11 offset:10240
    s_waitcnt lgkmcnt(8)
    v_mfma_f32_16x16x32_bf16 v[56:59], v[172:175], v[160:163], v[56:59]
    ds_read_b64_tr_b16 v[104:105], v11 offset:12288
    ds_read_b64_tr_b16 v[106:107], v11 offset:14336
    v_mfma_f32_16x16x32_bf16 v[60:63], v[168:171], v[160:163], v[60:63]
    ds_read_b128 v[92:95], v17 offset:2048
    v_mfma_f32_16x16x32_bf16 v[64:67], v[156:159], v[160:163], v[64:67]
    s_add_u32 m0, s78, 40192
    s_nop 0
    buffer_load_dwordx4 v5, s[44:47], s75 offen offset:768 lds
    v_mfma_f32_16x16x32_bf16 v[68:71], v[176:179], v[160:163], v[68:71]
    s_waitcnt lgkmcnt(10)
    v_mfma_f32_16x16x32_bf16 v[72:75], v[172:175], v[180:183], v[72:75]
    v_mfma_f32_16x16x32_bf16 v[76:79], v[168:171], v[180:183], v[76:79]
    ds_read_b128 v[112:115], v17 offset:4096
    v_mfma_f32_16x16x32_bf16 v[80:83], v[156:159], v[180:183], v[80:83]
    v_mfma_f32_16x16x32_bf16 v[84:87], v[176:179], v[180:183], v[84:87]
    s_waitcnt lgkmcnt(8)
    v_mfma_f32_16x16x32_bf16 v[24:27], v[100:103], v[88:91], v[24:27]
    s_waitcnt lgkmcnt(6)
    v_mfma_f32_16x16x32_bf16 v[28:31], v[96:99], v[88:91], v[28:31]
    ds_read_b128 v[116:119], v17 offset:6144
    s_waitcnt lgkmcnt(5)
    v_mfma_f32_16x16x32_bf16 v[32:35], v[108:111], v[88:91], v[32:35]
    v_lshlrev_b32 v22, 6, v0
    s_and_b64 exec, s[80:81], 0xf
    buffer_load_dword v1, v22, s[56:59], 0 offen sc1
    s_mov_b64 exec, -1
    s_waitcnt lgkmcnt(3)
    v_mfma_f32_16x16x32_bf16 v[36:39], v[104:107], v[88:91], v[36:39]
    s_waitcnt lgkmcnt(2)
    v_mfma_f32_16x16x32_bf16 v[40:43], v[100:103], v[92:95], v[40:43]
    v_mfma_f32_16x16x32_bf16 v[44:47], v[96:99], v[92:95], v[44:47]
    s_waitcnt vmcnt(7)
    s_barrier
    ds_read_b64_tr_b16 v[132:133], v12 offset:0
    ds_read_b64_tr_b16 v[134:135], v12 offset:2048
    ds_read_b128 v[120:123], v18 offset:0
    v_mfma_f32_16x16x32_bf16 v[48:51], v[108:111], v[92:95], v[48:51]
    ds_read_b64_tr_b16 v[128:129], v12 offset:4096
    ds_read_b64_tr_b16 v[130:131], v12 offset:6144
    s_add_u32 s77, s76, 1548288
    s_add_u32 m0, s79, 98304
    s_nop 0
    buffer_load_dwordx4 v6, s[48:51], s77 offen lds
    v_mfma_f32_16x16x32_bf16 v[52:55], v[104:107], v[92:95], v[52:55]
    ds_read_b64_tr_b16 v[140:141], v13 offset:0
    ds_read_b64_tr_b16 v[142:143], v13 offset:2048
    s_waitcnt lgkmcnt(8)
    v_mfma_f32_16x16x32_bf16 v[56:59], v[100:103], v[112:115], v[56:59]
    ds_read_b64_tr_b16 v[136:137], v13 offset:4096
    ds_read_b64_tr_b16 v[138:139], v13 offset:6144
    v_mfma_f32_16x16x32_bf16 v[60:63], v[96:99], v[112:115], v[60:63]
    ds_read_b128 v[124:127], v18 offset:2048
    v_mfma_f32_16x16x32_bf16 v[64:67], v[108:111], v[112:115], v[64:67]
    s_add_u32 m0, s78, 113792
    s_nop 0
    buffer_load_dwordx4 v5, s[44:47], s72 offen offset:896 lds
    v_mfma_f32_16x16x32_bf16 v[68:71], v[104:107], v[112:115], v[68:71]
    s_waitcnt lgkmcnt(10)
    v_mfma_f32_16x16x32_bf16 v[72:75], v[100:103], v[116:119], v[72:75]
    v_mfma_f32_16x16x32_bf16 v[76:79], v[96:99], v[116:119], v[76:79]
    ds_read_b128 v[144:147], v18 offset:4096
    v_mfma_f32_16x16x32_bf16 v[80:83], v[108:111], v[116:119], v[80:83]
    s_add_u32 m0, s78, 130176
    s_nop 0
    buffer_load_dwordx4 v5, s[44:47], s74 offen offset:896 lds
    v_mfma_f32_16x16x32_bf16 v[84:87], v[104:107], v[116:119], v[84:87]
    s_waitcnt lgkmcnt(8)
    v_mfma_f32_16x16x32_bf16 v[24:27], v[132:135], v[120:123], v[24:27]
    s_waitcnt lgkmcnt(6)
    v_mfma_f32_16x16x32_bf16 v[28:31], v[128:131], v[120:123], v[28:31]
    ds_read_b128 v[148:151], v18 offset:6144
    s_waitcnt lgkmcnt(5)
    v_mfma_f32_16x16x32_bf16 v[32:35], v[140:143], v[120:123], v[32:35]
    s_add_u32 m0, s79, 99328
    s_nop 0
    buffer_load_dwordx4 v7, s[48:51], s77 offen lds
    s_waitcnt lgkmcnt(3)
    v_mfma_f32_16x16x32_bf16 v[36:39], v[136:139], v[120:123], v[36:39]
    s_waitcnt lgkmcnt(2)
    v_mfma_f32_16x16x32_bf16 v[40:43], v[132:135], v[124:127], v[40:43]
    v_mfma_f32_16x16x32_bf16 v[44:47], v[128:131], v[124:127], v[44:47]
    ds_read_b64_tr_b16 v[164:165], v12 offset:8192
    ds_read_b64_tr_b16 v[166:167], v12 offset:10240
    ds_read_b128 v[152:155], v19 offset:0
    v_mfma_f32_16x16x32_bf16 v[48:51], v[140:143], v[124:127], v[48:51]
    ds_read_b64_tr_b16 v[160:161], v12 offset:12288
    ds_read_b64_tr_b16 v[162:163], v12 offset:14336
    s_add_u32 m0, s78, 121984
    s_nop 0
    buffer_load_dwordx4 v5, s[44:47], s73 offen offset:896 lds
    v_mfma_f32_16x16x32_bf16 v[52:55], v[136:139], v[124:127], v[52:55]
    ds_read_b64_tr_b16 v[172:173], v13 offset:8192
    ds_read_b64_tr_b16 v[174:175], v13 offset:10240
    s_waitcnt lgkmcnt(8)
    v_mfma_f32_16x16x32_bf16 v[56:59], v[132:135], v[144:147], v[56:59]
    ds_read_b64_tr_b16 v[168:169], v13 offset:12288
    ds_read_b64_tr_b16 v[170:171], v13 offset:14336
    v_mfma_f32_16x16x32_bf16 v[60:63], v[128:131], v[144:147], v[60:63]
    ds_read_b128 v[156:159], v19 offset:2048
    v_mfma_f32_16x16x32_bf16 v[64:67], v[140:143], v[144:147], v[64:67]
    s_add_u32 m0, s78, 138368
    s_nop 0
    buffer_load_dwordx4 v5, s[44:47], s75 offen offset:896 lds
    v_mfma_f32_16x16x32_bf16 v[68:71], v[136:139], v[144:147], v[68:71]
    s_waitcnt lgkmcnt(10)
    v_mfma_f32_16x16x32_bf16 v[72:75], v[132:135], v[148:151], v[72:75]
    v_mfma_f32_16x16x32_bf16 v[76:79], v[128:131], v[148:151], v[76:79]
    ds_read_b128 v[176:179], v19 offset:4096
    v_mfma_f32_16x16x32_bf16 v[80:83], v[140:143], v[148:151], v[80:83]
    v_mfma_f32_16x16x32_bf16 v[84:87], v[136:139], v[148:151], v[84:87]
    s_waitcnt lgkmcnt(8)
    v_mfma_f32_16x16x32_bf16 v[24:27], v[164:167], v[152:155], v[24:27]
    s_waitcnt lgkmcnt(6)
    v_mfma_f32_16x16x32_bf16 v[28:31], v[160:163], v[152:155], v[28:31]
    ds_read_b128 v[180:183], v19 offset:6144
    s_waitcnt lgkmcnt(5)
    v_mfma_f32_16x16x32_bf16 v[32:35], v[172:175], v[152:155], v[32:35]
    s_waitcnt lgkmcnt(3)
    v_mfma_f32_16x16x32_bf16 v[36:39], v[168:171], v[152:155], v[36:39]
    s_waitcnt lgkmcnt(2)
    v_mfma_f32_16x16x32_bf16 v[40:43], v[164:167], v[156:159], v[40:43]
    v_mfma_f32_16x16x32_bf16 v[44:47], v[160:163], v[156:159], v[44:47]
    s_waitcnt vmcnt(6)
    s_and_b64 exec, s[80:81], 0xf
    s_mov_b32 s12, 0x40000
    s_nop 4
Z1_PA:
    v_cmp_ne_u32 vcc, 64, v1
    s_nop 1
    s_cbranch_vccz Z1_PA_OK
    s_sub_u32 s12, s12, 1
    s_cbranch_scc1 Z1_PA_OK
    buffer_load_dword v1, v22, s[56:59], 0 offen sc1
    s_waitcnt vmcnt(0)
    s_branch Z1_PA
Z1_PA_OK:
    s_mov_b64 exec, s[80:81]
    buffer_load_dwordx4 v[236:239], v4, s[52:55], s84 offen offset:0 sc1
    buffer_load_dwordx4 v[240:243], v4, s[52:55], s84 offen offset:1024 sc1
    buffer_load_dwordx4 v[244:247], v4, s[52:55], s84 offen offset:2048 sc1
    buffer_load_dwordx4 v[248:251], v4, s[52:55], s84 offen offset:3072 sc1
    s_mov_b64 exec, -1
    s_barrier
    ds_read_b64_tr_b16 v[88:89], v8 offset:0
    ds_read_b64_tr_b16 v[90:91], v8 offset:2048
    ds_read_b128 v[92:95], v14 offset:0
    v_mfma_f32_16x16x32_bf16 v[48:51], v[172:175], v[156:159], v[48:51]
    ds_read_b64_tr_b16 v[112:113], v8 offset:4096
    ds_read_b64_tr_b16 v[114:115], v8 offset:6144
    s_add_u32 s77, s76, 1769472
    s_add_u32 m0, s79, 49152
    s_nop 0
    buffer_load_dwordx4 v6, s[48:51], s77 offen lds
    v_mfma_f32_16x16x32_bf16 v[52:55], v[168:171], v[156:159], v[52:55]
    ds_read_b64_tr_b16 v[100:101], v9 offset:0
    ds_read_b64_tr_b16 v[102:103], v9 offset:2048
    s_waitcnt lgkmcnt(8)
    v_mfma_f32_16x16x32_bf16 v[56:59], v[164:167], v[176:179], v[56:59]
    ds_read_b64_tr_b16 v[96:97], v9 offset:4096
    ds_read_b64_tr_b16 v[98:99], v9 offset:6144
    v_mfma_f32_16x16x32_bf16 v[60:63], v[160:163], v[176:179], v[60:63]
    ds_read_b128 v[108:111], v14 offset:2048
    v_mfma_f32_16x16x32_bf16 v[64:67], v[172:175], v[176:179], v[64:67]
    s_add_u32 m0, s78, 64512
    s_nop 0
    buffer_load_dwordx4 v5, s[44:47], s72 offen offset:1024 lds
    v_mfma_f32_16x16x32_bf16 v[68:71], v[168:171], v[176:179], v[68:71]
    s_waitcnt lgkmcnt(10)
    v_mfma_f32_16x16x32_bf16 v[72:75], v[164:167], v[180:183], v[72:75]
    v_mfma_f32_16x16x32_bf16 v[76:79], v[160:163], v[180:183], v[76:79]
    ds_read_b128 v[104:107], v14 offset:4096
    v_mfma_f32_16x16x32_bf16 v[80:83], v[172:175], v[180:183], v[80:83]
    s_add_u32 m0, s78, 80896
    s_nop 0
    buffer_load_dwordx4 v5, s[44:47], s74 offen offset:1024 lds
    v_mfma_f32_16x16x32_bf16 v[84:87], v[168:171], v[180:183], v[84:87]
    s_waitcnt lgkmcnt(8)
    v_mfma_f32_16x16x32_bf16 v[24:27], v[88:91], v[92:95], v[24:27]
    s_waitcnt lgkmcnt(6)
    v_mfma_f32_16x16x32_bf16 v[28:31], v[112:115], v[92:95], v[28:31]
    ds_read_b128 v[116:119], v14 offset:6144
    s_waitcnt lgkmcnt(5)
    v_mfma_f32_16x16x32_bf16 v[32:35], v[100:103], v[92:95], v[32:35]
    s_add_u32 m0, s79, 50176
    s_nop 0
    buffer_load_dwordx4 v7, s[48:51], s77 offen lds
    s_waitcnt lgkmcnt(3)
    v_mfma_f32_16x16x32_bf16 v[36:39], v[96:99], v[92:95], v[36:39]
    s_waitcnt lgkmcnt(2)
    v_mfma_f32_16x16x32_bf16 v[40:43], v[88:91], v[108:111], v[40:43]
    v_mfma_f32_16x16x32_bf16 v[44:47], v[112:115], v[108:111], v[44:47]
    ds_read_b64_tr_b16 v[120:121], v8 offset:8192
    ds_read_b64_tr_b16 v[122:123], v8 offset:10240
    ds_read_b128 v[124:127], v15 offset:0
    v_mfma_f32_16x16x32_bf16 v[48:51], v[100:103], v[108:111], v[48:51]
    ds_read_b64_tr_b16 v[144:145], v8 offset:12288
    ds_read_b64_tr_b16 v[146:147], v8 offset:14336
    s_add_u32 m0, s78, 72704
    s_nop 0
    buffer_load_dwordx4 v5, s[44:47], s73 offen offset:1024 lds
    v_mfma_f32_16x16x32_bf16 v[52:55], v[96:99], v[108:111], v[52:55]
    ds_read_b64_tr_b16 v[132:133], v9 offset:8192
    ds_read_b64_tr_b16 v[134:135], v9 offset:10240
    s_waitcnt lgkmcnt(8)
    v_mfma_f32_16x16x32_bf16 v[56:59], v[88:91], v[104:107], v[56:59]
    ds_read_b64_tr_b16 v[128:129], v9 offset:12288
    ds_read_b64_tr_b16 v[130:131], v9 offset:14336
    v_mfma_f32_16x16x32_bf16 v[60:63], v[112:115], v[104:107], v[60:63]
    ds_read_b128 v[140:143], v15 offset:2048
    v_mfma_f32_16x16x32_bf16 v[64:67], v[100:103], v[104:107], v[64:67]
    s_add_u32 m0, s78, 89088
    s_nop 0
    buffer_load_dwordx4 v5, s[44:47], s75 offen offset:1024 lds
    v_mfma_f32_16x16x32_bf16 v[68:71], v[96:99], v[104:107], v[68:71]
    s_waitcnt lgkmcnt(10)
    v_mfma_f32_16x16x32_bf16 v[72:75], v[88:91], v[116:119], v[72:75]
    v_lshlrev_b32 v23, 4, v2
    v_mfma_f32_16x16x32_bf16 v[76:79], v[112:115], v[116:119], v[76:79]
    ds_read_b128 v[136:139], v15 offset:4096
    buffer_load_dwordx4 v[200:203], v23, s[52:55], s83 offen offset:0 sc1
    v_mfma_f32_16x16x32_bf16 v[80:83], v[100:103], v[116:119], v[80:83]
    v_mfma_f32_16x16x32_bf16 v[84:87], v[96:99], v[116:119], v[84:87]
    buffer_load_dwordx4 v[204:207], v23, s[52:55], s83 offen offset:256 sc1
    s_waitcnt lgkmcnt(8)
    v_mfma_f32_16x16x32_bf16 v[24:27], v[120:123], v[124:127], v[24:27]
    buffer_load_dwordx4 v[208:211], v23, s[52:55], s83 offen offset:512 sc1
    s_waitcnt lgkmcnt(6)
    v_mfma_f32_16x16x32_bf16 v[28:31], v[144:147], v[124:127], v[28:31]
    ds_read_b128 v[148:151], v15 offset:6144
    s_waitcnt lgkmcnt(5)
    v_mfma_f32_16x16x32_bf16 v[32:35], v[132:135], v[124:127], v[32:35]
    buffer_load_dwordx4 v[212:215], v23, s[52:55], s83 offen offset:768 sc1
    s_waitcnt lgkmcnt(3)
    v_mfma_f32_16x16x32_bf16 v[36:39], v[128:131], v[124:127], v[36:39]
    s_waitcnt lgkmcnt(2)
    v_mfma_f32_16x16x32_bf16 v[40:43], v[120:123], v[140:143], v[40:43]
    v_mfma_f32_16x16x32_bf16 v[44:47], v[144:147], v[140:143], v[44:47]
    s_waitcnt vmcnt(14)
    s_barrier
    ds_read_b64_tr_b16 v[152:153], v10 offset:0
    ds_read_b64_tr_b16 v[154:155], v10 offset:2048
    ds_read_b128 v[156:159], v16 offset:0
    v_mfma_f32_16x16x32_bf16 v[48:51], v[132:135], v[140:143], v[48:51]
    ds_read_b64_tr_b16 v[176:177], v10 offset:4096
    ds_read_b64_tr_b16 v[178:179], v10 offset:6144
    s_add_u32 s77, s76, 1990656
    s_add_u32 m0, s79, 0
    s_nop 0
    buffer_load_dwordx4 v6, s[48:51], s77 offen lds
    v_mfma_f32_16x16x32_bf16 v[52:55], v[128:131], v[140:143], v[52:55]
    ds_read_b64_tr_b16 v[164:165], v11 offset:0
    ds_read_b64_tr_b16 v[166:167], v11 offset:2048
    s_waitcnt lgkmcnt(8)
    v_mfma_f32_16x16x32_bf16 v[56:59], v[120:123], v[136:139], v[56:59]
    ds_read_b64_tr_b16 v[160:161], v11 offset:4096
    ds_read_b64_tr_b16 v[162:163], v11 offset:6144
    v_mfma_f32_16x16x32_bf16 v[60:63], v[144:147], v[136:139], v[60:63]
    ds_read_b128 v[172:175], v16 offset:2048
    v_mfma_f32_16x16x32_bf16 v[64:67], v[132:135], v[136:139], v[64:67]
    s_waitcnt vmcnt(11)
    v_add_f32 v236, v236, v240
    s_add_u32 m0, s78, 15232
    s_nop 0
    buffer_load_dwordx4 v5, s[44:47], s72 offen offset:1152 lds
    v_mfma_f32_16x16x32_bf16 v[68:71], v[128:131], v[136:139], v[68:71]
    v_add_f32 v237, v237, v241
    s_waitcnt lgkmcnt(10)
    v_mfma_f32_16x16x32_bf16 v[72:75], v[120:123], v[148:151], v[72:75]
    v_add_f32 v238, v238, v242
    v_mfma_f32_16x16x32_bf16 v[76:79], v[144:147], v[148:151], v[76:79]
    ds_read_b128 v[168:171], v16 offset:4096
    v_add_f32 v239, v239, v243
    v_mfma_f32_16x16x32_bf16 v[80:83], v[132:135], v[148:151], v[80:83]
    v_add_f32 v244, v244, v248
    s_add_u32 m0, s78, 31616
    s_nop 0
    buffer_load_dwordx4 v5, s[44:47], s74 offen offset:1152 lds
    v_mfma_f32_16x16x32_bf16 v[84:87], v[128:131], v[148:151], v[84:87]
    v_add_f32 v245, v245, v249
    s_waitcnt lgkmcnt(8)
    v_mfma_f32_16x16x32_bf16 v[24:27], v[152:155], v[156:159], v[24:27]
    v_add_f32 v246, v246, v250
    s_waitcnt lgkmcnt(6)
    v_mfma_f32_16x16x32_bf16 v[28:31], v[176:179], v[156:159], v[28:31]
    ds_read_b128 v[180:183], v16 offset:6144
    v_add_f32 v247, v247, v251
    s_waitcnt lgkmcnt(5)
    v_mfma_f32_16x16x32_bf16 v[32:35], v[164:167], v[156:159], v[32:35]
    v_add_f32 v236, v236, v244
    v_add_f32 v237, v237, v245
    s_add_u32 m0, s79, 1024
    s_nop 0
    buffer_load_dwordx4 v7, s[48:51], s77 offen lds
    s_waitcnt lgkmcnt(3)
    v_mfma_f32_16x16x32_bf16 v[36:39], v[160:163], v[156:159], v[36:39]
    v_add_f32 v238, v238, v246
    s_waitcnt lgkmcnt(2)
    v_mfma_f32_16x16x32_bf16 v[40:43], v[152:155], v[172:175], v[40:43]
    v_add_f32 v239, v239, v247
    v_mfma_f32_16x16x32_bf16 v[44:47], v[176:179], v[172:175], v[44:47]
    ds_read_b64_tr_b16 v[92:93], v10 offset:8192
    ds_read_b64_tr_b16 v[94:95], v10 offset:10240
    ds_read_b128 v[108:111], v17 offset:0
    v_mov_b32 v240, v236
    v_mfma_f32_16x16x32_bf16 v[48:51], v[164:167], v[172:175], v[48:51]
    ds_read_b64_tr_b16 v[104:105], v10 offset:12288
    ds_read_b64_tr_b16 v[106:107], v10 offset:14336
    v_mov_b32 v241, v237
    s_add_u32 m0, s78, 23424
    s_nop 0
    buffer_load_dwordx4 v5, s[44:47], s73 offen offset:1152 lds
    v_mfma_f32_16x16x32_bf16 v[52:55], v[160:163], v[172:175], v[52:55]
    ds_read_b64_tr_b16 v[88:89], v11 offset:8192
    ds_read_b64_tr_b16 v[90:91], v11 offset:10240
    v_mov_b32 v242, v238
    s_waitcnt lgkmcnt(8)
    v_mfma_f32_16x16x32_bf16 v[56:59], v[152:155], v[168:171], v[56:59]
    ds_read_b64_tr_b16 v[112:113], v11 offset:12288
    ds_read_b64_tr_b16 v[114:115], v11 offset:14336
    v_mov_b32 v243, v239
    v_mfma_f32_16x16x32_bf16 v[60:63], v[176:179], v[168:171], v[60:63]
    ds_read_b128 v[100:103], v17 offset:2048
    v_permlane32_swap_b32 v236, v240
    v_mfma_f32_16x16x32_bf16 v[64:67], v[164:167], v[168:171], v[64:67]
    v_permlane32_swap_b32 v237, v241
    v_permlane32_swap_b32 v238, v242
    s_add_u32 m0, s78, 39808
    s_nop 0
    buffer_load_dwordx4 v5, s[44:47], s75 offen offset:1152 lds
    v_mfma_f32_16x16x32_bf16 v[68:71], v[160:163], v[168:171], v[68:71]
    v_permlane32_swap_b32 v239, v243
    s_waitcnt lgkmcnt(10)
    v_mfma_f32_16x16x32_bf16 v[72:75], v[152:155], v[180:183], v[72:75]
    v_add_f32 v236, v236, v240
    v_mfma_f32_16x16x32_bf16 v[76:79], v[176:179], v[180:183], v[76:79]
    ds_read_b128 v[96:99], v17 offset:4096
    v_add_f32 v237, v237, v241
    v_mfma_f32_16x16x32_bf16 v[80:83], v[164:167], v[180:183], v[80:83]
    v_add_f32 v238, v238, v242
    v_mfma_f32_16x16x32_bf16 v[84:87], v[160:163], v[180:183], v[84:87]
    v_add_f32 v239, v239, v243
    s_waitcnt lgkmcnt(8)
    v_mfma_f32_16x16x32_bf16 v[24:27], v[92:95], v[108:111], v[24:27]
    v_add_u32 v20, 155904, v4
    s_waitcnt lgkmcnt(6)
    v_mfma_f32_16x16x32_bf16 v[28:31], v[104:107], v[108:111], v[28:31]
    ds_read_b128 v[116:119], v17 offset:6144
    s_mov_b32 exec_lo, s80
    s_mov_b32 exec_hi, 0
    ds_write_b128 v20, v[236:239]
    s_mov_b64 exec, -1
    s_waitcnt lgkmcnt(6)
    v_mfma_f32_16x16x32_bf16 v[32:35], v[88:91], v[108:111], v[32:35]
    s_waitcnt lgkmcnt(4)
    v_mfma_f32_16x16x32_bf16 v[36:39], v[112:115], v[108:111], v[36:39]
    s_waitcnt lgkmcnt(3)
    v_mfma_f32_16x16x32_bf16 v[40:43], v[92:95], v[100:103], v[40:43]
    v_mfma_f32_16x16x32_bf16 v[44:47], v[104:107], v[100:103], v[44:47]
    s_waitcnt lgkmcnt(0)
    s_waitcnt vmcnt(10)
    s_barrier
    s_lshl_b32 s13, s8, 7
    s_add_u32 s13, s13, 155904
    v_lshl_add_u32 v20, v3, 4, s13
    ds_read_b128 v[184:187], v20 offset:0
    ds_read_b128 v[188:191], v20 offset:256
    ds_read_b128 v[192:195], v20 offset:64
    ds_read_b128 v[196:199], v20 offset:320
    ds_read_b64_tr_b16 v[124:125], v12 offset:0
    ds_read_b64_tr_b16 v[126:127], v12 offset:2048
    ds_read_b128 v[140:143], v18 offset:0
    v_mfma_f32_16x16x32_bf16 v[48:51], v[88:91], v[100:103], v[48:51]
    ds_read_b64_tr_b16 v[136:137], v12 offset:4096
    ds_read_b64_tr_b16 v[138:139], v12 offset:6144
    v_mfma_f32_16x16x32_bf16 v[52:55], v[112:115], v[100:103], v[52:55]
    ds_read_b64_tr_b16 v[120:121], v12 offset:8192
    ds_read_b64_tr_b16 v[122:123], v12 offset:10240
    ds_read_b128 v[144:147], v19 offset:0
    v_mfma_f32_16x16x32_bf16 v[56:59], v[92:95], v[96:99], v[56:59]
    ds_read_b64_tr_b16 v[132:133], v12 offset:12288
    ds_read_b64_tr_b16 v[134:135], v12 offset:14336
    s_mov_b32 s60, s24
    s_and_b32 s61, s25, 0xffff
    s_mov_b32 s62, 0x280000
    s_mov_b32 s63, 0x20000
    s_lshl_b32 s12, s5, 1
    s_add_u32 s12, s12, s3
    s_cmp_lt_u32 s3, 2
    s_cselect_b32 s12, s12, 999
    s_cmp_lt_u32 s12, 40
    s_cselect_b64 exec, -1, 0
    s_min_u32 s12, s12, 39
    s_mul_i32 s13, s12, 205
    s_lshr_b32 s13, s13, 11
    s_mul_i32 s14, s13, 30
    s_add_u32 s12, s12, s14
    s_add_u32 s13, s4, 0
    s_and_b32 s14, s13, 1
    s_mul_i32 s14, s14, 160
    s_add_u32 s12, s12, s14
    s_bfe_u32 s14, s13, 0x20001
    s_mul_i32 s14, s14, 10
    s_add_u32 s12, s12, s14
    s_lshl_b32 s12, s12, 13
    v_lshlrev_b32 v252, 7, v0
    buffer_load_dword v253, v252, s[60:63], s12 offen
    s_mov_b64 exec, -1
    v_mfma_f32_16x16x32_bf16 v[60:63], v[104:107], v[96:99], v[60:63]
    v_mfma_f32_16x16x32_bf16 v[64:67], v[88:91], v[96:99], v[64:67]
    s_getpc_b64 s[12:13]
Z1_PC3:
    s_add_u32 s12, s12, k2_kernel-Z1_PC3
    s_addc_u32 s13, s13, 0
    s_sub_u32 s14, s5, 20
    s_cmp_lt_u32 s14, 4
    s_cselect_b32 s15, s3, 99
    s_lshl_b32 s14, s14, 13
    v_lshl_add_u32 v254, v0, 7, s14
    v_min_u32 v254, K2_END-k2_kernel, v254
    s_cmp_eq_u32 s15, 0
    s_cselect_b64 exec, -1, 0
    global_load_dword v255, v254, s[12:13]
    s_mov_b64 exec, -1
    v_mfma_f32_16x16x32_bf16 v[68:71], v[112:115], v[96:99], v[68:71]
    v_mfma_f32_16x16x32_bf16 v[72:75], v[92:95], v[116:119], v[72:75]
    v_mov_b32 v232, -1
    v_mov_b32 v233, -1
    v_mov_b32 v234, -1
    v_mov_b32 v235, -1
    s_mul_i32 s71, s4, 27
    s_add_u32 s71, s71, s5
    s_lshl_b32 s71, s71, 2
    s_add_u32 s71, s71, s3
    s_mul_i32 s71, s71, 3
    s_add_u32 s12, s71, 0
    s_min_u32 s12, s12, 2559
    s_lshl_b32 s12, s12, 10
    s_add_u32 s12, s12, 0xc00000
    s_cmp_lt_u32 s3, 4
    s_cselect_b64 exec, -1, 0
    buffer_store_dwordx4 v[232:235], v4, s[52:55], s12 offen sc1
    s_mov_b64 exec, -1
    v_mfma_f32_16x16x32_bf16 v[76:79], v[104:107], v[116:119], v[76:79]
    v_mfma_f32_16x16x32_bf16 v[80:83], v[88:91], v[116:119], v[80:83]
    v_mfma_f32_16x16x32_bf16 v[84:87], v[112:115], v[116:119], v[84:87]
    s_add_u32 s12, s71, 1
    s_min_u32 s12, s12, 2559
    s_lshl_b32 s12, s12, 10
    s_add_u32 s12, s12, 0xc00000
    s_cmp_lt_u32 s3, 4
    s_cselect_b64 exec, -1, 0
    buffer_store_dwordx4 v[232:235], v4, s[52:55], s12 offen sc1
    s_mov_b64 exec, -1
    s_waitcnt lgkmcnt(7)
    v_mfma_f32_16x16x32_bf16 v[24:27], v[124:127], v[140:143], v[24:27]
    ds_read_b64_tr_b16 v[128:129], v13 offset:0
    ds_read_b64_tr_b16 v[130:131], v13 offset:2048
    ds_read_b64_tr_b16 v[148:149], v13 offset:4096
    ds_read_b64_tr_b16 v[150:151], v13 offset:6144
    ds_read_b64_tr_b16 v[156:157], v13 offset:8192
    ds_read_b64_tr_b16 v[158:159], v13 offset:10240
    s_waitcnt lgkmcnt(11)
    v_mfma_f32_16x16x32_bf16 v[28:31], v[136:139], v[140:143], v[28:31]
    ds_read_b64_tr_b16 v[172:173], v13 offset:12288
    ds_read_b64_tr_b16 v[174:175], v13 offset:14336
    s_waitcnt lgkmcnt(10)
    v_mfma_f32_16x16x32_bf16 v[24:27], v[120:123], v[144:147], v[24:27]
    ds_read_b128 v[168:171], v18 offset:2048
    ds_read_b128 v[152:155], v19 offset:2048
    s_waitcnt vmcnt(4)
    s_barrier
    ds_read_b64_tr_b16 v[176:177], v8 offset:0
    ds_read_b64_tr_b16 v[178:179], v8 offset:2048
    s_add_u32 s12, s71, 2
    s_min_u32 s12, s12, 2559
    s_lshl_b32 s12, s12, 10
    s_add_u32 s12, s12, 0xc00000
    s_cmp_lt_u32 s3, 4
    s_cselect_b64 exec, -1, 0
    buffer_store_dwordx4 v[232:235], v4, s[52:55], s12 offen sc1
    s_mov_b64 exec, -1
    s_waitcnt lgkmcnt(12)
    v_mfma_f32_16x16x32_bf16 v[28:31], v[132:135], v[144:147], v[28:31]
    ds_read_b128 v[164:167], v14 offset:0
    s_waitcnt lgkmcnt(11)
    v_mfma_f32_16x16x32_bf16 v[32:35], v[128:131], v[140:143], v[32:35]
    ds_read_b64_tr_b16 v[160:161], v8 offset:4096
    ds_read_b64_tr_b16 v[162:163], v8 offset:6144
    s_waitcnt lgkmcnt(11)
    v_mfma_f32_16x16x32_bf16 v[36:39], v[148:151], v[140:143], v[36:39]
    ds_read_b64_tr_b16 v[180:181], v8 offset:8192
    ds_read_b64_tr_b16 v[182:183], v8 offset:10240
    s_waitcnt lgkmcnt(11)
    v_mfma_f32_16x16x32_bf16 v[32:35], v[156:159], v[144:147], v[32:35]
    ds_read_b128 v[108:111], v15 offset:0
    ds_read_b64_tr_b16 v[100:101], v8 offset:12288
    ds_read_b64_tr_b16 v[102:103], v8 offset:14336
    s_waitcnt lgkmcnt(12)
    v_mfma_f32_16x16x32_bf16 v[36:39], v[172:175], v[144:147], v[36:39]
    ds_read_b64_tr_b16 v[96:97], v9 offset:0
    ds_read_b64_tr_b16 v[98:99], v9 offset:2048
    s_waitcnt lgkmcnt(13)
    v_mfma_f32_16x16x32_bf16 v[40:43], v[124:127], v[168:171], v[40:43]
    v_mfma_f32_16x16x32_bf16 v[44:47], v[136:139], v[168:171], v[44:47]
    s_waitcnt lgkmcnt(12)
    v_mfma_f32_16x16x32_bf16 v[40:43], v[120:123], v[152:155], v[40:43]
    ds_read_b64_tr_b16 v[92:93], v9 offset:4096
    ds_read_b64_tr_b16 v[94:95], v9 offset:6144
    v_mfma_f32_16x16x32_bf16 v[44:47], v[132:135], v[152:155], v[44:47]
    s_waitcnt lgkmcnt(11)
    v_mfma_f32_16x16x32_bf16 v[24:27], v[176:179], v[164:167], v[24:27]
    ds_read_b64_tr_b16 v[104:105], v9 offset:8192
    ds_read_b64_tr_b16 v[106:107], v9 offset:10240
    s_waitcnt lgkmcnt(11)
    v_mfma_f32_16x16x32_bf16 v[28:31], v[160:163], v[164:167], v[28:31]
    ds_read_b64_tr_b16 v[88:89], v9 offset:12288
    ds_read_b64_tr_b16 v[90:91], v9 offset:14336
    s_waitcnt lgkmcnt(10)
    v_mfma_f32_16x16x32_bf16 v[24:27], v[180:183], v[108:111], v[24:27]
    ds_read_b128 v[112:115], v14 offset:2048
    ds_read_b128 v[116:119], v15 offset:2048
    s_waitcnt lgkmcnt(10)
    v_mfma_f32_16x16x32_bf16 v[28:31], v[100:103], v[108:111], v[28:31]
    s_waitcnt lgkmcnt(8)
    v_mfma_f32_16x16x32_bf16 v[32:35], v[96:99], v[164:167], v[32:35]
    s_waitcnt lgkmcnt(6)
    v_mfma_f32_16x16x32_bf16 v[36:39], v[92:95], v[164:167], v[36:39]
    v_pk_fma_f32 v[24:25], v[200:201], v[184:185], v[24:25] op_sel_hi:[0,1,1]
    v_pk_fma_f32 v[26:27], v[200:201], v[186:187], v[26:27] op_sel_hi:[0,1,1]
    v_pk_mul_f32 v[216:217], v[24:25], v[24:25]
    v_pk_mul_f32 v[218:219], v[26:27], v[26:27]
    v_pk_fma_f32 v[28:29], v[200:201], v[188:189], v[28:29] op_sel_hi:[0,1,1]
    v_pk_fma_f32 v[216:217], v[216:217], v[200:201], v[202:203] op_sel:[0,1,0] op_sel_hi:[1,1,0]
    v_pk_fma_f32 v[218:219], v[218:219], v[200:201], v[202:203] op_sel:[0,1,0] op_sel_hi:[1,1,0]
    v_pk_fma_f32 v[30:31], v[200:201], v[190:191], v[30:31] op_sel_hi:[0,1,1]
    v_pk_mul_f32 v[216:217], v[216:217], v[24:25]
    v_pk_mul_f32 v[218:219], v[218:219], v[26:27]
    v_exp_f32 v216, v216
    s_waitcnt lgkmcnt(4)
    v_mfma_f32_16x16x32_bf16 v[32:35], v[104:107], v[108:111], v[32:35]
    v_exp_f32 v217, v217
    v_pk_mul_f32 v[24:25], v[24:25], v[28:29]
    v_exp_f32 v218, v218
    v_exp_f32 v219, v219
    v_pk_fma_f32 v[216:217], v[216:217], v[202:203], v[202:203] op_sel:[0,1,1] op_sel_hi:[1,1,1]
    v_pk_mul_f32 v[26:27], v[26:27], v[30:31]
    v_pk_fma_f32 v[218:219], v[218:219], v[202:203], v[202:203] op_sel:[0,1,1] op_sel_hi:[1,1,1]
    v_rcp_f32 v216, v216
    v_rcp_f32 v217, v217
    v_rcp_f32 v218, v218
    v_rcp_f32 v219, v219
    v_pk_mul_f32 v[24:25], v[24:25], v[216:217]
    s_waitcnt lgkmcnt(2)
    v_mfma_f32_16x16x32_bf16 v[36:39], v[88:91], v[108:111], v[36:39]
    v_pk_mul_f32 v[26:27], v[26:27], v[218:219]
    v_cvt_pk_bf16_f32 v224, v24, v25
    v_cvt_pk_bf16_f32 v225, v26, v27
    s_waitcnt lgkmcnt(1)
    v_mfma_f32_16x16x32_bf16 v[40:43], v[176:179], v[112:115], v[40:43]
    v_mfma_f32_16x16x32_bf16 v[44:47], v[160:163], v[112:115], v[44:47]
    ds_read_b128 v[140:143], v18 offset:4096
    v_pk_fma_f32 v[32:33], v[200:201], v[192:193], v[32:33] op_sel_hi:[0,1,1]
    v_pk_fma_f32 v[34:35], v[200:201], v[194:195], v[34:35] op_sel_hi:[0,1,1]
    v_pk_mul_f32 v[220:221], v[32:33], v[32:33]
    v_pk_mul_f32 v[222:223], v[34:35], v[34:35]
    v_pk_fma_f32 v[36:37], v[200:201], v[196:197], v[36:37] op_sel_hi:[0,1,1]
    v_pk_fma_f32 v[220:221], v[220:221], v[200:201], v[202:203] op_sel:[0,1,0] op_sel_hi:[1,1,0]
    v_pk_fma_f32 v[222:223], v[222:223], v[200:201], v[202:203] op_sel:[0,1,0] op_sel_hi:[1,1,0]
    v_pk_fma_f32 v[38:39], v[200:201], v[198:199], v[38:39] op_sel_hi:[0,1,1]
    v_pk_mul_f32 v[220:221], v[220:221], v[32:33]
    v_pk_mul_f32 v[222:223], v[222:223], v[34:35]
    v_exp_f32 v220, v220
    s_waitcnt lgkmcnt(1)
    v_mfma_f32_16x16x32_bf16 v[40:43], v[180:183], v[116:119], v[40:43]
    v_exp_f32 v221, v221
    v_pk_mul_f32 v[32:33], v[32:33], v[36:37]
    v_exp_f32 v222, v222
    v_exp_f32 v223, v223
    v_pk_fma_f32 v[220:221], v[220:221], v[202:203], v[202:203] op_sel:[0,1,1] op_sel_hi:[1,1,1]
    v_pk_mul_f32 v[34:35], v[34:35], v[38:39]
    v_pk_fma_f32 v[222:223], v[222:223], v[202:203], v[202:203] op_sel:[0,1,1] op_sel_hi:[1,1,1]
    v_rcp_f32 v220, v220
    v_rcp_f32 v221, v221
    v_rcp_f32 v222, v222
    v_rcp_f32 v223, v223
    v_pk_mul_f32 v[32:33], v[32:33], v[220:221]
    v_mfma_f32_16x16x32_bf16 v[44:47], v[100:103], v[116:119], v[44:47]
    ds_read_b128 v[144:147], v19 offset:4096
    v_pk_mul_f32 v[34:35], v[34:35], v[222:223]
    v_cvt_pk_bf16_f32 v226, v32, v33
    v_cvt_pk_bf16_f32 v227, v34, v35
    buffer_store_dwordx4 v[224:227], v4, s[52:55], s82 offen sc1
    s_add_u32 s82, s82, 55296
    v_mfma_f32_16x16x32_bf16 v[48:51], v[128:131], v[168:171], v[48:51]
    v_mfma_f32_16x16x32_bf16 v[52:55], v[148:151], v[168:171], v[52:55]
    ds_read_b128 v[164:167], v14 offset:4096
    v_pk_fma_f32 v[40:41], v[204:205], v[184:185], v[40:41] op_sel_hi:[0,1,1]
    v_pk_fma_f32 v[42:43], v[204:205], v[186:187], v[42:43] op_sel_hi:[0,1,1]
    v_pk_mul_f32 v[216:217], v[40:41], v[40:41]
    v_pk_mul_f32 v[218:219], v[42:43], v[42:43]
    v_pk_fma_f32 v[44:45], v[204:205], v[188:189], v[44:45] op_sel_hi:[0,1,1]
    v_pk_fma_f32 v[216:217], v[216:217], v[204:205], v[206:207] op_sel:[0,1,0] op_sel_hi:[1,1,0]
    v_pk_fma_f32 v[218:219], v[218:219], v[204:205], v[206:207] op_sel:[0,1,0] op_sel_hi:[1,1,0]
    v_pk_fma_f32 v[46:47], v[204:205], v[190:191], v[46:47] op_sel_hi:[0,1,1]
    v_pk_mul_f32 v[216:217], v[216:217], v[40:41]
    v_pk_mul_f32 v[218:219], v[218:219], v[42:43]
    v_exp_f32 v216, v216
    v_mfma_f32_16x16x32_bf16 v[48:51], v[156:159], v[152:155], v[48:51]
    v_exp_f32 v217, v217
    v_pk_mul_f32 v[40:41], v[40:41], v[44:45]
    v_exp_f32 v218, v218
    v_exp_f32 v219, v219
    v_pk_fma_f32 v[216:217], v[216:217], v[206:207], v[206:207] op_sel:[0,1,1] op_sel_hi:[1,1,1]
    v_pk_mul_f32 v[42:43], v[42:43], v[46:47]
    v_pk_fma_f32 v[218:219], v[218:219], v[206:207], v[206:207] op_sel:[0,1,1] op_sel_hi:[1,1,1]
    v_rcp_f32 v216, v216
    v_rcp_f32 v217, v217
    v_rcp_f32 v218, v218
    v_rcp_f32 v219, v219
    v_pk_mul_f32 v[40:41], v[40:41], v[216:217]
    v_mfma_f32_16x16x32_bf16 v[52:55], v[172:175], v[152:155], v[52:55]
    ds_read_b128 v[108:111], v15 offset:4096
    v_pk_mul_f32 v[42:43], v[42:43], v[218:219]
    v_cvt_pk_bf16_f32 v228, v40, v41
    v_cvt_pk_bf16_f32 v229, v42, v43
    v_mfma_f32_16x16x32_bf16 v[48:51], v[96:99], v[112:115], v[48:51]
    v_mfma_f32_16x16x32_bf16 v[52:55], v[92:95], v[112:115], v[52:55]
    v_mfma_f32_16x16x32_bf16 v[48:51], v[104:107], v[116:119], v[48:51]
    v_mfma_f32_16x16x32_bf16 v[52:55], v[88:91], v[116:119], v[52:55]
    s_waitcnt lgkmcnt(3)
    v_mfma_f32_16x16x32_bf16 v[56:59], v[124:127], v[140:143], v[56:59]
    v_mfma_f32_16x16x32_bf16 v[60:63], v[136:139], v[140:143], v[60:63]
    s_nop 3
    v_pk_fma_f32 v[48:49], v[204:205], v[192:193], v[48:49] op_sel_hi:[0,1,1]
    v_pk_fma_f32 v[50:51], v[204:205], v[194:195], v[50:51] op_sel_hi:[0,1,1]
    v_pk_mul_f32 v[220:221], v[48:49], v[48:49]
    v_pk_mul_f32 v[222:223], v[50:51], v[50:51]
    v_pk_fma_f32 v[52:53], v[204:205], v[196:197], v[52:53] op_sel_hi:[0,1,1]
    v_pk_fma_f32 v[220:221], v[220:221], v[204:205], v[206:207] op_sel:[0,1,0] op_sel_hi:[1,1,0]
    v_pk_fma_f32 v[222:223], v[222:223], v[204:205], v[206:207] op_sel:[0,1,0] op_sel_hi:[1,1,0]
    v_pk_fma_f32 v[54:55], v[204:205], v[198:199], v[54:55] op_sel_hi:[0,1,1]
    v_pk_mul_f32 v[220:221], v[220:221], v[48:49]
    v_pk_mul_f32 v[222:223], v[222:223], v[50:51]
    v_exp_f32 v220, v220
    s_waitcnt lgkmcnt(2)
    v_mfma_f32_16x16x32_bf16 v[56:59], v[120:123], v[144:147], v[56:59]
    v_exp_f32 v221, v221
    v_pk_mul_f32 v[48:49], v[48:49], v[52:53]
    v_exp_f32 v222, v222
    v_exp_f32 v223, v223
    v_pk_fma_f32 v[220:221], v[220:221], v[206:207], v[206:207] op_sel:[0,1,1] op_sel_hi:[1,1,1]
    v_pk_mul_f32 v[50:51], v[50:51], v[54:55]
    v_pk_fma_f32 v[222:223], v[222:223], v[206:207], v[206:207] op_sel:[0,1,1] op_sel_hi:[1,1,1]
    v_rcp_f32 v220, v220
    v_rcp_f32 v221, v221
    v_rcp_f32 v222, v222
    v_rcp_f32 v223, v223
    v_pk_mul_f32 v[48:49], v[48:49], v[220:221]
    v_mfma_f32_16x16x32_bf16 v[60:63], v[132:135], v[144:147], v[60:63]
    v_pk_mul_f32 v[50:51], v[50:51], v[222:223]
    v_cvt_pk_bf16_f32 v230, v48, v49
    v_cvt_pk_bf16_f32 v231, v50, v51
    buffer_store_dwordx4 v[228:231], v4, s[52:55], s82 offen sc1
    s_add_u32 s82, s82, 55296
    s_waitcnt lgkmcnt(1)
    v_mfma_f32_16x16x32_bf16 v[56:59], v[176:179], v[164:167], v[56:59]
    v_mfma_f32_16x16x32_bf16 v[60:63], v[160:163], v[164:167], v[60:63]
    ds_read_b128 v[168:171], v18 offset:6144
    s_waitcnt lgkmcnt(1)
    v_mfma_f32_16x16x32_bf16 v[56:59], v[180:183], v[108:111], v[56:59]
    v_mfma_f32_16x16x32_bf16 v[60:63], v[100:103], v[108:111], v[60:63]
    ds_read_b128 v[152:155], v19 offset:6144
    v_mfma_f32_16x16x32_bf16 v[64:67], v[128:131], v[140:143], v[64:67]
    v_mfma_f32_16x16x32_bf16 v[68:71], v[148:151], v[140:143], v[68:71]
    ds_read_b128 v[112:115], v14 offset:6144
    s_nop 2
    v_pk_fma_f32 v[56:57], v[208:209], v[184:185], v[56:57] op_sel_hi:[0,1,1]
    v_pk_fma_f32 v[58:59], v[208:209], v[186:187], v[58:59] op_sel_hi:[0,1,1]
    v_pk_mul_f32 v[216:217], v[56:57], v[56:57]
    v_pk_mul_f32 v[218:219], v[58:59], v[58:59]
    v_pk_fma_f32 v[60:61], v[208:209], v[188:189], v[60:61] op_sel_hi:[0,1,1]
    v_pk_fma_f32 v[216:217], v[216:217], v[208:209], v[210:211] op_sel:[0,1,0] op_sel_hi:[1,1,0]
    v_pk_fma_f32 v[218:219], v[218:219], v[208:209], v[210:211] op_sel:[0,1,0] op_sel_hi:[1,1,0]
    v_pk_fma_f32 v[62:63], v[208:209], v[190:191], v[62:63] op_sel_hi:[0,1,1]
    v_pk_mul_f32 v[216:217], v[216:217], v[56:57]
    v_pk_mul_f32 v[218:219], v[218:219], v[58:59]
    v_exp_f32 v216, v216
    v_mfma_f32_16x16x32_bf16 v[64:67], v[156:159], v[144:147], v[64:67]
    v_exp_f32 v217, v217
    v_pk_mul_f32 v[56:57], v[56:57], v[60:61]
    v_exp_f32 v218, v218
    v_exp_f32 v219, v219
    v_pk_fma_f32 v[216:217], v[216:217], v[210:211], v[210:211] op_sel:[0,1,1] op_sel_hi:[1,1,1]
    v_pk_mul_f32 v[58:59], v[58:59], v[62:63]
    v_pk_fma_f32 v[218:219], v[218:219], v[210:211], v[210:211] op_sel:[0,1,1] op_sel_hi:[1,1,1]
    v_rcp_f32 v216, v216
    v_rcp_f32 v217, v217
    v_rcp_f32 v218, v218
    v_rcp_f32 v219, v219
    v_pk_mul_f32 v[56:57], v[56:57], v[216:217]
    v_mfma_f32_16x16x32_bf16 v[68:71], v[172:175], v[144:147], v[68:71]
    ds_read_b128 v[116:119], v15 offset:6144
    v_pk_mul_f32 v[58:59], v[58:59], v[218:219]
    v_cvt_pk_bf16_f32 v224, v56, v57
    v_cvt_pk_bf16_f32 v225, v58, v59
    v_mfma_f32_16x16x32_bf16 v[64:67], v[96:99], v[164:167], v[64:67]
    v_mfma_f32_16x16x32_bf16 v[68:71], v[92:95], v[164:167], v[68:71]
    v_mfma_f32_16x16x32_bf16 v[64:67], v[104:107], v[108:111], v[64:67]
    v_mfma_f32_16x16x32_bf16 v[68:71], v[88:91], v[108:111], v[68:71]
    s_waitcnt lgkmcnt(3)
    v_mfma_f32_16x16x32_bf16 v[72:75], v[124:127], v[168:171], v[72:75]
    v_mfma_f32_16x16x32_bf16 v[76:79], v[136:139], v[168:171], v[76:79]
    s_nop 3
    v_pk_fma_f32 v[64:65], v[208:209], v[192:193], v[64:65] op_sel_hi:[0,1,1]
    v_pk_fma_f32 v[66:67], v[208:209], v[194:195], v[66:67] op_sel_hi:[0,1,1]
    v_pk_mul_f32 v[220:221], v[64:65], v[64:65]
    v_pk_mul_f32 v[222:223], v[66:67], v[66:67]
    v_pk_fma_f32 v[68:69], v[208:209], v[196:197], v[68:69] op_sel_hi:[0,1,1]
    v_pk_fma_f32 v[220:221], v[220:221], v[208:209], v[210:211] op_sel:[0,1,0] op_sel_hi:[1,1,0]
    v_pk_fma_f32 v[222:223], v[222:223], v[208:209], v[210:211] op_sel:[0,1,0] op_sel_hi:[1,1,0]
    v_pk_fma_f32 v[70:71], v[208:209], v[198:199], v[70:71] op_sel_hi:[0,1,1]
    v_pk_mul_f32 v[220:221], v[220:221], v[64:65]
    v_pk_mul_f32 v[222:223], v[222:223], v[66:67]
    v_exp_f32 v220, v220
    s_waitcnt lgkmcnt(2)
    v_mfma_f32_16x16x32_bf16 v[72:75], v[120:123], v[152:155], v[72:75]
    v_exp_f32 v221, v221
    v_pk_mul_f32 v[64:65], v[64:65], v[68:69]
    v_exp_f32 v222, v222
    v_exp_f32 v223, v223
    v_pk_fma_f32 v[220:221], v[220:221], v[210:211], v[210:211] op_sel:[0,1,1] op_sel_hi:[1,1,1]
    v_pk_mul_f32 v[66:67], v[66:67], v[70:71]
    v_pk_fma_f32 v[222:223], v[222:223], v[210:211], v[210:211] op_sel:[0,1,1] op_sel_hi:[1,1,1]
    v_rcp_f32 v220, v220
    v_rcp_f32 v221, v221
    v_rcp_f32 v222, v222
    v_rcp_f32 v223, v223
    v_pk_mul_f32 v[64:65], v[64:65], v[220:221]
    v_mfma_f32_16x16x32_bf16 v[76:79], v[132:135], v[152:155], v[76:79]
    v_pk_mul_f32 v[66:67], v[66:67], v[222:223]
    v_cvt_pk_bf16_f32 v226, v64, v65
    v_cvt_pk_bf16_f32 v227, v66, v67
    buffer_store_dwordx4 v[224:227], v4, s[52:55], s82 offen sc1
    s_add_u32 s82, s82, 55296
    s_waitcnt lgkmcnt(1)
    v_mfma_f32_16x16x32_bf16 v[72:75], v[176:179], v[112:115], v[72:75]
    v_mfma_f32_16x16x32_bf16 v[76:79], v[160:163], v[112:115], v[76:79]
    s_waitcnt lgkmcnt(0)
    v_mfma_f32_16x16x32_bf16 v[72:75], v[180:183], v[116:119], v[72:75]
    v_mfma_f32_16x16x32_bf16 v[76:79], v[100:103], v[116:119], v[76:79]
    v_mfma_f32_16x16x32_bf16 v[80:83], v[128:131], v[168:171], v[80:83]
    v_mfma_f32_16x16x32_bf16 v[84:87], v[148:151], v[168:171], v[84:87]
    s_nop 4
    v_pk_fma_f32 v[72:73], v[212:213], v[184:185], v[72:73] op_sel_hi:[0,1,1]
    v_pk_fma_f32 v[74:75], v[212:213], v[186:187], v[74:75] op_sel_hi:[0,1,1]
    v_pk_mul_f32 v[216:217], v[72:73], v[72:73]
    v_pk_mul_f32 v[218:219], v[74:75], v[74:75]
    v_pk_fma_f32 v[76:77], v[212:213], v[188:189], v[76:77] op_sel_hi:[0,1,1]
    v_pk_fma_f32 v[216:217], v[216:217], v[212:213], v[214:215] op_sel:[0,1,0] op_sel_hi:[1,1,0]
    v_pk_fma_f32 v[218:219], v[218:219], v[212:213], v[214:215] op_sel:[0,1,0] op_sel_hi:[1,1,0]
    v_pk_fma_f32 v[78:79], v[212:213], v[190:191], v[78:79] op_sel_hi:[0,1,1]
    v_pk_mul_f32 v[216:217], v[216:217], v[72:73]
    v_pk_mul_f32 v[218:219], v[218:219], v[74:75]
    v_exp_f32 v216, v216
    v_mfma_f32_16x16x32_bf16 v[80:83], v[156:159], v[152:155], v[80:83]
    v_exp_f32 v217, v217
    v_pk_mul_f32 v[72:73], v[72:73], v[76:77]
    v_exp_f32 v218, v218
    v_exp_f32 v219, v219
    v_pk_fma_f32 v[216:217], v[216:217], v[214:215], v[214:215] op_sel:[0,1,1] op_sel_hi:[1,1,1]
    v_pk_mul_f32 v[74:75], v[74:75], v[78:79]
    v_pk_fma_f32 v[218:219], v[218:219], v[214:215], v[214:215] op_sel:[0,1,1] op_sel_hi:[1,1,1]
    v_rcp_f32 v216, v216
    v_rcp_f32 v217, v217
    v_rcp_f32 v218, v218
    v_rcp_f32 v219, v219
    v_pk_mul_f32 v[72:73], v[72:73], v[216:217]
    v_mfma_f32_16x16x32_bf16 v[84:87], v[172:175], v[152:155], v[84:87]
    v_pk_mul_f32 v[74:75], v[74:75], v[218:219]
    v_cvt_pk_bf16_f32 v228, v72, v73
    v_cvt_pk_bf16_f32 v229, v74, v75
    v_mfma_f32_16x16x32_bf16 v[80:83], v[96:99], v[112:115], v[80:83]
    v_mfma_f32_16x16x32_bf16 v[84:87], v[92:95], v[112:115], v[84:87]
    v_mfma_f32_16x16x32_bf16 v[80:83], v[104:107], v[116:119], v[80:83]
    v_mfma_f32_16x16x32_bf16 v[84:87], v[88:91], v[116:119], v[84:87]
    s_nop 6
    v_pk_fma_f32 v[80:81], v[212:213], v[192:193], v[80:81] op_sel_hi:[0,1,1]
    v_pk_fma_f32 v[82:83], v[212:213], v[194:195], v[82:83] op_sel_hi:[0,1,1]
    v_pk_mul_f32 v[220:221], v[80:81], v[80:81]
    v_pk_mul_f32 v[222:223], v[82:83], v[82:83]
    v_pk_fma_f32 v[84:85], v[212:213], v[196:197], v[84:85] op_sel_hi:[0,1,1]
    v_pk_fma_f32 v[220:221], v[220:221], v[212:213], v[214:215] op_sel:[0,1,0] op_sel_hi:[1,1,0]
    v_pk_fma_f32 v[222:223], v[222:223], v[212:213], v[214:215] op_sel:[0,1,0] op_sel_hi:[1,1,0]
    v_pk_fma_f32 v[86:87], v[212:213], v[198:199], v[86:87] op_sel_hi:[0,1,1]
    v_pk_mul_f32 v[220:221], v[220:221], v[80:81]
    v_pk_mul_f32 v[222:223], v[222:223], v[82:83]
    v_exp_f32 v220, v220
    v_exp_f32 v221, v221
    v_pk_mul_f32 v[80:81], v[80:81], v[84:85]
    v_exp_f32 v222, v222
    v_exp_f32 v223, v223
    v_pk_fma_f32 v[220:221], v[220:221], v[214:215], v[214:215] op_sel:[0,1,1] op_sel_hi:[1,1,1]
    v_pk_mul_f32 v[82:83], v[82:83], v[86:87]
    v_pk_fma_f32 v[222:223], v[222:223], v[214:215], v[214:215] op_sel:[0,1,1] op_sel_hi:[1,1,1]
    v_rcp_f32 v220, v220
    v_rcp_f32 v221, v221
    v_rcp_f32 v222, v222
    v_rcp_f32 v223, v223
    v_pk_mul_f32 v[80:81], v[80:81], v[220:221]
    v_pk_mul_f32 v[82:83], v[82:83], v[222:223]
    v_cvt_pk_bf16_f32 v230, v80, v81
    v_cvt_pk_bf16_f32 v231, v82, v83
    buffer_store_dwordx4 v[228:231], v4, s[52:55], s82 offen sc1
    s_endpgm
Z1_SPARE:
    s_sub_u32 s6, s5, 27
    s_mul_i32 s8, s4, 5
    s_add_u32 s8, s8, s6
    s_lshl_b32 s9, s8, 3
    s_add_u32 s9, s9, s3
    v_lshrrev_b32 v2, 3, v0
    v_and_b32 v3, 7, v0
    v_mul_u32_u24 v1, 0x500, v2
    v_lshl_add_u32 v1, v3, 4, v1
    s_lshl_b32 s80, s3, 13
    s_add_u32 s80, s80, 16384
    s_mul_hi_u32 s10, s8, 0x1999999a
    s_mul_i32 s11, s10, 10
    s_sub_u32 s11, s8, s11
    s_lshl_b32 s10, s10, 9
    s_lshl_b32 s12, s3, 6
    s_add_u32 s10, s10, s12
    v_lshl_add_u32 v12, v2, 3, s10
    v_mul_u32_u24 v5, 0x500, v12
    v_lshl_add_u32 v5, v3, 4, v5
    s_lshl_b32 s12, s11, 7
    v_add_u32 v5, s12, v5
    v_lshlrev_b32 v14, 15, v3
    s_lshl_b32 s12, s11, 18
    s_add_u32 s12, s12, 0x940ff0
    v_add_u32 v14, s12, v14
    v_lshlrev_b32 v12, 1, v12
    v_sub_u32 v14, v14, v12
    v_lshlrev_b32 v15, 6, v3
    s_lshl_b32 s12, s11, 9
    v_add_u32 v15, s12, v15
    v_mov_b32 v236, 0
    v_mov_b32 v237, 0
    v_mov_b32 v238, 0
    v_mov_b32 v239, 0
    s_waitcnt lgkmcnt(0)
    s_mov_b32 s44, s16
    s_and_b32 s45, s17, 0xffff
    s_mov_b32 s46, 0x280000
    s_mov_b32 s47, 0x20000
    s_add_u32 s12, s42, s3
    s_mul_i32 s12, s12, 1280
    buffer_load_dwordx4 v[232:235], v4, s[44:47], s12 offen
    s_mov_b64 exec, 0xffff
    buffer_load_dwordx4 v[236:239], v4, s[44:47], s12 offen offset:1024
    s_mov_b64 exec, -1
    s_mov_b32 s60, s18
    s_and_b32 s61, s19, 0xffff
    s_mov_b32 s62, 0x280000
    s_mov_b32 s63, 0x20000
    s_mov_b32 s64, s20
    s_and_b32 s65, s21, 0xffff
    s_mov_b32 s66, 0x280000
    s_mov_b32 s67, 0x20000
    s_mov_b32 s68, s22
    s_and_b32 s69, s23, 0xffff
    s_mov_b32 s70, 0x1400
    s_mov_b32 s71, 0x20000
    buffer_load_dwordx4 v[108:111], v15, s[68:71], 0 offen offset:0
    buffer_load_dwordx4 v[112:115], v15, s[68:71], 0 offen offset:16
    buffer_load_dwordx4 v[116:119], v15, s[68:71], 0 offen offset:32
    buffer_load_dwordx4 v[120:123], v15, s[68:71], 0 offen offset:48
    s_mov_b32 s52, s40
    s_and_b32 s53, s41, 0xffff
    s_mov_b32 s54, 0x1000000
    s_mov_b32 s55, 0x20000
    s_mov_b32 s56, s38
    s_and_b32 s57, s39, 0xffff
    s_mov_b32 s58, 0x100
    s_mov_b32 s59, 0x20000
    s_waitcnt vmcnt(4)
    s_mov_b32 s43, 0x3f803f80
    v_mov_b32 v244, 0
    v_mov_b32 v245, 0
    v_dot2c_f32_bf16 v244, s43, v232
    v_dot2c_f32_bf16 v245, v232, v232
    v_dot2c_f32_bf16 v244, s43, v233
    v_dot2c_f32_bf16 v245, v233, v233
    v_dot2c_f32_bf16 v244, s43, v234
    v_dot2c_f32_bf16 v245, v234, v234
    v_dot2c_f32_bf16 v244, s43, v235
    v_dot2c_f32_bf16 v245, v235, v235
    v_dot2c_f32_bf16 v244, s43, v236
    v_dot2c_f32_bf16 v245, v236, v236
    v_dot2c_f32_bf16 v244, s43, v237
    v_dot2c_f32_bf16 v245, v237, v237
    v_dot2c_f32_bf16 v244, s43, v238
    v_dot2c_f32_bf16 v245, v238, v238
    v_dot2c_f32_bf16 v244, s43, v239
    v_dot2c_f32_bf16 v245, v239, v239
    s_nop 2
    v_add_f32_dpp v244, v244, v244 quad_perm:[1,0,3,2] row_mask:0xf bank_mask:0xf
    v_add_f32_dpp v245, v245, v245 quad_perm:[1,0,3,2] row_mask:0xf bank_mask:0xf
    s_nop 0
    v_add_f32_dpp v244, v244, v244 quad_perm:[2,3,0,1] row_mask:0xf bank_mask:0xf
    v_add_f32_dpp v245, v245, v245 quad_perm:[2,3,0,1] row_mask:0xf bank_mask:0xf
    s_nop 0
    v_add_f32_dpp v244, v244, v244 row_half_mirror row_mask:0xf bank_mask:0xf
    v_add_f32_dpp v245, v245, v245 row_half_mirror row_mask:0xf bank_mask:0xf
    s_nop 0
    v_add_f32_dpp v244, v244, v244 row_mirror row_mask:0xf bank_mask:0xf
    v_add_f32_dpp v245, v245, v245 row_mirror row_mask:0xf bank_mask:0xf
    s_nop 0
    v_add_f32_dpp v244, v244, v244 row_bcast:15 row_mask:0xa bank_mask:0xf
    v_add_f32_dpp v245, v245, v245 row_bcast:15 row_mask:0xa bank_mask:0xf
    s_nop 0
    v_add_f32_dpp v244, v244, v244 row_bcast:31 row_mask:0xc bank_mask:0xf
    v_add_f32_dpp v245, v245, v245 row_bcast:31 row_mask:0xc bank_mask:0xf
    v_mul_f32 v244, 0x3acccccd, v244
    v_mul_f32 v245, 0x3acccccd, v245
    v_fma_f32 v245, -v244, v244, v245
    v_max_f32 v245, 0, v245
    v_cvt_pk_bf16_f32 v244, v244, v245
    v_and_b32 v245, 0xffff0000, v244
    v_add_f32 v245, 0x3727c5ac, v245
    v_cvt_pk_bf16_f32 v245, v245, v245
    v_and_b32 v245, 0xffff0000, v245
    v_sqrt_f32 v245, v245
    v_lshlrev_b32 v244, 16, v244
    v_cvt_pk_bf16_f32 v245, v245, v245
    v_and_b32 v245, 0xffff0000, v245
    v_rcp_f32 v242, v245
    v_mul_f32 v243, v245, v245
    v_sub_f32 v240, 0, v244
    v_mul_f32 v241, v242, v242
    v_mul_f32 v242, 0xc0135761, v242
    v_mul_f32 v241, 0x3d372713, v241
    v_mul_f32 v241, v241, v242
    s_lshl_b32 s13, s3, 3
    s_add_u32 s14, s13, 128
    s_lshl_b32 s13, s13, 1
    s_add_u32 s13, s13, 0
    v_mov_b32 v246, s13
    v_mov_b32 v247, s14
    s_mov_b32 exec_lo, 0
    s_mov_b32 exec_hi, 0x80000000
    ds_write_b128 v246, v[240:243]
    ds_write_b64 v247, v[244:245]
    s_mov_b64 exec, -1
    s_waitcnt lgkmcnt(0)
    s_barrier
    v_add_u32 v247, 0, v4
    ds_read_b128 v[240:243], v247
    v_lshrrev_b32 v246, 1, v4
    v_add_u32 v247, 128, v246
    ds_read_b64 v[244:245], v247
    s_waitcnt lgkmcnt(0)
    s_lshl_b32 s13, s42, 4
    s_add_u32 s13, s13, 0xf20000
    s_lshl_b32 s14, s42, 3
    s_add_u32 s14, s14, 0xf00000
    s_cmp_eq_u32 s3, 0
    s_cselect_b64 exec, 0xff, 0
    buffer_store_dwordx4 v[240:243], v4, s[52:55], s13 offen sc1
    buffer_store_dwordx2 v[244:245], v246, s[52:55], s14 offen sc1
    s_mov_b64 exec, -1
    v_add_u32 v6, 0xfffff100, v5
    buffer_load_dwordx4 v[148:151], v6, s[60:63], 0 offen
    v_add_u32 v7, 0xfffff600, v5
    buffer_load_dwordx4 v[152:155], v7, s[60:63], 0 offen
    v_add_u32 v6, 0xfffffb00, v5
    buffer_load_dwordx4 v[156:159], v6, s[60:63], 0 offen
    v_add_u32 v7, 0x0, v5
    buffer_load_dwordx4 v[160:163], v7, s[60:63], 0 offen
    v_add_u32 v6, 0x500, v5
    buffer_load_dwordx4 v[164:167], v6, s[60:63], 0 offen
    v_add_u32 v7, 0xa00, v5
    buffer_load_dwordx4 v[168:171], v7, s[60:63], 0 offen
    v_add_u32 v6, 0xf00, v5
    buffer_load_dwordx4 v[172:175], v6, s[60:63], 0 offen
    v_add_u32 v7, 0x1400, v5
    buffer_load_dwordx4 v[176:179], v7, s[60:63], 0 offen
    v_add_u32 v6, 0x1900, v5
    buffer_load_dwordx4 v[180:183], v6, s[60:63], 0 offen
    v_add_u32 v7, 0x1e00, v5
    buffer_load_dwordx4 v[184:187], v7, s[60:63], 0 offen
    v_add_u32 v6, 0x2300, v5
    buffer_load_dwordx4 v[188:191], v6, s[60:63], 0 offen
    v_add_u32 v7, 0x0, v5
    buffer_load_dwordx4 v[192:195], v7, s[64:67], 0 offen
    v_add_u32 v6, 0x500, v5
    buffer_load_dwordx4 v[196:199], v6, s[64:67], 0 offen
    v_add_u32 v7, 0xa00, v5
    buffer_load_dwordx4 v[200:203], v7, s[64:67], 0 offen
    v_add_u32 v6, 0xf00, v5
    buffer_load_dwordx4 v[204:207], v6, s[64:67], 0 offen
    v_add_u32 v7, 0x1400, v5
    buffer_load_dwordx4 v[208:211], v7, s[64:67], 0 offen
    v_add_u32 v6, 0x1900, v5
    buffer_load_dwordx4 v[212:215], v6, s[64:67], 0 offen
    v_add_u32 v7, 0x1e00, v5
    buffer_load_dwordx4 v[216:219], v7, s[64:67], 0 offen
    v_add_u32 v6, 0x2300, v5
    buffer_load_dwordx4 v[220:223], v6, s[64:67], 0 offen
    s_mov_b32 s68, s34
    s_and_b32 s69, s35, 0xffff
    s_mov_b32 s70, 0x21c000
    s_mov_b32 s71, 0x20000
    s_waitcnt vmcnt(19)
    s_and_b32 s13, s5, 3
    s_lshl_b32 s13, s13, 6
    v_mov_b32 v8, 1
    s_cmp_eq_u32 s3, 0
    s_cselect_b64 exec, 1, 0
    buffer_atomic_add v8, off, s[56:59], s13
    s_mov_b64 exec, -1
    s_waitcnt vmcnt(1)
    v_lshlrev_b32 v36, 16, v108
    v_and_b32 v37, 0xffff0000, v108
    v_lshlrev_b32 v38, 16, v109
    v_and_b32 v39, 0xffff0000, v109
    v_lshlrev_b32 v16, 16, v148
    v_lshlrev_b32 v17, 16, v152
    v_lshlrev_b32 v18, 16, v156
    v_lshlrev_b32 v19, 16, v160
    v_lshlrev_b32 v20, 16, v164
    v_lshlrev_b32 v21, 16, v168
    v_lshlrev_b32 v22, 16, v172
    v_lshlrev_b32 v23, 16, v176
    v_lshlrev_b32 v24, 16, v180
    v_lshlrev_b32 v25, 16, v184
    v_lshlrev_b32 v26, 16, v188
    v_lshlrev_b32 v28, 16, v192
    v_lshlrev_b32 v29, 16, v196
    v_lshlrev_b32 v30, 16, v200
    v_lshlrev_b32 v31, 16, v204
    v_lshlrev_b32 v32, 16, v208
    v_lshlrev_b32 v33, 16, v212
    v_lshlrev_b32 v34, 16, v216
    v_lshlrev_b32 v35, 16, v220
    v_mul_f32 v48, v16, v39
    v_mul_f32 v49, v17, v39
    v_mul_f32 v50, v18, v39
    v_mul_f32 v51, v19, v39
    v_mul_f32 v52, v20, v39
    v_mul_f32 v53, v21, v39
    v_mul_f32 v54, v22, v39
    v_mul_f32 v55, v23, v39
    v_fmac_f32 v48, v17, v38
    v_fmac_f32 v49, v18, v38
    v_fmac_f32 v50, v19, v38
    v_fmac_f32 v51, v20, v38
    v_fmac_f32 v52, v21, v38
    v_fmac_f32 v53, v22, v38
    v_fmac_f32 v54, v23, v38
    v_fmac_f32 v55, v24, v38
    v_fmac_f32 v48, v18, v37
    v_fmac_f32 v49, v19, v37
    v_fmac_f32 v50, v20, v37
    v_fmac_f32 v51, v21, v37
    v_fmac_f32 v52, v22, v37
    v_fmac_f32 v53, v23, v37
    v_fmac_f32 v54, v24, v37
    v_fmac_f32 v55, v25, v37
    v_fmac_f32 v48, v19, v36
    v_fmac_f32 v49, v20, v36
    v_fmac_f32 v50, v21, v36
    v_fmac_f32 v51, v22, v36
    v_fmac_f32 v52, v23, v36
    v_fmac_f32 v53, v24, v36
    v_fmac_f32 v54, v25, v36
    v_fmac_f32 v55, v26, v36
    v_mul_f32 v48, v48, v28
    v_mul_f32 v49, v49, v29
    v_mul_f32 v50, v50, v30
    v_mul_f32 v51, v51, v31
    v_mul_f32 v52, v52, v32
    v_mul_f32 v53, v53, v33
    v_mul_f32 v54, v54, v34
    v_mul_f32 v55, v55, v35
    v_cvt_pk_bf16_f32 v40, v55, v54
    v_cvt_pk_bf16_f32 v41, v53, v52
    v_cvt_pk_bf16_f32 v42, v51, v50
    v_cvt_pk_bf16_f32 v43, v49, v48
    s_mov_b32 s12, 0
    buffer_store_dwordx4 v[40:43], v14, s[52:55], s12 offen sc1
    v_lshlrev_b32 v36, 16, v110
    v_and_b32 v37, 0xffff0000, v110
    v_lshlrev_b32 v38, 16, v111
    v_and_b32 v39, 0xffff0000, v111
    v_and_b32 v16, 0xffff0000, v148
    v_and_b32 v17, 0xffff0000, v152
    v_and_b32 v18, 0xffff0000, v156
    v_and_b32 v19, 0xffff0000, v160
    v_and_b32 v20, 0xffff0000, v164
    v_and_b32 v21, 0xffff0000, v168
    v_and_b32 v22, 0xffff0000, v172
    v_and_b32 v23, 0xffff0000, v176
    v_and_b32 v24, 0xffff0000, v180
    v_and_b32 v25, 0xffff0000, v184
    v_and_b32 v26, 0xffff0000, v188
    v_and_b32 v28, 0xffff0000, v192
    v_and_b32 v29, 0xffff0000, v196
    v_and_b32 v30, 0xffff0000, v200
    v_and_b32 v31, 0xffff0000, v204
    v_and_b32 v32, 0xffff0000, v208
    v_and_b32 v33, 0xffff0000, v212
    v_and_b32 v34, 0xffff0000, v216
    v_and_b32 v35, 0xffff0000, v220
    v_mul_f32 v48, v16, v39
    v_mul_f32 v49, v17, v39
    v_mul_f32 v50, v18, v39
    v_mul_f32 v51, v19, v39
    v_mul_f32 v52, v20, v39
    v_mul_f32 v53, v21, v39
    v_mul_f32 v54, v22, v39
    v_mul_f32 v55, v23, v39
    v_fmac_f32 v48, v17, v38
    v_fmac_f32 v49, v18, v38
    v_fmac_f32 v50, v19, v38
    v_fmac_f32 v51, v20, v38
    v_fmac_f32 v52, v21, v38
    v_fmac_f32 v53, v22, v38
    v_fmac_f32 v54, v23, v38
    v_fmac_f32 v55, v24, v38
    v_fmac_f32 v48, v18, v37
    v_fmac_f32 v49, v19, v37
    v_fmac_f32 v50, v20, v37
    v_fmac_f32 v51, v21, v37
    v_fmac_f32 v52, v22, v37
    v_fmac_f32 v53, v23, v37
    v_fmac_f32 v54, v24, v37
    v_fmac_f32 v55, v25, v37
    v_fmac_f32 v48, v19, v36
    v_fmac_f32 v49, v20, v36
    v_fmac_f32 v50, v21, v36
    v_fmac_f32 v51, v22, v36
    v_fmac_f32 v52, v23, v36
    v_fmac_f32 v53, v24, v36
    v_fmac_f32 v54, v25, v36
    v_fmac_f32 v55, v26, v36
    v_mul_f32 v48, v48, v28
    v_mul_f32 v49, v49, v29
    v_mul_f32 v50, v50, v30
    v_mul_f32 v51, v51, v31
    v_mul_f32 v52, v52, v32
    v_mul_f32 v53, v53, v33
    v_mul_f32 v54, v54, v34
    v_mul_f32 v55, v55, v35
    v_cvt_pk_bf16_f32 v44, v55, v54
    v_cvt_pk_bf16_f32 v45, v53, v52
    v_cvt_pk_bf16_f32 v46, v51, v50
    v_cvt_pk_bf16_f32 v47, v49, v48
    s_mov_b32 s12, 4096
    buffer_store_dwordx4 v[44:47], v14, s[52:55], s12 offen sc1
    v_lshlrev_b32 v36, 16, v112
    v_and_b32 v37, 0xffff0000, v112
    v_lshlrev_b32 v38, 16, v113
    v_and_b32 v39, 0xffff0000, v113
    v_lshlrev_b32 v16, 16, v149
    v_lshlrev_b32 v17, 16, v153
    v_lshlrev_b32 v18, 16, v157
    v_lshlrev_b32 v19, 16, v161
    v_lshlrev_b32 v20, 16, v165
    v_lshlrev_b32 v21, 16, v169
    v_lshlrev_b32 v22, 16, v173
    v_lshlrev_b32 v23, 16, v177
    v_lshlrev_b32 v24, 16, v181
    v_lshlrev_b32 v25, 16, v185
    v_lshlrev_b32 v26, 16, v189
    v_lshlrev_b32 v28, 16, v193
    v_lshlrev_b32 v29, 16, v197
    v_lshlrev_b32 v30, 16, v201
    v_lshlrev_b32 v31, 16, v205
    v_lshlrev_b32 v32, 16, v209
    v_lshlrev_b32 v33, 16, v213
    v_lshlrev_b32 v34, 16, v217
    v_lshlrev_b32 v35, 16, v221
    v_mul_f32 v48, v16, v39
    v_mul_f32 v49, v17, v39
    v_mul_f32 v50, v18, v39
    v_mul_f32 v51, v19, v39
    v_mul_f32 v52, v20, v39
    v_mul_f32 v53, v21, v39
    v_mul_f32 v54, v22, v39
    v_mul_f32 v55, v23, v39
    v_fmac_f32 v48, v17, v38
    v_fmac_f32 v49, v18, v38
    v_fmac_f32 v50, v19, v38
    v_fmac_f32 v51, v20, v38
    v_fmac_f32 v52, v21, v38
    v_fmac_f32 v53, v22, v38
    v_fmac_f32 v54, v23, v38
    v_fmac_f32 v55, v24, v38
    v_fmac_f32 v48, v18, v37
    v_fmac_f32 v49, v19, v37
    v_fmac_f32 v50, v20, v37
    v_fmac_f32 v51, v21, v37
    v_fmac_f32 v52, v22, v37
    v_fmac_f32 v53, v23, v37
    v_fmac_f32 v54, v24, v37
    v_fmac_f32 v55, v25, v37
    v_fmac_f32 v48, v19, v36
    v_fmac_f32 v49, v20, v36
    v_fmac_f32 v50, v21, v36
    v_fmac_f32 v51, v22, v36
    v_fmac_f32 v52, v23, v36
    v_fmac_f32 v53, v24, v36
    v_fmac_f32 v54, v25, v36
    v_fmac_f32 v55, v26, v36
    v_mul_f32 v48, v48, v28
    v_mul_f32 v49, v49, v29
    v_mul_f32 v50, v50, v30
    v_mul_f32 v51, v51, v31
    v_mul_f32 v52, v52, v32
    v_mul_f32 v53, v53, v33
    v_mul_f32 v54, v54, v34
    v_mul_f32 v55, v55, v35
    v_cvt_pk_bf16_f32 v40, v55, v54
    v_cvt_pk_bf16_f32 v41, v53, v52
    v_cvt_pk_bf16_f32 v42, v51, v50
    v_cvt_pk_bf16_f32 v43, v49, v48
    s_mov_b32 s12, 8192
    buffer_store_dwordx4 v[40:43], v14, s[52:55], s12 offen sc1
    v_lshlrev_b32 v36, 16, v114
    v_and_b32 v37, 0xffff0000, v114
    v_lshlrev_b32 v38, 16, v115
    v_and_b32 v39, 0xffff0000, v115
    v_and_b32 v16, 0xffff0000, v149
    v_and_b32 v17, 0xffff0000, v153
    v_and_b32 v18, 0xffff0000, v157
    v_and_b32 v19, 0xffff0000, v161
    v_and_b32 v20, 0xffff0000, v165
    v_and_b32 v21, 0xffff0000, v169
    v_and_b32 v22, 0xffff0000, v173
    v_and_b32 v23, 0xffff0000, v177
    v_and_b32 v24, 0xffff0000, v181
    v_and_b32 v25, 0xffff0000, v185
    v_and_b32 v26, 0xffff0000, v189
    v_and_b32 v28, 0xffff0000, v193
    v_and_b32 v29, 0xffff0000, v197
    v_and_b32 v30, 0xffff0000, v201
    v_and_b32 v31, 0xffff0000, v205
    v_and_b32 v32, 0xffff0000, v209
    v_and_b32 v33, 0xffff0000, v213
    v_and_b32 v34, 0xffff0000, v217
    v_and_b32 v35, 0xffff0000, v221
    v_mul_f32 v48, v16, v39
    v_mul_f32 v49, v17, v39
    v_mul_f32 v50, v18, v39
    v_mul_f32 v51, v19, v39
    v_mul_f32 v52, v20, v39
    v_mul_f32 v53, v21, v39
    v_mul_f32 v54, v22, v39
    v_mul_f32 v55, v23, v39
    v_fmac_f32 v48, v17, v38
    v_fmac_f32 v49, v18, v38
    v_fmac_f32 v50, v19, v38
    v_fmac_f32 v51, v20, v38
    v_fmac_f32 v52, v21, v38
    v_fmac_f32 v53, v22, v38
    v_fmac_f32 v54, v23, v38
    v_fmac_f32 v55, v24, v38
    v_fmac_f32 v48, v18, v37
    v_fmac_f32 v49, v19, v37
    v_fmac_f32 v50, v20, v37
    v_fmac_f32 v51, v21, v37
    v_fmac_f32 v52, v22, v37
    v_fmac_f32 v53, v23, v37
    v_fmac_f32 v54, v24, v37
    v_fmac_f32 v55, v25, v37
    v_fmac_f32 v48, v19, v36
    v_fmac_f32 v49, v20, v36
    v_fmac_f32 v50, v21, v36
    v_fmac_f32 v51, v22, v36
    v_fmac_f32 v52, v23, v36
    v_fmac_f32 v53, v24, v36
    v_fmac_f32 v54, v25, v36
    v_fmac_f32 v55, v26, v36
    v_mul_f32 v48, v48, v28
    v_mul_f32 v49, v49, v29
    v_mul_f32 v50, v50, v30
    v_mul_f32 v51, v51, v31
    v_mul_f32 v52, v52, v32
    v_mul_f32 v53, v53, v33
    v_mul_f32 v54, v54, v34
    v_mul_f32 v55, v55, v35
    v_cvt_pk_bf16_f32 v44, v55, v54
    v_cvt_pk_bf16_f32 v45, v53, v52
    v_cvt_pk_bf16_f32 v46, v51, v50
    v_cvt_pk_bf16_f32 v47, v49, v48
    s_mov_b32 s12, 12288
    buffer_store_dwordx4 v[44:47], v14, s[52:55], s12 offen sc1
    v_lshlrev_b32 v36, 16, v116
    v_and_b32 v37, 0xffff0000, v116
    v_lshlrev_b32 v38, 16, v117
    v_and_b32 v39, 0xffff0000, v117
    v_lshlrev_b32 v16, 16, v150
    v_lshlrev_b32 v17, 16, v154
    v_lshlrev_b32 v18, 16, v158
    v_lshlrev_b32 v19, 16, v162
    v_lshlrev_b32 v20, 16, v166
    v_lshlrev_b32 v21, 16, v170
    v_lshlrev_b32 v22, 16, v174
    v_lshlrev_b32 v23, 16, v178
    v_lshlrev_b32 v24, 16, v182
    v_lshlrev_b32 v25, 16, v186
    v_lshlrev_b32 v26, 16, v190
    v_lshlrev_b32 v28, 16, v194
    v_lshlrev_b32 v29, 16, v198
    v_lshlrev_b32 v30, 16, v202
    v_lshlrev_b32 v31, 16, v206
    v_lshlrev_b32 v32, 16, v210
    v_lshlrev_b32 v33, 16, v214
    v_lshlrev_b32 v34, 16, v218
    v_lshlrev_b32 v35, 16, v222
    v_mul_f32 v48, v16, v39
    v_mul_f32 v49, v17, v39
    v_mul_f32 v50, v18, v39
    v_mul_f32 v51, v19, v39
    v_mul_f32 v52, v20, v39
    v_mul_f32 v53, v21, v39
    v_mul_f32 v54, v22, v39
    v_mul_f32 v55, v23, v39
    v_fmac_f32 v48, v17, v38
    v_fmac_f32 v49, v18, v38
    v_fmac_f32 v50, v19, v38
    v_fmac_f32 v51, v20, v38
    v_fmac_f32 v52, v21, v38
    v_fmac_f32 v53, v22, v38
    v_fmac_f32 v54, v23, v38
    v_fmac_f32 v55, v24, v38
    v_fmac_f32 v48, v18, v37
    v_fmac_f32 v49, v19, v37
    v_fmac_f32 v50, v20, v37
    v_fmac_f32 v51, v21, v37
    v_fmac_f32 v52, v22, v37
    v_fmac_f32 v53, v23, v37
    v_fmac_f32 v54, v24, v37
    v_fmac_f32 v55, v25, v37
    v_fmac_f32 v48, v19, v36
    v_fmac_f32 v49, v20, v36
    v_fmac_f32 v50, v21, v36
    v_fmac_f32 v51, v22, v36
    v_fmac_f32 v52, v23, v36
    v_fmac_f32 v53, v24, v36
    v_fmac_f32 v54, v25, v36
    v_fmac_f32 v55, v26, v36
    v_mul_f32 v48, v48, v28
    v_mul_f32 v49, v49, v29
    v_mul_f32 v50, v50, v30
    v_mul_f32 v51, v51, v31
    v_mul_f32 v52, v52, v32
    v_mul_f32 v53, v53, v33
    v_mul_f32 v54, v54, v34
    v_mul_f32 v55, v55, v35
    v_cvt_pk_bf16_f32 v40, v55, v54
    v_cvt_pk_bf16_f32 v41, v53, v52
    v_cvt_pk_bf16_f32 v42, v51, v50
    v_cvt_pk_bf16_f32 v43, v49, v48
    s_mov_b32 s12, 16384
    buffer_store_dwordx4 v[40:43], v14, s[52:55], s12 offen sc1
    v_lshlrev_b32 v36, 16, v118
    v_and_b32 v37, 0xffff0000, v118
    v_lshlrev_b32 v38, 16, v119
    v_and_b32 v39, 0xffff0000, v119
    v_and_b32 v16, 0xffff0000, v150
    v_and_b32 v17, 0xffff0000, v154
    v_and_b32 v18, 0xffff0000, v158
    v_and_b32 v19, 0xffff0000, v162
    v_and_b32 v20, 0xffff0000, v166
    v_and_b32 v21, 0xffff0000, v170
    v_and_b32 v22, 0xffff0000, v174
    v_and_b32 v23, 0xffff0000, v178
    v_and_b32 v24, 0xffff0000, v182
    v_and_b32 v25, 0xffff0000, v186
    v_and_b32 v26, 0xffff0000, v190
    v_and_b32 v28, 0xffff0000, v194
    v_and_b32 v29, 0xffff0000, v198
    v_and_b32 v30, 0xffff0000, v202
    v_and_b32 v31, 0xffff0000, v206
    v_and_b32 v32, 0xffff0000, v210
    v_and_b32 v33, 0xffff0000, v214
    v_and_b32 v34, 0xffff0000, v218
    v_and_b32 v35, 0xffff0000, v222
    v_mul_f32 v48, v16, v39
    v_mul_f32 v49, v17, v39
    v_mul_f32 v50, v18, v39
    v_mul_f32 v51, v19, v39
    v_mul_f32 v52, v20, v39
    v_mul_f32 v53, v21, v39
    v_mul_f32 v54, v22, v39
    v_mul_f32 v55, v23, v39
    v_fmac_f32 v48, v17, v38
    v_fmac_f32 v49, v18, v38
    v_fmac_f32 v50, v19, v38
    v_fmac_f32 v51, v20, v38
    v_fmac_f32 v52, v21, v38
    v_fmac_f32 v53, v22, v38
    v_fmac_f32 v54, v23, v38
    v_fmac_f32 v55, v24, v38
    v_fmac_f32 v48, v18, v37
    v_fmac_f32 v49, v19, v37
    v_fmac_f32 v50, v20, v37
    v_fmac_f32 v51, v21, v37
    v_fmac_f32 v52, v22, v37
    v_fmac_f32 v53, v23, v37
    v_fmac_f32 v54, v24, v37
    v_fmac_f32 v55, v25, v37
    v_fmac_f32 v48, v19, v36
    v_fmac_f32 v49, v20, v36
    v_fmac_f32 v50, v21, v36
    v_fmac_f32 v51, v22, v36
    v_fmac_f32 v52, v23, v36
    v_fmac_f32 v53, v24, v36
    v_fmac_f32 v54, v25, v36
    v_fmac_f32 v55, v26, v36
    v_mul_f32 v48, v48, v28
    v_mul_f32 v49, v49, v29
    v_mul_f32 v50, v50, v30
    v_mul_f32 v51, v51, v31
    v_mul_f32 v52, v52, v32
    v_mul_f32 v53, v53, v33
    v_mul_f32 v54, v54, v34
    v_mul_f32 v55, v55, v35
    v_cvt_pk_bf16_f32 v44, v55, v54
    v_cvt_pk_bf16_f32 v45, v53, v52
    v_cvt_pk_bf16_f32 v46, v51, v50
    v_cvt_pk_bf16_f32 v47, v49, v48
    s_mov_b32 s12, 20480
    buffer_store_dwordx4 v[44:47], v14, s[52:55], s12 offen sc1
    v_lshlrev_b32 v36, 16, v120
    v_and_b32 v37, 0xffff0000, v120
    v_lshlrev_b32 v38, 16, v121
    v_and_b32 v39, 0xffff0000, v121
    v_lshlrev_b32 v16, 16, v151
    v_lshlrev_b32 v17, 16, v155
    v_lshlrev_b32 v18, 16, v159
    v_lshlrev_b32 v19, 16, v163
    v_lshlrev_b32 v20, 16, v167
    v_lshlrev_b32 v21, 16, v171
    v_lshlrev_b32 v22, 16, v175
    v_lshlrev_b32 v23, 16, v179
    v_lshlrev_b32 v24, 16, v183
    v_lshlrev_b32 v25, 16, v187
    v_lshlrev_b32 v26, 16, v191
    v_lshlrev_b32 v28, 16, v195
    v_lshlrev_b32 v29, 16, v199
    v_lshlrev_b32 v30, 16, v203
    v_lshlrev_b32 v31, 16, v207
    v_lshlrev_b32 v32, 16, v211
    v_lshlrev_b32 v33, 16, v215
    v_lshlrev_b32 v34, 16, v219
    v_lshlrev_b32 v35, 16, v223
    v_mul_f32 v48, v16, v39
    v_mul_f32 v49, v17, v39
    v_mul_f32 v50, v18, v39
    v_mul_f32 v51, v19, v39
    v_mul_f32 v52, v20, v39
    v_mul_f32 v53, v21, v39
    v_mul_f32 v54, v22, v39
    v_mul_f32 v55, v23, v39
    v_fmac_f32 v48, v17, v38
    v_fmac_f32 v49, v18, v38
    v_fmac_f32 v50, v19, v38
    v_fmac_f32 v51, v20, v38
    v_fmac_f32 v52, v21, v38
    v_fmac_f32 v53, v22, v38
    v_fmac_f32 v54, v23, v38
    v_fmac_f32 v55, v24, v38
    v_fmac_f32 v48, v18, v37
    v_fmac_f32 v49, v19, v37
    v_fmac_f32 v50, v20, v37
    v_fmac_f32 v51, v21, v37
    v_fmac_f32 v52, v22, v37
    v_fmac_f32 v53, v23, v37
    v_fmac_f32 v54, v24, v37
    v_fmac_f32 v55, v25, v37
    v_fmac_f32 v48, v19, v36
    v_fmac_f32 v49, v20, v36
    v_fmac_f32 v50, v21, v36
    v_fmac_f32 v51, v22, v36
    v_fmac_f32 v52, v23, v36
    v_fmac_f32 v53, v24, v36
    v_fmac_f32 v54, v25, v36
    v_fmac_f32 v55, v26, v36
    v_mul_f32 v48, v48, v28
    v_mul_f32 v49, v49, v29
    v_mul_f32 v50, v50, v30
    v_mul_f32 v51, v51, v31
    v_mul_f32 v52, v52, v32
    v_mul_f32 v53, v53, v33
    v_mul_f32 v54, v54, v34
    v_mul_f32 v55, v55, v35
    v_cvt_pk_bf16_f32 v40, v55, v54
    v_cvt_pk_bf16_f32 v41, v53, v52
    v_cvt_pk_bf16_f32 v42, v51, v50
    v_cvt_pk_bf16_f32 v43, v49, v48
    s_mov_b32 s12, 24576
    buffer_store_dwordx4 v[40:43], v14, s[52:55], s12 offen sc1
    v_lshlrev_b32 v36, 16, v122
    v_and_b32 v37, 0xffff0000, v122
    v_lshlrev_b32 v38, 16, v123
    v_and_b32 v39, 0xffff0000, v123
    v_and_b32 v16, 0xffff0000, v151
    v_and_b32 v17, 0xffff0000, v155
    v_and_b32 v18, 0xffff0000, v159
    v_and_b32 v19, 0xffff0000, v163
    v_and_b32 v20, 0xffff0000, v167
    v_and_b32 v21, 0xffff0000, v171
    v_and_b32 v22, 0xffff0000, v175
    v_and_b32 v23, 0xffff0000, v179
    v_and_b32 v24, 0xffff0000, v183
    v_and_b32 v25, 0xffff0000, v187
    v_and_b32 v26, 0xffff0000, v191
    v_and_b32 v28, 0xffff0000, v195
    v_and_b32 v29, 0xffff0000, v199
    v_and_b32 v30, 0xffff0000, v203
    v_and_b32 v31, 0xffff0000, v207
    v_and_b32 v32, 0xffff0000, v211
    v_and_b32 v33, 0xffff0000, v215
    v_and_b32 v34, 0xffff0000, v219
    v_and_b32 v35, 0xffff0000, v223
    v_mul_f32 v48, v16, v39
    v_mul_f32 v49, v17, v39
    v_mul_f32 v50, v18, v39
    v_mul_f32 v51, v19, v39
    v_mul_f32 v52, v20, v39
    v_mul_f32 v53, v21, v39
    v_mul_f32 v54, v22, v39
    v_mul_f32 v55, v23, v39
    v_fmac_f32 v48, v17, v38
    v_fmac_f32 v49, v18, v38
    v_fmac_f32 v50, v19, v38
    v_fmac_f32 v51, v20, v38
    v_fmac_f32 v52, v21, v38
    v_fmac_f32 v53, v22, v38
    v_fmac_f32 v54, v23, v38
    v_fmac_f32 v55, v24, v38
    v_fmac_f32 v48, v18, v37
    v_fmac_f32 v49, v19, v37
    v_fmac_f32 v50, v20, v37
    v_fmac_f32 v51, v21, v37
    v_fmac_f32 v52, v22, v37
    v_fmac_f32 v53, v23, v37
    v_fmac_f32 v54, v24, v37
    v_fmac_f32 v55, v25, v37
    v_fmac_f32 v48, v19, v36
    v_fmac_f32 v49, v20, v36
    v_fmac_f32 v50, v21, v36
    v_fmac_f32 v51, v22, v36
    v_fmac_f32 v52, v23, v36
    v_fmac_f32 v53, v24, v36
    v_fmac_f32 v54, v25, v36
    v_fmac_f32 v55, v26, v36
    v_mul_f32 v48, v48, v28
    v_mul_f32 v49, v49, v29
    v_mul_f32 v50, v50, v30
    v_mul_f32 v51, v51, v31
    v_mul_f32 v52, v52, v32
    v_mul_f32 v53, v53, v33
    v_mul_f32 v54, v54, v34
    v_mul_f32 v55, v55, v35
    v_cvt_pk_bf16_f32 v44, v55, v54
    v_cvt_pk_bf16_f32 v45, v53, v52
    v_cvt_pk_bf16_f32 v46, v51, v50
    v_cvt_pk_bf16_f32 v47, v49, v48
    s_mov_b32 s12, 28672
    buffer_store_dwordx4 v[44:47], v14, s[52:55], s12 offen sc1
    s_cmp_lt_u32 s3, 4
    s_cbranch_scc0 Z1_SWD_X
    s_lshl_b32 s80, s3, 14
    s_add_u32 s80, s80, 16384
    s_lshl_b32 s15, s8, 2
    s_add_u32 s15, s15, s3
    s_add_u32 s13, s15, 0
    s_mul_hi_u32 s72, s13, 0x1999999a
    s_mul_i32 s12, s72, 10
    s_sub_u32 s73, s13, s12
    s_mul_i32 s12, s72, 40960
    s_lshl_b32 s14, s73, 7
    s_add_u32 s12, s12, s14
    s_add_u32 m0, s80, 0
    s_add_u32 s14, s12, 0
    buffer_load_dwordx4 v1, s[68:71], s14 offen lds
    s_add_u32 m0, s80, 1024
    s_add_u32 s14, s12, 10240
    buffer_load_dwordx4 v1, s[68:71], s14 offen lds
    s_add_u32 m0, s80, 2048
    s_add_u32 s14, s12, 20480
    buffer_load_dwordx4 v1, s[68:71], s14 offen lds
    s_add_u32 m0, s80, 3072
    s_add_u32 s14, s12, 30720
    buffer_load_dwordx4 v1, s[68:71], s14 offen lds
    s_mul_i32 s12, s73, 216
    s_add_u32 s12, s12, s72
    s_lshl_b32 s12, s12, 10
    s_add_u32 s72, s12, 0x700000
    s_add_u32 s13, s15, 160
    s_mul_hi_u32 s74, s13, 0x1999999a
    s_mul_i32 s12, s74, 10
    s_sub_u32 s75, s13, s12
    s_mul_i32 s12, s74, 40960
    s_lshl_b32 s14, s75, 7
    s_add_u32 s12, s12, s14
    s_add_u32 m0, s80, 4096
    s_add_u32 s14, s12, 0
    buffer_load_dwordx4 v1, s[68:71], s14 offen lds
    s_add_u32 m0, s80, 5120
    s_add_u32 s14, s12, 10240
    buffer_load_dwordx4 v1, s[68:71], s14 offen lds
    s_add_u32 m0, s80, 6144
    s_add_u32 s14, s12, 20480
    buffer_load_dwordx4 v1, s[68:71], s14 offen lds
    s_add_u32 m0, s80, 7168
    s_add_u32 s14, s12, 30720
    buffer_load_dwordx4 v1, s[68:71], s14 offen lds
    s_mul_i32 s12, s75, 216
    s_add_u32 s12, s12, s74
    s_lshl_b32 s12, s12, 10
    s_add_u32 s74, s12, 0x700000
    s_add_u32 s13, s15, 320
    s_mul_hi_u32 s76, s13, 0x1999999a
    s_mul_i32 s12, s76, 10
    s_sub_u32 s77, s13, s12
    s_mul_i32 s12, s76, 40960
    s_lshl_b32 s14, s77, 7
    s_add_u32 s12, s12, s14
    s_add_u32 m0, s80, 8192
    s_add_u32 s14, s12, 0
    buffer_load_dwordx4 v1, s[68:71], s14 offen lds
    s_add_u32 m0, s80, 9216
    s_add_u32 s14, s12, 10240
    buffer_load_dwordx4 v1, s[68:71], s14 offen lds
    s_add_u32 m0, s80, 10240
    s_add_u32 s14, s12, 20480
    buffer_load_dwordx4 v1, s[68:71], s14 offen lds
    s_add_u32 m0, s80, 11264
    s_add_u32 s14, s12, 30720
    buffer_load_dwordx4 v1, s[68:71], s14 offen lds
    s_mul_i32 s12, s77, 216
    s_add_u32 s12, s12, s76
    s_lshl_b32 s12, s12, 10
    s_add_u32 s76, s12, 0x700000
    s_add_u32 s13, s15, 480
    s_cmp_lt_u32 s13, 540
    s_cselect_b64 s[82:83], -1, 0
    s_mov_b64 exec, s[82:83]
    s_min_u32 s13, s13, 539
    s_mul_hi_u32 s78, s13, 0x1999999a
    s_mul_i32 s12, s78, 10
    s_sub_u32 s79, s13, s12
    s_mul_i32 s12, s78, 40960
    s_lshl_b32 s14, s79, 7
    s_add_u32 s12, s12, s14
    s_add_u32 m0, s80, 12288
    s_add_u32 s14, s12, 0
    buffer_load_dwordx4 v1, s[68:71], s14 offen lds
    s_add_u32 m0, s80, 13312
    s_add_u32 s14, s12, 10240
    buffer_load_dwordx4 v1, s[68:71], s14 offen lds
    s_add_u32 m0, s80, 14336
    s_add_u32 s14, s12, 20480
    buffer_load_dwordx4 v1, s[68:71], s14 offen lds
    s_add_u32 m0, s80, 15360
    s_add_u32 s14, s12, 30720
    buffer_load_dwordx4 v1, s[68:71], s14 offen lds
    s_mul_i32 s12, s79, 216
    s_add_u32 s12, s12, s78
    s_lshl_b32 s12, s12, 10
    s_add_u32 s78, s12, 0x700000
    s_mov_b64 exec, -1
    v_lshrrev_b32 v7, 2, v0
    v_lshlrev_b32 v7, 7, v7
    v_and_b32 v12, 3, v0
    v_lshl_add_u32 v7, v12, 3, v7
    v_add_u32 v7, s80, v7
    s_waitcnt vmcnt(12)
    ds_read_b64_tr_b16 v[64:65], v7 offset:0
    ds_read_b64_tr_b16 v[66:67], v7 offset:2048
    ds_read_b64_tr_b16 v[68:69], v7 offset:32
    ds_read_b64_tr_b16 v[70:71], v7 offset:2080
    ds_read_b64_tr_b16 v[72:73], v7 offset:64
    ds_read_b64_tr_b16 v[74:75], v7 offset:2112
    ds_read_b64_tr_b16 v[76:77], v7 offset:96
    ds_read_b64_tr_b16 v[78:79], v7 offset:2144
    s_waitcnt lgkmcnt(6)
    buffer_store_dwordx4 v[64:67], v4, s[52:55], s72 offen sc1
    s_add_u32 s72, s72, 55296
    s_waitcnt lgkmcnt(4)
    buffer_store_dwordx4 v[68:71], v4, s[52:55], s72 offen sc1
    s_add_u32 s72, s72, 55296
    s_waitcnt lgkmcnt(2)
    buffer_store_dwordx4 v[72:75], v4, s[52:55], s72 offen sc1
    s_add_u32 s72, s72, 55296
    s_waitcnt lgkmcnt(0)
    buffer_store_dwordx4 v[76:79], v4, s[52:55], s72 offen sc1
    s_waitcnt vmcnt(12)
    ds_read_b64_tr_b16 v[80:81], v7 offset:4096
    ds_read_b64_tr_b16 v[82:83], v7 offset:6144
    ds_read_b64_tr_b16 v[84:85], v7 offset:4128
    ds_read_b64_tr_b16 v[86:87], v7 offset:6176
    ds_read_b64_tr_b16 v[88:89], v7 offset:4160
    ds_read_b64_tr_b16 v[90:91], v7 offset:6208
    ds_read_b64_tr_b16 v[92:93], v7 offset:4192
    ds_read_b64_tr_b16 v[94:95], v7 offset:6240
    s_waitcnt lgkmcnt(6)
    buffer_store_dwordx4 v[80:83], v4, s[52:55], s74 offen sc1
    s_add_u32 s74, s74, 55296
    s_waitcnt lgkmcnt(4)
    buffer_store_dwordx4 v[84:87], v4, s[52:55], s74 offen sc1
    s_add_u32 s74, s74, 55296
    s_waitcnt lgkmcnt(2)
    buffer_store_dwordx4 v[88:91], v4, s[52:55], s74 offen sc1
    s_add_u32 s74, s74, 55296
    s_waitcnt lgkmcnt(0)
    buffer_store_dwordx4 v[92:95], v4, s[52:55], s74 offen sc1
    s_waitcnt vmcnt(12)
    ds_read_b64_tr_b16 v[96:97], v7 offset:8192
    ds_read_b64_tr_b16 v[98:99], v7 offset:10240
    ds_read_b64_tr_b16 v[100:101], v7 offset:8224
    ds_read_b64_tr_b16 v[102:103], v7 offset:10272
    ds_read_b64_tr_b16 v[104:105], v7 offset:8256
    ds_read_b64_tr_b16 v[106:107], v7 offset:10304
    ds_read_b64_tr_b16 v[108:109], v7 offset:8288
    ds_read_b64_tr_b16 v[110:111], v7 offset:10336
    s_waitcnt lgkmcnt(6)
    buffer_store_dwordx4 v[96:99], v4, s[52:55], s76 offen sc1
    s_add_u32 s76, s76, 55296
    s_waitcnt lgkmcnt(4)
    buffer_store_dwordx4 v[100:103], v4, s[52:55], s76 offen sc1
    s_add_u32 s76, s76, 55296
    s_waitcnt lgkmcnt(2)
    buffer_store_dwordx4 v[104:107], v4, s[52:55], s76 offen sc1
    s_add_u32 s76, s76, 55296
    s_waitcnt lgkmcnt(0)
    buffer_store_dwordx4 v[108:111], v4, s[52:55], s76 offen sc1
    s_waitcnt vmcnt(12)
    ds_read_b64_tr_b16 v[112:113], v7 offset:12288
    ds_read_b64_tr_b16 v[114:115], v7 offset:14336
    ds_read_b64_tr_b16 v[116:117], v7 offset:12320
    ds_read_b64_tr_b16 v[118:119], v7 offset:14368
    ds_read_b64_tr_b16 v[120:121], v7 offset:12352
    ds_read_b64_tr_b16 v[122:123], v7 offset:14400
    ds_read_b64_tr_b16 v[124:125], v7 offset:12384
    ds_read_b64_tr_b16 v[126:127], v7 offset:14432
    s_mov_b64 exec, s[82:83]
    s_waitcnt lgkmcnt(6)
    buffer_store_dwordx4 v[112:115], v4, s[52:55], s78 offen sc1
    s_add_u32 s78, s78, 55296
    s_waitcnt lgkmcnt(4)
    buffer_store_dwordx4 v[116:119], v4, s[52:55], s78 offen sc1
    s_add_u32 s78, s78, 55296
    s_waitcnt lgkmcnt(2)
    buffer_store_dwordx4 v[120:123], v4, s[52:55], s78 offen sc1
    s_add_u32 s78, s78, 55296
    s_waitcnt lgkmcnt(0)
    buffer_store_dwordx4 v[124:127], v4, s[52:55], s78 offen sc1
    s_mov_b64 exec, -1
    s_nop 0
Z1_SWD_X:
K1_END:
    s_endpgm

.globl k2_kernel
.p2align 8
.type k2_kernel,@function
k2_kernel:
    s_cmp_ge_u32 s2, 256
    s_cbranch_scc1 K2_END
    s_load_dwordx16 s[16:31], s[0:1], 0
    s_load_dwordx8 s[32:39], s[0:1], 64
    s_load_dwordx2 s[40:41], s[0:1], 96
    v_lshrrev_b32 v1, 6, v0
    v_and_b32 v0, 63, v0
    v_readfirstlane_b32 s3, v1
    s_and_b32 s4, s2, 7
    s_lshr_b32 s5, s2, 3
    s_lshr_b32 s6, s4, 1
    s_lshl_b32 s6, s6, 3
    s_and_b32 s7, s5, 7
    s_add_u32 s6, s6, s7
    s_and_b32 s7, s4, 1
    s_lshl_b32 s7, s7, 2
    s_lshr_b32 s8, s5, 3
    s_add_u32 s7, s7, s8
    s_cmp_ge_u32 s3, 4
    s_cbranch_scc1 K2_CONV
    s_mul_i32 s8, s3, 14
    s_sub_u32 s9, s3, 1
    s_max_i32 s9, s9, 0
    s_sub_u32 s8, s8, s9
    v_lshlrev_b32 v13, 4, v0
    s_add_u32 s9, s3, 0
    s_and_b32 s9, s9, 3
    s_lshl_b32 s10, s6, 2
    s_add_u32 s10, s10, s9
    s_mul_i32 s10, s10, 54
    s_add_u32 s10, s10, s8
    s_lshl_b32 s10, s10, 10
    v_add_u32 v4, s10, v13
    s_add_u32 s9, s3, 1
    s_and_b32 s9, s9, 3
    s_lshl_b32 s10, s6, 2
    s_add_u32 s10, s10, s9
    s_mul_i32 s10, s10, 54
    s_add_u32 s10, s10, s8
    s_lshl_b32 s10, s10, 10
    v_add_u32 v5, s10, v13
    s_mul_i32 s9, s9, 15360
    s_add_u32 s9, s9, 76032
    v_add_u32 v1, s9, v13
    s_add_u32 s9, s3, 2
    s_and_b32 s9, s9, 3
    s_lshl_b32 s10, s6, 2
    s_add_u32 s10, s10, s9
    s_mul_i32 s10, s10, 54
    s_add_u32 s10, s10, s8
    s_lshl_b32 s10, s10, 10
    v_add_u32 v6, s10, v13
    s_mul_i32 s9, s9, 15360
    s_add_u32 s9, s9, 81152
    v_add_u32 v2, s9, v13
    s_add_u32 s9, s3, 3
    s_and_b32 s9, s9, 3
    s_lshl_b32 s10, s6, 2
    s_add_u32 s10, s10, s9
    s_mul_i32 s10, s10, 54
    s_add_u32 s10, s10, s8
    s_lshl_b32 s10, s10, 10
    v_add_u32 v7, s10, v13
    s_mul_i32 s9, s9, 15360
    s_add_u32 s9, s9, 86272
    v_add_u32 v3, s9, v13
    s_mul_i32 s9, s7, 270
    s_add_u32 s9, s9, s8
    s_lshl_b32 s9, s9, 10
    s_add_u32 s9, s9, 0x700000
    v_add_u32 v8, s9, v13
    v_add_u32 v9, 0xd800, v8
    v_add_u32 v10, 0x1b000, v8
    v_add_u32 v11, 0x28800, v8
    v_add_u32 v12, 0x36000, v8
    s_mov_b32 s73, 4096
    s_mov_b32 s74, 8192
    s_mov_b32 s75, 12288
    s_waitcnt lgkmcnt(0)
    s_mov_b32 s44, s40
    s_and_b32 s45, s41, 0xffff
    s_mov_b32 s46, 0x1000000
    s_mov_b32 s47, 0x20000
    s_barrier
    s_cmp_ge_u32 s3, 2
    s_cbranch_scc1 K2_G_SK0
    buffer_load_dwordx4 v[112:115], v8, s[44:47], 0 offen offset:0
    buffer_load_dwordx4 v[116:119], v9, s[44:47], 0 offen offset:0
    buffer_load_dwordx4 v[120:123], v10, s[44:47], 0 offen offset:0
    buffer_load_dwordx4 v[124:127], v11, s[44:47], 0 offen offset:0
    buffer_load_dwordx4 v[96:99], v4, s[44:47], 0 offen offset:0
    buffer_load_dwordx4 v[100:103], v5, s[44:47], 0 offen offset:0
    buffer_load_dwordx4 v[104:107], v6, s[44:47], 0 offen offset:0
    buffer_load_dwordx4 v[108:111], v7, s[44:47], 0 offen offset:0
    buffer_load_dwordx4 v[128:131], v12, s[44:47], 0 offen offset:0
K2_G_SK0:
    buffer_load_dwordx4 v[148:151], v8, s[44:47], 0 offen offset:1024
    buffer_load_dwordx4 v[152:155], v9, s[44:47], 0 offen offset:1024
    buffer_load_dwordx4 v[156:159], v10, s[44:47], 0 offen offset:1024
    buffer_load_dwordx4 v[160:163], v11, s[44:47], 0 offen offset:1024
    buffer_load_dwordx4 v[132:135], v4, s[44:47], 0 offen offset:1024
    buffer_load_dwordx4 v[136:139], v5, s[44:47], 0 offen offset:1024
    buffer_load_dwordx4 v[140:143], v6, s[44:47], 0 offen offset:1024
    buffer_load_dwordx4 v[144:147], v7, s[44:47], 0 offen offset:1024
    buffer_load_dwordx4 v[164:167], v12, s[44:47], 0 offen offset:1024
    buffer_load_dwordx4 v[184:187], v8, s[44:47], 0 offen offset:2048
    buffer_load_dwordx4 v[188:191], v9, s[44:47], 0 offen offset:2048
    buffer_load_dwordx4 v[192:195], v10, s[44:47], 0 offen offset:2048
    buffer_load_dwordx4 v[196:199], v11, s[44:47], 0 offen offset:2048
    buffer_load_dwordx4 v[168:171], v4, s[44:47], 0 offen offset:2048
    buffer_load_dwordx4 v[172:175], v5, s[44:47], 0 offen offset:2048
    buffer_load_dwordx4 v[176:179], v6, s[44:47], 0 offen offset:2048
    buffer_load_dwordx4 v[180:183], v7, s[44:47], 0 offen offset:2048
    buffer_load_dwordx4 v[200:203], v12, s[44:47], 0 offen offset:2048
    buffer_load_dwordx4 v[220:223], v8, s[44:47], 0 offen offset:3072
    buffer_load_dwordx4 v[224:227], v9, s[44:47], 0 offen offset:3072
    buffer_load_dwordx4 v[228:231], v10, s[44:47], 0 offen offset:3072
    buffer_load_dwordx4 v[232:235], v11, s[44:47], 0 offen offset:3072
    buffer_load_dwordx4 v[204:207], v4, s[44:47], 0 offen offset:3072
    buffer_load_dwordx4 v[208:211], v5, s[44:47], 0 offen offset:3072
    buffer_load_dwordx4 v[212:215], v6, s[44:47], 0 offen offset:3072
    buffer_load_dwordx4 v[216:219], v7, s[44:47], 0 offen offset:3072
    buffer_load_dwordx4 v[236:239], v12, s[44:47], 0 offen offset:3072
    s_cmp_lt_u32 s3, 2
    s_cbranch_scc1 K2_G_SK1
    buffer_load_dwordx4 v[112:115], v8, s[44:47], s73 offen offset:0
    buffer_load_dwordx4 v[116:119], v9, s[44:47], s73 offen offset:0
    buffer_load_dwordx4 v[120:123], v10, s[44:47], s73 offen offset:0
    buffer_load_dwordx4 v[124:127], v11, s[44:47], s73 offen offset:0
    buffer_load_dwordx4 v[96:99], v4, s[44:47], s73 offen offset:0
    buffer_load_dwordx4 v[100:103], v5, s[44:47], s73 offen offset:0
    buffer_load_dwordx4 v[104:107], v6, s[44:47], s73 offen offset:0
    buffer_load_dwordx4 v[108:111], v7, s[44:47], s73 offen offset:0
    buffer_load_dwordx4 v[128:131], v12, s[44:47], s73 offen offset:0
K2_G_SK1:
    v_mov_b32 v16, 0
    v_mov_b32 v17, 0
    v_mov_b32 v18, 0
    v_mov_b32 v19, 0
    v_mov_b32 v20, 0
    v_mov_b32 v21, 0
    v_mov_b32 v22, 0
    v_mov_b32 v23, 0
    v_mov_b32 v24, 0
    v_mov_b32 v25, 0
    v_mov_b32 v26, 0
    v_mov_b32 v27, 0
    v_mov_b32 v28, 0
    v_mov_b32 v29, 0
    v_mov_b32 v30, 0
    v_mov_b32 v31, 0
    v_mov_b32 v32, 0
    v_mov_b32 v33, 0
    v_mov_b32 v34, 0
    v_mov_b32 v35, 0
    v_mov_b32 v36, 0
    v_mov_b32 v37, 0
    v_mov_b32 v38, 0
    v_mov_b32 v39, 0
    v_mov_b32 v40, 0
    v_mov_b32 v41, 0
    v_mov_b32 v42, 0
    v_mov_b32 v43, 0
    v_mov_b32 v44, 0
    v_mov_b32 v45, 0
    v_mov_b32 v46, 0
    v_mov_b32 v47, 0
    v_mov_b32 v48, 0
    v_mov_b32 v49, 0
    v_mov_b32 v50, 0
    v_mov_b32 v51, 0
    v_mov_b32 v52, 0
    v_mov_b32 v53, 0
    v_mov_b32 v54, 0
    v_mov_b32 v55, 0
    v_mov_b32 v56, 0
    v_mov_b32 v57, 0
    v_mov_b32 v58, 0
    v_mov_b32 v59, 0
    v_mov_b32 v60, 0
    v_mov_b32 v61, 0
    v_mov_b32 v62, 0
    v_mov_b32 v63, 0
    v_mov_b32 v64, 0
    v_mov_b32 v65, 0
    v_mov_b32 v66, 0
    v_mov_b32 v67, 0
    v_mov_b32 v68, 0
    v_mov_b32 v69, 0
    v_mov_b32 v70, 0
    v_mov_b32 v71, 0
    v_mov_b32 v72, 0
    v_mov_b32 v73, 0
    v_mov_b32 v74, 0
    v_mov_b32 v75, 0
    v_mov_b32 v76, 0
    v_mov_b32 v77, 0
    v_mov_b32 v78, 0
    v_mov_b32 v79, 0
    v_mov_b32 v80, 0
    v_mov_b32 v81, 0
    v_mov_b32 v82, 0
    v_mov_b32 v83, 0
    v_mov_b32 v84, 0
    v_mov_b32 v85, 0
    v_mov_b32 v86, 0
    v_mov_b32 v87, 0
    v_mov_b32 v88, 0
    v_mov_b32 v89, 0
    v_mov_b32 v90, 0
    v_mov_b32 v91, 0
    v_mov_b32 v92, 0
    v_mov_b32 v93, 0
    v_mov_b32 v94, 0
    v_mov_b32 v95, 0
    s_mov_b32 s56, s36
    s_and_b32 s57, s37, 0xffff
    s_mov_b32 s58, 0x280000
    s_mov_b32 s59, 0x20000
    s_mul_i32 s9, s3, 15360
    s_add_u32 s9, s9, 76032
    v_add_u32 v14, s9, v13
    v_lshrrev_b32 v240, 4, v0
    v_and_b32 v241, 15, v0
    v_lshlrev_b32 v15, 10, v240
    v_lshl_add_u32 v15, v241, 4, v15
    s_lshl_b32 s9, s3, 8
    s_add_u32 s9, s9, 137472
    v_add_u32 v15, s9, v15
    s_lshl_b32 s9, s6, 6
    s_lshl_b32 s10, s3, 4
    s_add_u32 s9, s9, s10
    v_add_u32 v241, s9, v241
    v_mul_u32_u24 v241, 0x500, v241
    v_lshl_add_u32 v241, v240, 3, v241
    s_mul_i32 s9, s7, 160
    v_add_u32 v241, s9, v241
    v_mov_b32 v242, 157956
    v_mov_b32 v243, 1
    s_cmp_ge_u32 s3, 2
    s_cbranch_scc1 K2_G_BLK1
    s_waitcnt vmcnt(35)
    s_waitcnt vmcnt(31)
    v_mfma_f32_16x16x32_bf16 v[16:19], v[112:115], v[96:99], v[16:19]
    s_waitcnt vmcnt(30)
    v_mfma_f32_16x16x32_bf16 v[36:39], v[112:115], v[100:103], v[36:39]
    s_waitcnt vmcnt(29)
    v_mfma_f32_16x16x32_bf16 v[56:59], v[112:115], v[104:107], v[56:59]
    s_waitcnt vmcnt(28)
    v_mfma_f32_16x16x32_bf16 v[76:79], v[112:115], v[108:111], v[76:79]
    buffer_load_dwordx4 v[112:115], v8, s[44:47], s73 offen offset:0
    v_mfma_f32_16x16x32_bf16 v[20:23], v[116:119], v[96:99], v[20:23]
    v_mfma_f32_16x16x32_bf16 v[40:43], v[116:119], v[100:103], v[40:43]
    v_mfma_f32_16x16x32_bf16 v[60:63], v[116:119], v[104:107], v[60:63]
    v_mfma_f32_16x16x32_bf16 v[80:83], v[116:119], v[108:111], v[80:83]
    buffer_load_dwordx4 v[116:119], v9, s[44:47], s73 offen offset:0
    v_mfma_f32_16x16x32_bf16 v[24:27], v[120:123], v[96:99], v[24:27]
    v_mfma_f32_16x16x32_bf16 v[44:47], v[120:123], v[100:103], v[44:47]
    v_mfma_f32_16x16x32_bf16 v[64:67], v[120:123], v[104:107], v[64:67]
    v_mfma_f32_16x16x32_bf16 v[84:87], v[120:123], v[108:111], v[84:87]
    buffer_load_dwordx4 v[120:123], v10, s[44:47], s73 offen offset:0
    v_mfma_f32_16x16x32_bf16 v[28:31], v[124:127], v[96:99], v[28:31]
    v_mfma_f32_16x16x32_bf16 v[48:51], v[124:127], v[100:103], v[48:51]
    v_mfma_f32_16x16x32_bf16 v[68:71], v[124:127], v[104:107], v[68:71]
    v_mfma_f32_16x16x32_bf16 v[88:91], v[124:127], v[108:111], v[88:91]
    buffer_load_dwordx4 v[124:127], v11, s[44:47], s73 offen offset:0
    s_waitcnt vmcnt(31)
    v_mfma_f32_16x16x32_bf16 v[32:35], v[128:131], v[96:99], v[32:35]
    buffer_load_dwordx4 v[96:99], v4, s[44:47], s73 offen offset:0
    v_mfma_f32_16x16x32_bf16 v[52:55], v[128:131], v[100:103], v[52:55]
    buffer_load_dwordx4 v[100:103], v5, s[44:47], s73 offen offset:0
    v_mfma_f32_16x16x32_bf16 v[72:75], v[128:131], v[104:107], v[72:75]
    buffer_load_dwordx4 v[104:107], v6, s[44:47], s73 offen offset:0
    v_mfma_f32_16x16x32_bf16 v[92:95], v[128:131], v[108:111], v[92:95]
    buffer_load_dwordx4 v[108:111], v7, s[44:47], s73 offen offset:0
    buffer_load_dwordx4 v[128:131], v12, s[44:47], s73 offen offset:0
K2_G_BLK1:
    s_waitcnt vmcnt(35)
    s_waitcnt vmcnt(31)
    v_mfma_f32_16x16x32_bf16 v[16:19], v[148:151], v[132:135], v[16:19]
    s_waitcnt vmcnt(30)
    v_mfma_f32_16x16x32_bf16 v[36:39], v[148:151], v[136:139], v[36:39]
    s_waitcnt vmcnt(29)
    v_mfma_f32_16x16x32_bf16 v[56:59], v[148:151], v[140:143], v[56:59]
    s_waitcnt vmcnt(28)
    v_mfma_f32_16x16x32_bf16 v[76:79], v[148:151], v[144:147], v[76:79]
    buffer_load_dwordx4 v[148:151], v8, s[44:47], s73 offen offset:1024
    v_mfma_f32_16x16x32_bf16 v[20:23], v[152:155], v[132:135], v[20:23]
    v_mfma_f32_16x16x32_bf16 v[40:43], v[152:155], v[136:139], v[40:43]
    v_mfma_f32_16x16x32_bf16 v[60:63], v[152:155], v[140:143], v[60:63]
    v_mfma_f32_16x16x32_bf16 v[80:83], v[152:155], v[144:147], v[80:83]
    buffer_load_dwordx4 v[152:155], v9, s[44:47], s73 offen offset:1024
    v_mfma_f32_16x16x32_bf16 v[24:27], v[156:159], v[132:135], v[24:27]
    v_mfma_f32_16x16x32_bf16 v[44:47], v[156:159], v[136:139], v[44:47]
    v_mfma_f32_16x16x32_bf16 v[64:67], v[156:159], v[140:143], v[64:67]
    v_mfma_f32_16x16x32_bf16 v[84:87], v[156:159], v[144:147], v[84:87]
    buffer_load_dwordx4 v[156:159], v10, s[44:47], s73 offen offset:1024
    v_mfma_f32_16x16x32_bf16 v[28:31], v[160:163], v[132:135], v[28:31]
    v_mfma_f32_16x16x32_bf16 v[48:51], v[160:163], v[136:139], v[48:51]
    v_mfma_f32_16x16x32_bf16 v[68:71], v[160:163], v[140:143], v[68:71]
    v_mfma_f32_16x16x32_bf16 v[88:91], v[160:163], v[144:147], v[88:91]
    buffer_load_dwordx4 v[160:163], v11, s[44:47], s73 offen offset:1024
    s_waitcnt vmcnt(31)
    v_mfma_f32_16x16x32_bf16 v[32:35], v[164:167], v[132:135], v[32:35]
    buffer_load_dwordx4 v[132:135], v4, s[44:47], s73 offen offset:1024
    v_mfma_f32_16x16x32_bf16 v[52:55], v[164:167], v[136:139], v[52:55]
    buffer_load_dwordx4 v[136:139], v5, s[44:47], s73 offen offset:1024
    v_mfma_f32_16x16x32_bf16 v[72:75], v[164:167], v[140:143], v[72:75]
    buffer_load_dwordx4 v[140:143], v6, s[44:47], s73 offen offset:1024
    v_mfma_f32_16x16x32_bf16 v[92:95], v[164:167], v[144:147], v[92:95]
    buffer_load_dwordx4 v[144:147], v7, s[44:47], s73 offen offset:1024
    buffer_load_dwordx4 v[164:167], v12, s[44:47], s73 offen offset:1024
    s_waitcnt vmcnt(35)
    s_waitcnt vmcnt(31)
    v_mfma_f32_16x16x32_bf16 v[16:19], v[184:187], v[168:171], v[16:19]
    s_waitcnt vmcnt(30)
    v_mfma_f32_16x16x32_bf16 v[36:39], v[184:187], v[172:175], v[36:39]
    s_waitcnt vmcnt(29)
    v_mfma_f32_16x16x32_bf16 v[56:59], v[184:187], v[176:179], v[56:59]
    s_waitcnt vmcnt(28)
    v_mfma_f32_16x16x32_bf16 v[76:79], v[184:187], v[180:183], v[76:79]
    buffer_load_dwordx4 v[184:187], v8, s[44:47], s73 offen offset:2048
    v_mfma_f32_16x16x32_bf16 v[20:23], v[188:191], v[168:171], v[20:23]
    v_mfma_f32_16x16x32_bf16 v[40:43], v[188:191], v[172:175], v[40:43]
    v_mfma_f32_16x16x32_bf16 v[60:63], v[188:191], v[176:179], v[60:63]
    v_mfma_f32_16x16x32_bf16 v[80:83], v[188:191], v[180:183], v[80:83]
    buffer_load_dwordx4 v[188:191], v9, s[44:47], s73 offen offset:2048
    v_mfma_f32_16x16x32_bf16 v[24:27], v[192:195], v[168:171], v[24:27]
    v_mfma_f32_16x16x32_bf16 v[44:47], v[192:195], v[172:175], v[44:47]
    v_mfma_f32_16x16x32_bf16 v[64:67], v[192:195], v[176:179], v[64:67]
    v_mfma_f32_16x16x32_bf16 v[84:87], v[192:195], v[180:183], v[84:87]
    buffer_load_dwordx4 v[192:195], v10, s[44:47], s73 offen offset:2048
    v_mfma_f32_16x16x32_bf16 v[28:31], v[196:199], v[168:171], v[28:31]
    v_mfma_f32_16x16x32_bf16 v[48:51], v[196:199], v[172:175], v[48:51]
    v_mfma_f32_16x16x32_bf16 v[68:71], v[196:199], v[176:179], v[68:71]
    v_mfma_f32_16x16x32_bf16 v[88:91], v[196:199], v[180:183], v[88:91]
    buffer_load_dwordx4 v[196:199], v11, s[44:47], s73 offen offset:2048
    s_waitcnt vmcnt(31)
    v_mfma_f32_16x16x32_bf16 v[32:35], v[200:203], v[168:171], v[32:35]
    buffer_load_dwordx4 v[168:171], v4, s[44:47], s73 offen offset:2048
    v_mfma_f32_16x16x32_bf16 v[52:55], v[200:203], v[172:175], v[52:55]
    buffer_load_dwordx4 v[172:175], v5, s[44:47], s73 offen offset:2048
    v_mfma_f32_16x16x32_bf16 v[72:75], v[200:203], v[176:179], v[72:75]
    buffer_load_dwordx4 v[176:179], v6, s[44:47], s73 offen offset:2048
    v_mfma_f32_16x16x32_bf16 v[92:95], v[200:203], v[180:183], v[92:95]
    buffer_load_dwordx4 v[180:183], v7, s[44:47], s73 offen offset:2048
    buffer_load_dwordx4 v[200:203], v12, s[44:47], s73 offen offset:2048
    s_waitcnt vmcnt(35)
    s_waitcnt vmcnt(31)
    v_mfma_f32_16x16x32_bf16 v[16:19], v[220:223], v[204:207], v[16:19]
    s_waitcnt vmcnt(30)
    v_mfma_f32_16x16x32_bf16 v[36:39], v[220:223], v[208:211], v[36:39]
    s_waitcnt vmcnt(29)
    v_mfma_f32_16x16x32_bf16 v[56:59], v[220:223], v[212:215], v[56:59]
    s_waitcnt vmcnt(28)
    v_mfma_f32_16x16x32_bf16 v[76:79], v[220:223], v[216:219], v[76:79]
    buffer_load_dwordx4 v[220:223], v8, s[44:47], s73 offen offset:3072
    v_mfma_f32_16x16x32_bf16 v[20:23], v[224:227], v[204:207], v[20:23]
    v_mfma_f32_16x16x32_bf16 v[40:43], v[224:227], v[208:211], v[40:43]
    v_mfma_f32_16x16x32_bf16 v[60:63], v[224:227], v[212:215], v[60:63]
    v_mfma_f32_16x16x32_bf16 v[80:83], v[224:227], v[216:219], v[80:83]
    buffer_load_dwordx4 v[224:227], v9, s[44:47], s73 offen offset:3072
    v_mfma_f32_16x16x32_bf16 v[24:27], v[228:231], v[204:207], v[24:27]
    v_mfma_f32_16x16x32_bf16 v[44:47], v[228:231], v[208:211], v[44:47]
    v_mfma_f32_16x16x32_bf16 v[64:67], v[228:231], v[212:215], v[64:67]
    v_mfma_f32_16x16x32_bf16 v[84:87], v[228:231], v[216:219], v[84:87]
    buffer_load_dwordx4 v[228:231], v10, s[44:47], s73 offen offset:3072
    v_mfma_f32_16x16x32_bf16 v[28:31], v[232:235], v[204:207], v[28:31]
    v_mfma_f32_16x16x32_bf16 v[48:51], v[232:235], v[208:211], v[48:51]
    v_mfma_f32_16x16x32_bf16 v[68:71], v[232:235], v[212:215], v[68:71]
    v_mfma_f32_16x16x32_bf16 v[88:91], v[232:235], v[216:219], v[88:91]
    buffer_load_dwordx4 v[232:235], v11, s[44:47], s73 offen offset:3072
    s_waitcnt vmcnt(31)
    v_mfma_f32_16x16x32_bf16 v[32:35], v[236:239], v[204:207], v[32:35]
    buffer_load_dwordx4 v[204:207], v4, s[44:47], s73 offen offset:3072
    v_mfma_f32_16x16x32_bf16 v[52:55], v[236:239], v[208:211], v[52:55]
    buffer_load_dwordx4 v[208:211], v5, s[44:47], s73 offen offset:3072
    v_mfma_f32_16x16x32_bf16 v[72:75], v[236:239], v[212:215], v[72:75]
    buffer_load_dwordx4 v[212:215], v6, s[44:47], s73 offen offset:3072
    v_mfma_f32_16x16x32_bf16 v[92:95], v[236:239], v[216:219], v[92:95]
    buffer_load_dwordx4 v[216:219], v7, s[44:47], s73 offen offset:3072
    buffer_load_dwordx4 v[236:239], v12, s[44:47], s73 offen offset:3072
    s_waitcnt vmcnt(35)
    s_waitcnt vmcnt(31)
    v_mfma_f32_16x16x32_bf16 v[16:19], v[112:115], v[96:99], v[16:19]
    s_waitcnt vmcnt(30)
    v_mfma_f32_16x16x32_bf16 v[36:39], v[112:115], v[100:103], v[36:39]
    s_waitcnt vmcnt(29)
    v_mfma_f32_16x16x32_bf16 v[56:59], v[112:115], v[104:107], v[56:59]
    s_waitcnt vmcnt(28)
    v_mfma_f32_16x16x32_bf16 v[76:79], v[112:115], v[108:111], v[76:79]
    buffer_load_dwordx4 v[112:115], v8, s[44:47], s74 offen offset:0
    v_mfma_f32_16x16x32_bf16 v[20:23], v[116:119], v[96:99], v[20:23]
    v_mfma_f32_16x16x32_bf16 v[40:43], v[116:119], v[100:103], v[40:43]
    v_mfma_f32_16x16x32_bf16 v[60:63], v[116:119], v[104:107], v[60:63]
    v_mfma_f32_16x16x32_bf16 v[80:83], v[116:119], v[108:111], v[80:83]
    buffer_load_dwordx4 v[116:119], v9, s[44:47], s74 offen offset:0
    v_mfma_f32_16x16x32_bf16 v[24:27], v[120:123], v[96:99], v[24:27]
    v_mfma_f32_16x16x32_bf16 v[44:47], v[120:123], v[100:103], v[44:47]
    v_mfma_f32_16x16x32_bf16 v[64:67], v[120:123], v[104:107], v[64:67]
    v_mfma_f32_16x16x32_bf16 v[84:87], v[120:123], v[108:111], v[84:87]
    buffer_load_dwordx4 v[120:123], v10, s[44:47], s74 offen offset:0
    v_mfma_f32_16x16x32_bf16 v[28:31], v[124:127], v[96:99], v[28:31]
    v_mfma_f32_16x16x32_bf16 v[48:51], v[124:127], v[100:103], v[48:51]
    v_mfma_f32_16x16x32_bf16 v[68:71], v[124:127], v[104:107], v[68:71]
    v_mfma_f32_16x16x32_bf16 v[88:91], v[124:127], v[108:111], v[88:91]
    buffer_load_dwordx4 v[124:127], v11, s[44:47], s74 offen offset:0
    s_waitcnt vmcnt(31)
    v_mfma_f32_16x16x32_bf16 v[32:35], v[128:131], v[96:99], v[32:35]
    buffer_load_dwordx4 v[96:99], v4, s[44:47], s74 offen offset:0
    v_mfma_f32_16x16x32_bf16 v[52:55], v[128:131], v[100:103], v[52:55]
    buffer_load_dwordx4 v[100:103], v5, s[44:47], s74 offen offset:0
    v_mfma_f32_16x16x32_bf16 v[72:75], v[128:131], v[104:107], v[72:75]
    buffer_load_dwordx4 v[104:107], v6, s[44:47], s74 offen offset:0
    v_mfma_f32_16x16x32_bf16 v[92:95], v[128:131], v[108:111], v[92:95]
    buffer_load_dwordx4 v[108:111], v7, s[44:47], s74 offen offset:0
    buffer_load_dwordx4 v[128:131], v12, s[44:47], s74 offen offset:0
    s_waitcnt vmcnt(35)
    s_waitcnt vmcnt(31)
    v_mfma_f32_16x16x32_bf16 v[16:19], v[148:151], v[132:135], v[16:19]
    s_waitcnt vmcnt(30)
    v_mfma_f32_16x16x32_bf16 v[36:39], v[148:151], v[136:139], v[36:39]
    s_waitcnt vmcnt(29)
    v_mfma_f32_16x16x32_bf16 v[56:59], v[148:151], v[140:143], v[56:59]
    s_waitcnt vmcnt(28)
    v_mfma_f32_16x16x32_bf16 v[76:79], v[148:151], v[144:147], v[76:79]
    buffer_load_dwordx4 v[148:151], v8, s[44:47], s74 offen offset:1024
    v_mfma_f32_16x16x32_bf16 v[20:23], v[152:155], v[132:135], v[20:23]
    v_mfma_f32_16x16x32_bf16 v[40:43], v[152:155], v[136:139], v[40:43]
    v_mfma_f32_16x16x32_bf16 v[60:63], v[152:155], v[140:143], v[60:63]
    v_mfma_f32_16x16x32_bf16 v[80:83], v[152:155], v[144:147], v[80:83]
    buffer_load_dwordx4 v[152:155], v9, s[44:47], s74 offen offset:1024
    v_mfma_f32_16x16x32_bf16 v[24:27], v[156:159], v[132:135], v[24:27]
    v_mfma_f32_16x16x32_bf16 v[44:47], v[156:159], v[136:139], v[44:47]
    v_mfma_f32_16x16x32_bf16 v[64:67], v[156:159], v[140:143], v[64:67]
    v_mfma_f32_16x16x32_bf16 v[84:87], v[156:159], v[144:147], v[84:87]
    buffer_load_dwordx4 v[156:159], v10, s[44:47], s74 offen offset:1024
    v_mfma_f32_16x16x32_bf16 v[28:31], v[160:163], v[132:135], v[28:31]
    v_mfma_f32_16x16x32_bf16 v[48:51], v[160:163], v[136:139], v[48:51]
    v_mfma_f32_16x16x32_bf16 v[68:71], v[160:163], v[140:143], v[68:71]
    v_mfma_f32_16x16x32_bf16 v[88:91], v[160:163], v[144:147], v[88:91]
    buffer_load_dwordx4 v[160:163], v11, s[44:47], s74 offen offset:1024
    s_waitcnt vmcnt(31)
    v_mfma_f32_16x16x32_bf16 v[32:35], v[164:167], v[132:135], v[32:35]
    buffer_load_dwordx4 v[132:135], v4, s[44:47], s74 offen offset:1024
    v_mfma_f32_16x16x32_bf16 v[52:55], v[164:167], v[136:139], v[52:55]
    buffer_load_dwordx4 v[136:139], v5, s[44:47], s74 offen offset:1024
    v_mfma_f32_16x16x32_bf16 v[72:75], v[164:167], v[140:143], v[72:75]
    buffer_load_dwordx4 v[140:143], v6, s[44:47], s74 offen offset:1024
    v_mfma_f32_16x16x32_bf16 v[92:95], v[164:167], v[144:147], v[92:95]
    buffer_load_dwordx4 v[144:147], v7, s[44:47], s74 offen offset:1024
    buffer_load_dwordx4 v[164:167], v12, s[44:47], s74 offen offset:1024
    s_waitcnt vmcnt(35)
    s_waitcnt vmcnt(31)
    v_mfma_f32_16x16x32_bf16 v[16:19], v[184:187], v[168:171], v[16:19]
    s_waitcnt vmcnt(30)
    v_mfma_f32_16x16x32_bf16 v[36:39], v[184:187], v[172:175], v[36:39]
    s_waitcnt vmcnt(29)
    v_mfma_f32_16x16x32_bf16 v[56:59], v[184:187], v[176:179], v[56:59]
    s_waitcnt vmcnt(28)
    v_mfma_f32_16x16x32_bf16 v[76:79], v[184:187], v[180:183], v[76:79]
    buffer_load_dwordx4 v[184:187], v8, s[44:47], s74 offen offset:2048
    v_mfma_f32_16x16x32_bf16 v[20:23], v[188:191], v[168:171], v[20:23]
    v_mfma_f32_16x16x32_bf16 v[40:43], v[188:191], v[172:175], v[40:43]
    v_mfma_f32_16x16x32_bf16 v[60:63], v[188:191], v[176:179], v[60:63]
    v_mfma_f32_16x16x32_bf16 v[80:83], v[188:191], v[180:183], v[80:83]
    buffer_load_dwordx4 v[188:191], v9, s[44:47], s74 offen offset:2048
    v_mfma_f32_16x16x32_bf16 v[24:27], v[192:195], v[168:171], v[24:27]
    v_mfma_f32_16x16x32_bf16 v[44:47], v[192:195], v[172:175], v[44:47]
    v_mfma_f32_16x16x32_bf16 v[64:67], v[192:195], v[176:179], v[64:67]
    v_mfma_f32_16x16x32_bf16 v[84:87], v[192:195], v[180:183], v[84:87]
    buffer_load_dwordx4 v[192:195], v10, s[44:47], s74 offen offset:2048
    v_mfma_f32_16x16x32_bf16 v[28:31], v[196:199], v[168:171], v[28:31]
    v_mfma_f32_16x16x32_bf16 v[48:51], v[196:199], v[172:175], v[48:51]
    v_mfma_f32_16x16x32_bf16 v[68:71], v[196:199], v[176:179], v[68:71]
    v_mfma_f32_16x16x32_bf16 v[88:91], v[196:199], v[180:183], v[88:91]
    buffer_load_dwordx4 v[196:199], v11, s[44:47], s74 offen offset:2048
    s_waitcnt vmcnt(31)
    v_mfma_f32_16x16x32_bf16 v[32:35], v[200:203], v[168:171], v[32:35]
    buffer_load_dwordx4 v[168:171], v4, s[44:47], s74 offen offset:2048
    v_mfma_f32_16x16x32_bf16 v[52:55], v[200:203], v[172:175], v[52:55]
    buffer_load_dwordx4 v[172:175], v5, s[44:47], s74 offen offset:2048
    v_mfma_f32_16x16x32_bf16 v[72:75], v[200:203], v[176:179], v[72:75]
    buffer_load_dwordx4 v[176:179], v6, s[44:47], s74 offen offset:2048
    v_mfma_f32_16x16x32_bf16 v[92:95], v[200:203], v[180:183], v[92:95]
    buffer_load_dwordx4 v[180:183], v7, s[44:47], s74 offen offset:2048
    buffer_load_dwordx4 v[200:203], v12, s[44:47], s74 offen offset:2048
    s_waitcnt vmcnt(35)
    s_waitcnt vmcnt(31)
    v_mfma_f32_16x16x32_bf16 v[16:19], v[220:223], v[204:207], v[16:19]
    s_waitcnt vmcnt(30)
    v_mfma_f32_16x16x32_bf16 v[36:39], v[220:223], v[208:211], v[36:39]
    s_waitcnt vmcnt(29)
    v_mfma_f32_16x16x32_bf16 v[56:59], v[220:223], v[212:215], v[56:59]
    s_waitcnt vmcnt(28)
    v_mfma_f32_16x16x32_bf16 v[76:79], v[220:223], v[216:219], v[76:79]
    buffer_load_dwordx4 v[220:223], v8, s[44:47], s74 offen offset:3072
    v_mfma_f32_16x16x32_bf16 v[20:23], v[224:227], v[204:207], v[20:23]
    v_mfma_f32_16x16x32_bf16 v[40:43], v[224:227], v[208:211], v[40:43]
    v_mfma_f32_16x16x32_bf16 v[60:63], v[224:227], v[212:215], v[60:63]
    v_mfma_f32_16x16x32_bf16 v[80:83], v[224:227], v[216:219], v[80:83]
    buffer_load_dwordx4 v[224:227], v9, s[44:47], s74 offen offset:3072
    v_mfma_f32_16x16x32_bf16 v[24:27], v[228:231], v[204:207], v[24:27]
    v_mfma_f32_16x16x32_bf16 v[44:47], v[228:231], v[208:211], v[44:47]
    v_mfma_f32_16x16x32_bf16 v[64:67], v[228:231], v[212:215], v[64:67]
    v_mfma_f32_16x16x32_bf16 v[84:87], v[228:231], v[216:219], v[84:87]
    buffer_load_dwordx4 v[228:231], v10, s[44:47], s74 offen offset:3072
    v_mfma_f32_16x16x32_bf16 v[28:31], v[232:235], v[204:207], v[28:31]
    v_mfma_f32_16x16x32_bf16 v[48:51], v[232:235], v[208:211], v[48:51]
    v_mfma_f32_16x16x32_bf16 v[68:71], v[232:235], v[212:215], v[68:71]
    v_mfma_f32_16x16x32_bf16 v[88:91], v[232:235], v[216:219], v[88:91]
    buffer_load_dwordx4 v[232:235], v11, s[44:47], s74 offen offset:3072
    s_waitcnt vmcnt(31)
    v_mfma_f32_16x16x32_bf16 v[32:35], v[236:239], v[204:207], v[32:35]
    buffer_load_dwordx4 v[204:207], v4, s[44:47], s74 offen offset:3072
    v_mfma_f32_16x16x32_bf16 v[52:55], v[236:239], v[208:211], v[52:55]
    buffer_load_dwordx4 v[208:211], v5, s[44:47], s74 offen offset:3072
    v_mfma_f32_16x16x32_bf16 v[72:75], v[236:239], v[212:215], v[72:75]
    buffer_load_dwordx4 v[212:215], v6, s[44:47], s74 offen offset:3072
    v_mfma_f32_16x16x32_bf16 v[92:95], v[236:239], v[216:219], v[92:95]
    buffer_load_dwordx4 v[216:219], v7, s[44:47], s74 offen offset:3072
    buffer_load_dwordx4 v[236:239], v12, s[44:47], s74 offen offset:3072
    s_waitcnt vmcnt(35)
    s_waitcnt vmcnt(31)
    v_mfma_f32_16x16x32_bf16 v[16:19], v[112:115], v[96:99], v[16:19]
    s_waitcnt vmcnt(30)
    v_mfma_f32_16x16x32_bf16 v[36:39], v[112:115], v[100:103], v[36:39]
    s_waitcnt vmcnt(29)
    v_mfma_f32_16x16x32_bf16 v[56:59], v[112:115], v[104:107], v[56:59]
    s_waitcnt vmcnt(28)
    v_mfma_f32_16x16x32_bf16 v[76:79], v[112:115], v[108:111], v[76:79]
    buffer_load_dwordx4 v[112:115], v8, s[44:47], s75 offen offset:0
    v_mfma_f32_16x16x32_bf16 v[20:23], v[116:119], v[96:99], v[20:23]
    v_mfma_f32_16x16x32_bf16 v[40:43], v[116:119], v[100:103], v[40:43]
    v_mfma_f32_16x16x32_bf16 v[60:63], v[116:119], v[104:107], v[60:63]
    v_mfma_f32_16x16x32_bf16 v[80:83], v[116:119], v[108:111], v[80:83]
    buffer_load_dwordx4 v[116:119], v9, s[44:47], s75 offen offset:0
    v_mfma_f32_16x16x32_bf16 v[24:27], v[120:123], v[96:99], v[24:27]
    v_mfma_f32_16x16x32_bf16 v[44:47], v[120:123], v[100:103], v[44:47]
    v_mfma_f32_16x16x32_bf16 v[64:67], v[120:123], v[104:107], v[64:67]
    v_mfma_f32_16x16x32_bf16 v[84:87], v[120:123], v[108:111], v[84:87]
    buffer_load_dwordx4 v[120:123], v10, s[44:47], s75 offen offset:0
    v_mfma_f32_16x16x32_bf16 v[28:31], v[124:127], v[96:99], v[28:31]
    v_mfma_f32_16x16x32_bf16 v[48:51], v[124:127], v[100:103], v[48:51]
    v_mfma_f32_16x16x32_bf16 v[68:71], v[124:127], v[104:107], v[68:71]
    v_mfma_f32_16x16x32_bf16 v[88:91], v[124:127], v[108:111], v[88:91]
    buffer_load_dwordx4 v[124:127], v11, s[44:47], s75 offen offset:0
    s_waitcnt vmcnt(31)
    v_mfma_f32_16x16x32_bf16 v[32:35], v[128:131], v[96:99], v[32:35]
    buffer_load_dwordx4 v[96:99], v4, s[44:47], s75 offen offset:0
    v_mfma_f32_16x16x32_bf16 v[52:55], v[128:131], v[100:103], v[52:55]
    buffer_load_dwordx4 v[100:103], v5, s[44:47], s75 offen offset:0
    v_mfma_f32_16x16x32_bf16 v[72:75], v[128:131], v[104:107], v[72:75]
    buffer_load_dwordx4 v[104:107], v6, s[44:47], s75 offen offset:0
    v_mfma_f32_16x16x32_bf16 v[92:95], v[128:131], v[108:111], v[92:95]
    buffer_load_dwordx4 v[108:111], v7, s[44:47], s75 offen offset:0
    buffer_load_dwordx4 v[128:131], v12, s[44:47], s75 offen offset:0
    s_waitcnt vmcnt(35)
    s_waitcnt vmcnt(31)
    v_mfma_f32_16x16x32_bf16 v[16:19], v[148:151], v[132:135], v[16:19]
    s_waitcnt vmcnt(30)
    v_mfma_f32_16x16x32_bf16 v[36:39], v[148:151], v[136:139], v[36:39]
    s_waitcnt vmcnt(29)
    v_mfma_f32_16x16x32_bf16 v[56:59], v[148:151], v[140:143], v[56:59]
    s_waitcnt vmcnt(28)
    v_mfma_f32_16x16x32_bf16 v[76:79], v[148:151], v[144:147], v[76:79]
    buffer_load_dwordx4 v[148:151], v8, s[44:47], s75 offen offset:1024
    v_mfma_f32_16x16x32_bf16 v[20:23], v[152:155], v[132:135], v[20:23]
    v_mfma_f32_16x16x32_bf16 v[40:43], v[152:155], v[136:139], v[40:43]
    v_mfma_f32_16x16x32_bf16 v[60:63], v[152:155], v[140:143], v[60:63]
    v_mfma_f32_16x16x32_bf16 v[80:83], v[152:155], v[144:147], v[80:83]
    buffer_load_dwordx4 v[152:155], v9, s[44:47], s75 offen offset:1024
    v_mfma_f32_16x16x32_bf16 v[24:27], v[156:159], v[132:135], v[24:27]
    v_mfma_f32_16x16x32_bf16 v[44:47], v[156:159], v[136:139], v[44:47]
    v_mfma_f32_16x16x32_bf16 v[64:67], v[156:159], v[140:143], v[64:67]
    v_mfma_f32_16x16x32_bf16 v[84:87], v[156:159], v[144:147], v[84:87]
    buffer_load_dwordx4 v[156:159], v10, s[44:47], s75 offen offset:1024
    v_mfma_f32_16x16x32_bf16 v[28:31], v[160:163], v[132:135], v[28:31]
    v_mfma_f32_16x16x32_bf16 v[48:51], v[160:163], v[136:139], v[48:51]
    v_mfma_f32_16x16x32_bf16 v[68:71], v[160:163], v[140:143], v[68:71]
    v_mfma_f32_16x16x32_bf16 v[88:91], v[160:163], v[144:147], v[88:91]
    buffer_load_dwordx4 v[160:163], v11, s[44:47], s75 offen offset:1024
    s_waitcnt vmcnt(31)
    v_mfma_f32_16x16x32_bf16 v[32:35], v[164:167], v[132:135], v[32:35]
    buffer_load_dwordx4 v[132:135], v4, s[44:47], s75 offen offset:1024
    v_mfma_f32_16x16x32_bf16 v[52:55], v[164:167], v[136:139], v[52:55]
    buffer_load_dwordx4 v[136:139], v5, s[44:47], s75 offen offset:1024
    v_mfma_f32_16x16x32_bf16 v[72:75], v[164:167], v[140:143], v[72:75]
    buffer_load_dwordx4 v[140:143], v6, s[44:47], s75 offen offset:1024
    v_mfma_f32_16x16x32_bf16 v[92:95], v[164:167], v[144:147], v[92:95]
    buffer_load_dwordx4 v[144:147], v7, s[44:47], s75 offen offset:1024
    buffer_load_dwordx4 v[164:167], v12, s[44:47], s75 offen offset:1024
    s_mov_b64 exec, 1
    ds_write_b32 v242, v243
    s_mov_b64 exec, -1
    s_waitcnt vmcnt(35)
    s_waitcnt vmcnt(31)
    v_mfma_f32_16x16x32_bf16 v[16:19], v[184:187], v[168:171], v[16:19]
    s_waitcnt vmcnt(30)
    v_mfma_f32_16x16x32_bf16 v[36:39], v[184:187], v[172:175], v[36:39]
    s_waitcnt vmcnt(29)
    v_mfma_f32_16x16x32_bf16 v[56:59], v[184:187], v[176:179], v[56:59]
    s_waitcnt vmcnt(28)
    v_mfma_f32_16x16x32_bf16 v[76:79], v[184:187], v[180:183], v[76:79]
    v_mfma_f32_16x16x32_bf16 v[20:23], v[188:191], v[168:171], v[20:23]
    v_mfma_f32_16x16x32_bf16 v[40:43], v[188:191], v[172:175], v[40:43]
    v_mfma_f32_16x16x32_bf16 v[60:63], v[188:191], v[176:179], v[60:63]
    v_mfma_f32_16x16x32_bf16 v[80:83], v[188:191], v[180:183], v[80:83]
    v_mfma_f32_16x16x32_bf16 v[24:27], v[192:195], v[168:171], v[24:27]
    v_mfma_f32_16x16x32_bf16 v[44:47], v[192:195], v[172:175], v[44:47]
    v_mfma_f32_16x16x32_bf16 v[64:67], v[192:195], v[176:179], v[64:67]
    v_mfma_f32_16x16x32_bf16 v[84:87], v[192:195], v[180:183], v[84:87]
    v_mfma_f32_16x16x32_bf16 v[28:31], v[196:199], v[168:171], v[28:31]
    v_mfma_f32_16x16x32_bf16 v[48:51], v[196:199], v[172:175], v[48:51]
    v_mfma_f32_16x16x32_bf16 v[68:71], v[196:199], v[176:179], v[68:71]
    v_mfma_f32_16x16x32_bf16 v[88:91], v[196:199], v[180:183], v[88:91]
    s_waitcnt vmcnt(27)
    v_mfma_f32_16x16x32_bf16 v[32:35], v[200:203], v[168:171], v[32:35]
    v_mfma_f32_16x16x32_bf16 v[52:55], v[200:203], v[172:175], v[52:55]
    v_mfma_f32_16x16x32_bf16 v[72:75], v[200:203], v[176:179], v[72:75]
    v_mfma_f32_16x16x32_bf16 v[92:95], v[200:203], v[180:183], v[92:95]
    s_waitcnt vmcnt(26)
    s_waitcnt vmcnt(22)
    v_mfma_f32_16x16x32_bf16 v[16:19], v[220:223], v[204:207], v[16:19]
    s_waitcnt vmcnt(21)
    v_mfma_f32_16x16x32_bf16 v[36:39], v[220:223], v[208:211], v[36:39]
    s_waitcnt vmcnt(20)
    v_mfma_f32_16x16x32_bf16 v[56:59], v[220:223], v[212:215], v[56:59]
    s_waitcnt vmcnt(19)
    v_mfma_f32_16x16x32_bf16 v[76:79], v[220:223], v[216:219], v[76:79]
    v_mfma_f32_16x16x32_bf16 v[20:23], v[224:227], v[204:207], v[20:23]
    v_mfma_f32_16x16x32_bf16 v[40:43], v[224:227], v[208:211], v[40:43]
    v_mfma_f32_16x16x32_bf16 v[60:63], v[224:227], v[212:215], v[60:63]
    v_mfma_f32_16x16x32_bf16 v[80:83], v[224:227], v[216:219], v[80:83]
    v_mfma_f32_16x16x32_bf16 v[24:27], v[228:231], v[204:207], v[24:27]
    v_mfma_f32_16x16x32_bf16 v[44:47], v[228:231], v[208:211], v[44:47]
    v_mfma_f32_16x16x32_bf16 v[64:67], v[228:231], v[212:215], v[64:67]
    v_mfma_f32_16x16x32_bf16 v[84:87], v[228:231], v[216:219], v[84:87]
    v_mfma_f32_16x16x32_bf16 v[28:31], v[232:235], v[204:207], v[28:31]
    v_mfma_f32_16x16x32_bf16 v[48:51], v[232:235], v[208:211], v[48:51]
    v_mfma_f32_16x16x32_bf16 v[68:71], v[232:235], v[212:215], v[68:71]
    v_mfma_f32_16x16x32_bf16 v[88:91], v[232:235], v[216:219], v[88:91]
    s_waitcnt vmcnt(18)
    v_mfma_f32_16x16x32_bf16 v[32:35], v[236:239], v[204:207], v[32:35]
    v_mfma_f32_16x16x32_bf16 v[52:55], v[236:239], v[208:211], v[52:55]
    v_mfma_f32_16x16x32_bf16 v[72:75], v[236:239], v[212:215], v[72:75]
    v_mfma_f32_16x16x32_bf16 v[92:95], v[236:239], v[216:219], v[92:95]
    s_waitcnt vmcnt(17)
    s_waitcnt vmcnt(13)
    v_mfma_f32_16x16x32_bf16 v[16:19], v[112:115], v[96:99], v[16:19]
    s_waitcnt vmcnt(12)
    v_mfma_f32_16x16x32_bf16 v[36:39], v[112:115], v[100:103], v[36:39]
    s_waitcnt vmcnt(11)
    v_mfma_f32_16x16x32_bf16 v[56:59], v[112:115], v[104:107], v[56:59]
    s_waitcnt vmcnt(10)
    v_mfma_f32_16x16x32_bf16 v[76:79], v[112:115], v[108:111], v[76:79]
    v_mfma_f32_16x16x32_bf16 v[20:23], v[116:119], v[96:99], v[20:23]
    v_mfma_f32_16x16x32_bf16 v[40:43], v[116:119], v[100:103], v[40:43]
    v_mfma_f32_16x16x32_bf16 v[60:63], v[116:119], v[104:107], v[60:63]
    v_mfma_f32_16x16x32_bf16 v[80:83], v[116:119], v[108:111], v[80:83]
    v_mfma_f32_16x16x32_bf16 v[24:27], v[120:123], v[96:99], v[24:27]
    v_mfma_f32_16x16x32_bf16 v[44:47], v[120:123], v[100:103], v[44:47]
    v_mfma_f32_16x16x32_bf16 v[64:67], v[120:123], v[104:107], v[64:67]
    v_mfma_f32_16x16x32_bf16 v[84:87], v[120:123], v[108:111], v[84:87]
    v_mfma_f32_16x16x32_bf16 v[28:31], v[124:127], v[96:99], v[28:31]
    v_mfma_f32_16x16x32_bf16 v[48:51], v[124:127], v[100:103], v[48:51]
    v_mfma_f32_16x16x32_bf16 v[68:71], v[124:127], v[104:107], v[68:71]
    v_mfma_f32_16x16x32_bf16 v[88:91], v[124:127], v[108:111], v[88:91]
    s_waitcnt vmcnt(9)
    v_mfma_f32_16x16x32_bf16 v[32:35], v[128:131], v[96:99], v[32:35]
    v_mfma_f32_16x16x32_bf16 v[52:55], v[128:131], v[100:103], v[52:55]
    v_mfma_f32_16x16x32_bf16 v[72:75], v[128:131], v[104:107], v[72:75]
    v_mfma_f32_16x16x32_bf16 v[92:95], v[128:131], v[108:111], v[92:95]
    s_waitcnt vmcnt(8)
    s_waitcnt vmcnt(3)
    v_mfma_f32_16x16x32_bf16 v[36:39], v[148:151], v[136:139], v[36:39]
    v_mfma_f32_16x16x32_bf16 v[40:43], v[152:155], v[136:139], v[40:43]
    v_mfma_f32_16x16x32_bf16 v[44:47], v[156:159], v[136:139], v[44:47]
    s_nop 5
    ds_write_b128 v1, v[36:39] offset:0
    v_mfma_f32_16x16x32_bf16 v[48:51], v[160:163], v[136:139], v[48:51]
    ds_write_b128 v1, v[40:43] offset:1024
    s_waitcnt vmcnt(0)
    v_mfma_f32_16x16x32_bf16 v[52:55], v[164:167], v[136:139], v[52:55]
    ds_write_b128 v1, v[44:47] offset:2048
    v_mfma_f32_16x16x32_bf16 v[56:59], v[148:151], v[140:143], v[56:59]
    s_nop 2
    ds_write_b128 v1, v[48:51] offset:3072
    v_mfma_f32_16x16x32_bf16 v[60:63], v[152:155], v[140:143], v[60:63]
    s_nop 0
    ds_write_b128 v1, v[52:55] offset:4096
    v_mfma_f32_16x16x32_bf16 v[64:67], v[156:159], v[140:143], v[64:67]
    ds_write_b128 v2, v[56:59] offset:0
    v_mfma_f32_16x16x32_bf16 v[68:71], v[160:163], v[140:143], v[68:71]
    s_nop 2
    ds_write_b128 v2, v[60:63] offset:1024
    v_mfma_f32_16x16x32_bf16 v[72:75], v[164:167], v[140:143], v[72:75]
    s_nop 0
    ds_write_b128 v2, v[64:67] offset:2048
    v_mfma_f32_16x16x32_bf16 v[76:79], v[148:151], v[144:147], v[76:79]
    ds_write_b128 v2, v[68:71] offset:3072
    v_mfma_f32_16x16x32_bf16 v[80:83], v[152:155], v[144:147], v[80:83]
    s_nop 2
    ds_write_b128 v2, v[72:75] offset:4096
    v_mfma_f32_16x16x32_bf16 v[84:87], v[156:159], v[144:147], v[84:87]
    s_nop 0
    ds_write_b128 v3, v[76:79] offset:0
    v_mfma_f32_16x16x32_bf16 v[88:91], v[160:163], v[144:147], v[88:91]
    ds_write_b128 v3, v[80:83] offset:1024
    v_mfma_f32_16x16x32_bf16 v[92:95], v[164:167], v[144:147], v[92:95]
    s_nop 2
    ds_write_b128 v3, v[84:87] offset:2048
    v_mfma_f32_16x16x32_bf16 v[16:19], v[148:151], v[132:135], v[16:19]
    s_nop 0
    ds_write_b128 v3, v[88:91] offset:3072
    v_mfma_f32_16x16x32_bf16 v[20:23], v[152:155], v[132:135], v[20:23]
    s_waitcnt lgkmcnt(14)
    ds_write_b128 v3, v[92:95] offset:4096
    v_mfma_f32_16x16x32_bf16 v[24:27], v[156:159], v[132:135], v[24:27]
    v_mfma_f32_16x16x32_bf16 v[28:31], v[160:163], v[132:135], v[28:31]
    v_mfma_f32_16x16x32_bf16 v[32:35], v[164:167], v[132:135], v[32:35]
    s_waitcnt lgkmcnt(0)
    s_barrier
    ds_read_b128 v[96:99], v14 offset:0
    ds_read_b128 v[100:103], v14 offset:5120
    ds_read_b128 v[104:107], v14 offset:10240
    ds_read_b128 v[108:111], v15 offset:0
    ds_read_b128 v[112:115], v14 offset:1024
    ds_read_b128 v[116:119], v14 offset:6144
    ds_read_b128 v[120:123], v14 offset:11264
    ds_read_b128 v[124:127], v15 offset:4096
    ds_read_b128 v[128:131], v14 offset:2048
    ds_read_b128 v[132:135], v14 offset:7168
    ds_read_b128 v[136:139], v14 offset:12288
    ds_read_b128 v[140:143], v15 offset:8192
    s_waitcnt lgkmcnt(8)
    ds_read_b128 v[144:147], v14 offset:3072
    ds_read_b128 v[148:151], v14 offset:8192
    ds_read_b128 v[152:155], v14 offset:13312
    ds_read_b128 v[156:159], v15 offset:12288
    v_pk_add_f32 v[96:97], v[96:97], v[100:101]
    v_pk_add_f32 v[104:105], v[104:105], v[108:109]
    v_pk_add_f32 v[98:99], v[98:99], v[102:103]
    v_pk_add_f32 v[106:107], v[106:107], v[110:111]
    v_pk_add_f32 v[16:17], v[16:17], v[96:97]
    v_pk_add_f32 v[18:19], v[18:19], v[98:99]
    v_pk_add_f32 v[16:17], v[16:17], v[104:105]
    v_pk_add_f32 v[18:19], v[18:19], v[106:107]
    v_cvt_pk_bf16_f32 v96, v16, v17
    v_cvt_pk_bf16_f32 v97, v18, v19
    buffer_store_dwordx2 v[96:97], v241, s[56:59], 0 offen offset:0
    s_waitcnt lgkmcnt(8)
    ds_read_b128 v[160:163], v14 offset:4096
    ds_read_b128 v[164:167], v14 offset:9216
    ds_read_b128 v[168:171], v14 offset:14336
    ds_read_b128 v[172:175], v15 offset:16384
    v_pk_add_f32 v[112:113], v[112:113], v[116:117]
    v_pk_add_f32 v[120:121], v[120:121], v[124:125]
    v_pk_add_f32 v[114:115], v[114:115], v[118:119]
    v_pk_add_f32 v[122:123], v[122:123], v[126:127]
    v_pk_add_f32 v[20:21], v[20:21], v[112:113]
    v_pk_add_f32 v[22:23], v[22:23], v[114:115]
    v_pk_add_f32 v[20:21], v[20:21], v[120:121]
    v_pk_add_f32 v[22:23], v[22:23], v[122:123]
    v_cvt_pk_bf16_f32 v112, v20, v21
    v_cvt_pk_bf16_f32 v113, v22, v23
    buffer_store_dwordx2 v[112:113], v241, s[56:59], 0 offen offset:32
    s_waitcnt lgkmcnt(8)
    v_pk_add_f32 v[128:129], v[128:129], v[132:133]
    v_pk_add_f32 v[136:137], v[136:137], v[140:141]
    v_pk_add_f32 v[130:131], v[130:131], v[134:135]
    v_pk_add_f32 v[138:139], v[138:139], v[142:143]
    v_pk_add_f32 v[24:25], v[24:25], v[128:129]
    v_pk_add_f32 v[26:27], v[26:27], v[130:131]
    v_pk_add_f32 v[24:25], v[24:25], v[136:137]
    v_pk_add_f32 v[26:27], v[26:27], v[138:139]
    v_cvt_pk_bf16_f32 v128, v24, v25
    v_cvt_pk_bf16_f32 v129, v26, v27
    buffer_store_dwordx2 v[128:129], v241, s[56:59], 0 offen offset:64
    s_waitcnt lgkmcnt(4)
    v_pk_add_f32 v[144:145], v[144:145], v[148:149]
    v_pk_add_f32 v[152:153], v[152:153], v[156:157]
    v_pk_add_f32 v[146:147], v[146:147], v[150:151]
    v_pk_add_f32 v[154:155], v[154:155], v[158:159]
    v_pk_add_f32 v[28:29], v[28:29], v[144:145]
    v_pk_add_f32 v[30:31], v[30:31], v[146:147]
    v_pk_add_f32 v[28:29], v[28:29], v[152:153]
    v_pk_add_f32 v[30:31], v[30:31], v[154:155]
    v_cvt_pk_bf16_f32 v144, v28, v29
    v_cvt_pk_bf16_f32 v145, v30, v31
    buffer_store_dwordx2 v[144:145], v241, s[56:59], 0 offen offset:96
    s_waitcnt lgkmcnt(0)
    v_pk_add_f32 v[160:161], v[160:161], v[164:165]
    v_pk_add_f32 v[168:169], v[168:169], v[172:173]
    v_pk_add_f32 v[162:163], v[162:163], v[166:167]
    v_pk_add_f32 v[170:171], v[170:171], v[174:175]
    v_pk_add_f32 v[32:33], v[32:33], v[160:161]
    v_pk_add_f32 v[34:35], v[34:35], v[162:163]
    v_pk_add_f32 v[32:33], v[32:33], v[168:169]
    v_pk_add_f32 v[34:35], v[34:35], v[170:171]
    v_cvt_pk_bf16_f32 v160, v32, v33
    v_cvt_pk_bf16_f32 v161, v34, v35
    buffer_store_dwordx2 v[160:161], v241, s[56:59], 0 offen offset:128
    s_endpgm
K2_CONV:
    s_setprio 1
    v_mov_b32 v249, 157952
    v_mov_b32 v250, 0
    v_mov_b32 v251, 0
    ds_write_b64 v249, v[250:251]
    s_sub_u32 s8, s3, 4
    s_lshr_b32 s9, s6, 1
    s_mul_i32 s9, s9, 5
    s_mul_i32 s10, s7, 80
    s_add_u32 s9, s9, s10
    s_add_u32 s11, s9, 2
    s_and_b32 s12, s6, 1
    s_mul_i32 s10, s12, 3
    s_add_u32 s9, s9, s10
    s_add_u32 s10, s9, 1
    v_lshlrev_b32 v13, 4, v0
    s_lshl_b32 s13, s8, 10
    v_add_u32 v14, s13, v13
    s_sub_u32 s14, s13, 8
    s_max_i32 s14, s14, 0
    s_lshl_b32 s72, s9, 12
    s_add_u32 s76, s72, s14
    s_lshl_b32 s80, s9, 1
    s_and_b32 s80, s80, 0xfffffffc
    s_lshl_b32 s73, s10, 12
    s_add_u32 s77, s73, s14
    s_lshl_b32 s81, s10, 1
    s_and_b32 s81, s81, 0xfffffffc
    s_lshl_b32 s74, s11, 12
    s_add_u32 s78, s74, s14
    s_lshl_b32 s82, s11, 1
    s_and_b32 s82, s82, 0xfffffffc
    s_waitcnt lgkmcnt(0)
    s_mov_b32 s52, s24
    s_and_b32 s53, s25, 0xffff
    s_mov_b32 s54, 0x280000
    s_mov_b32 s55, 0x20000
    buffer_load_dwordx4 v[16:19], v14, s[52:55], s72 offen
    buffer_load_dwordx4 v[36:39], v14, s[52:55], s73 offen
    buffer_load_dwordx4 v[56:59], v14, s[52:55], s74 offen
    s_mov_b32 s44, s40
    s_and_b32 s45, s41, 0xffff
    s_mov_b32 s46, 0x1000000
    s_mov_b32 s47, 0x20000
    s_add_u32 m0, s13, 16640
    s_add_u32 s72, s72, 0x940000
    buffer_load_dwordx4 v14, s[44:47], s72 offen lds
    s_add_u32 m0, s13, 37888
    s_add_u32 s73, s73, 0x940000
    buffer_load_dwordx4 v14, s[44:47], s73 offen lds
    s_add_u32 m0, s13, 59136
    s_add_u32 s74, s74, 0x940000
    buffer_load_dwordx4 v14, s[44:47], s74 offen lds
    s_load_dwordx2 s[84:85], s[24:25], s76
    s_load_dword s60, s[26:27], s80
    s_load_dwordx2 s[86:87], s[24:25], s77
    s_load_dword s61, s[26:27], s81
    s_load_dwordx2 s[88:89], s[24:25], s78
    s_load_dword s62, s[26:27], s82
    s_barrier
    s_mov_b32 s48, s16
    s_and_b32 s49, s17, 0xffff
    s_mov_b32 s50, 0x280000
    s_mov_b32 s51, 0x20000
    s_min_u32 s14, s8, 2
    s_mul_i32 s14, s14, 21248
    v_bfe_u32 v8, v0, 1, 2
    v_mul_u32_u24 v8, 4160, v8
    v_and_b32 v9, 1, v0
    v_lshl_add_u32 v8, v9, 4, v8
    v_add_u32 v9, 20736, v13
    v_cmp_gt_u32 vcc, 32, v0
    s_nop 1
    v_cndmask_b32 v8, v8, v9, vcc
    v_add_u32 v8, s14, v8
    v_mov_b32 v76, 0
    v_mov_b32 v77, 0
    v_mov_b32 v78, 0
    v_mov_b32 v79, 0
    ds_write_b128 v8, v[76:79]
    v_and_b32 v8, 15, v0
    v_lshrrev_b32 v9, 4, v0
    v_sub_u32 v10, 15, v8
    v_and_b32 v11, 3, v10
    v_lshrrev_b32 v10, 2, v10
    v_mul_u32_u24 v11, 4160, v11
    v_lshl_add_u32 v11, v9, 4, v11
    v_lshlrev_b32 v10, 3, v10
    v_sub_u32 v11, v11, v10
    s_and_b32 s14, s8, 1
    s_mul_i32 s14, s14, 21248
    s_add_u32 s15, s14, 32
    v_add_u32 v1, s15, v11
    v_add_u32 v2, 32, v11
    v_lshlrev_b32 v10, 5, v8
    v_lshlrev_b32 v11, 4, v9
    v_sub_u32 v11, v11, v10
    s_add_u32 s15, s14, 17120
    v_add_u32 v3, s15, v11
    v_add_u32 v4, 17120, v11
    v_lshl_add_u32 v7, v9, 3, v10
    s_add_u32 s15, s14, 17144
    v_sub_u32 v5, s15, v7
    v_sub_u32 v6, 17144, v7
    v_add_u32 v15, 32, v14
    s_waitcnt lgkmcnt(0)
    s_cmp_eq_u32 s8, 0
    s_cselect_b32 s84, 0, s84
    s_cselect_b32 s85, 0, s85
    s_cselect_b32 s86, 0, s86
    s_cselect_b32 s87, 0, s87
    s_cselect_b32 s88, 0, s88
    s_cselect_b32 s89, 0, s89
    v_mov_b32 v24, s85
    v_mov_b32 v32, s84
    s_lshl_b32 s15, s60, 16
    s_and_b32 s60, s60, 0xffff0000
    s_bitcmp1_b32 s9, 0
    s_cselect_b32 s60, s60, s15
    v_mov_b32 v44, s87
    v_mov_b32 v52, s86
    s_lshl_b32 s15, s61, 16
    s_and_b32 s61, s61, 0xffff0000
    s_bitcmp1_b32 s10, 0
    s_cselect_b32 s61, s61, s15
    v_mov_b32 v64, s89
    v_mov_b32 v72, s88
    s_lshl_b32 s15, s62, 16
    s_and_b32 s62, s62, 0xffff0000
    s_bitcmp1_b32 s11, 0
    s_cselect_b32 s62, s62, s15
    s_bitcmp1_b32 s8, 0
    s_cselect_b32 s63, s61, s60
    s_cselect_b32 s64, s10, s9
    s_lshl_b32 s64, s64, 12
    s_add_u32 s64, s64, 0xc00000
    s_lshl_b32 s65, s11, 12
    s_add_u32 s65, s65, 0xc00000
    s_mov_b32 s66, 0xfffefffe
    s_lshl_b32 s56, s9, 12
    s_add_u32 s56, s56, 0xc00000
    s_add_u32 s57, s56, 4096
    s_waitcnt vmcnt(5)
    ds_write_b128 v15, v[16:19] offset:0
    v_mov_b32_dpp v24, v19 wave_shr:1 row_mask:0xf bank_mask:0xf
    v_mov_b32_dpp v32, v18 wave_shr:1 row_mask:0xf bank_mask:0xf
    v_mov_b32 v25, v16
    v_mov_b32 v26, v17
    v_mov_b32 v27, v18
    ds_write_b128 v15, v[24:27] offset:8320
    v_alignbit_b32 v20, v16, v24, 16
    v_alignbit_b32 v21, v17, v25, 16
    v_alignbit_b32 v22, v18, v26, 16
    v_alignbit_b32 v23, v19, v27, 16
    ds_write_b128 v15, v[20:23] offset:4160
    v_alignbit_b32 v28, v24, v32, 16
    v_mov_b32 v29, v20
    v_mov_b32 v30, v21
    v_mov_b32 v31, v22
    ds_write_b128 v15, v[28:31] offset:12480
    s_waitcnt vmcnt(4)
    ds_write_b128 v15, v[36:39] offset:21248
    v_mov_b32_dpp v44, v39 wave_shr:1 row_mask:0xf bank_mask:0xf
    v_mov_b32_dpp v52, v38 wave_shr:1 row_mask:0xf bank_mask:0xf
    v_mov_b32 v45, v36
    v_mov_b32 v46, v37
    v_mov_b32 v47, v38
    ds_write_b128 v15, v[44:47] offset:29568
    v_alignbit_b32 v40, v36, v44, 16
    v_alignbit_b32 v41, v37, v45, 16
    v_alignbit_b32 v42, v38, v46, 16
    v_alignbit_b32 v43, v39, v47, 16
    ds_write_b128 v15, v[40:43] offset:25408
    v_alignbit_b32 v48, v44, v52, 16
    v_mov_b32 v49, v40
    v_mov_b32 v50, v41
    v_mov_b32 v51, v42
    ds_write_b128 v15, v[48:51] offset:33728
    s_waitcnt vmcnt(3)
    ds_write_b128 v15, v[56:59] offset:42496
    v_mov_b32_dpp v64, v59 wave_shr:1 row_mask:0xf bank_mask:0xf
    v_mov_b32_dpp v72, v58 wave_shr:1 row_mask:0xf bank_mask:0xf
    v_mov_b32 v65, v56
    v_mov_b32 v66, v57
    v_mov_b32 v67, v58
    ds_write_b128 v15, v[64:67] offset:50816
    v_alignbit_b32 v60, v56, v64, 16
    v_alignbit_b32 v61, v57, v65, 16
    v_alignbit_b32 v62, v58, v66, 16
    v_alignbit_b32 v63, v59, v67, 16
    ds_write_b128 v15, v[60:63] offset:46656
    v_alignbit_b32 v68, v64, v72, 16
    v_mov_b32 v69, v60
    v_mov_b32 v70, v61
    v_mov_b32 v71, v62
    ds_write_b128 v15, v[68:71] offset:54976
    s_waitcnt vmcnt(0) lgkmcnt(0)
    v_mov_b32 v248, 1
    s_mov_b64 exec, 1
    ds_add_u32 v249, v248
    s_mov_b64 exec, -1
    s_mov_b32 s70, 0x100000
K2_CS:
    ds_read_b32 v248, v249 offset:0
    s_waitcnt lgkmcnt(0)
    v_readfirstlane_b32 s71, v248
    s_cmp_eq_u32 s71, 4
    s_cbranch_scc1 K2_CS_OK
    s_sub_u32 s70, s70, 1
    s_cbranch_scc0 K2_CS
K2_CS_OK:
    s_cmp_eq_u32 s8, 2
    s_cbranch_scc1 K2_CV1
    s_cmp_eq_u32 s8, 3
    s_cselect_b32 s14, 1, 0
    s_lshl_b32 s14, s14, s12
    s_cmp_eq_u32 s14, 1
    s_cbranch_scc1 K2_CV2
    s_cmp_eq_u32 s14, 2
    s_cbranch_scc1 K2_CV3
    ds_read_b64 v[44:45], v5 offset:0
    ds_read_b64 v[46:47], v5 offset:512
    ds_read_b64 v[48:49], v5 offset:1024
    ds_read_b64 v[50:51], v5 offset:3072
    ds_read_b64 v[60:61], v1 offset:0
    ds_read_b64 v[62:63], v1 offset:8
    ds_read_b128 v[64:67], v3 offset:0
    ds_read_b64 v[68:69], v1 offset:512
    ds_read_b64 v[70:71], v1 offset:520
    ds_read_b128 v[72:75], v3 offset:512
    ds_read_b64 v[76:77], v1 offset:1024
    ds_read_b64 v[78:79], v1 offset:1032
    s_waitcnt lgkmcnt(8)
    v_and_b32 v16, 0xffff0000, v45
    v_lshlrev_b32 v17, 16, v45
    v_and_b32 v18, 0xffff0000, v44
    v_lshlrev_b32 v19, 16, v44
    v_mul_f32 v16, s63, v16
    v_mul_f32 v17, s63, v17
    v_mul_f32 v18, s63, v18
    v_mul_f32 v19, s63, v19
    s_waitcnt lgkmcnt(6)
    s_waitcnt lgkmcnt(5)
    v_mfma_f32_16x16x32_bf16 v[16:19], v[60:63], v[64:67], v[16:19]
    ds_read_b128 v[80:83], v3 offset:1024
    ds_read_b64 v[84:85], v1 offset:1536
    ds_read_b64 v[86:87], v1 offset:1544
    ds_read_b128 v[88:91], v3 offset:1536
    v_and_b32 v20, 0xffff0000, v47
    v_lshlrev_b32 v21, 16, v47
    v_and_b32 v22, 0xffff0000, v46
    v_lshlrev_b32 v23, 16, v46
    s_waitcnt lgkmcnt(7)
    s_waitcnt lgkmcnt(6)
    v_mfma_f32_16x16x32_bf16 v[16:19], v[68:71], v[72:75], v[16:19]
    ds_read_b64 v[92:93], v1 offset:2048
    ds_read_b64 v[94:95], v1 offset:2056
    ds_read_b128 v[96:99], v3 offset:2048
    ds_read_b64 v[100:101], v1 offset:2560
    ds_read_b64 v[102:103], v1 offset:2568
    v_mul_f32 v20, s63, v20
    v_mul_f32 v21, s63, v21
    v_mul_f32 v22, s63, v22
    v_mul_f32 v23, s63, v23
    s_waitcnt lgkmcnt(9)
    s_waitcnt lgkmcnt(8)
    v_mfma_f32_16x16x32_bf16 v[16:19], v[76:79], v[80:83], v[16:19]
    ds_read_b128 v[104:107], v3 offset:2560
    ds_read_b64 v[108:109], v1 offset:3072
    ds_read_b64 v[110:111], v1 offset:3080
    ds_read_b128 v[112:115], v3 offset:3072
    v_and_b32 v24, 0xffff0000, v49
    v_lshlrev_b32 v25, 16, v49
    v_and_b32 v26, 0xffff0000, v48
    v_lshlrev_b32 v27, 16, v48
    s_waitcnt lgkmcnt(10)
    s_waitcnt lgkmcnt(9)
    v_mfma_f32_16x16x32_bf16 v[16:19], v[84:87], v[88:91], v[16:19]
    ds_read_b64 v[116:117], v1 offset:3584
    ds_read_b64 v[118:119], v1 offset:3592
    ds_read_b128 v[120:123], v3 offset:3584
    v_mul_f32 v24, s63, v24
    v_mul_f32 v25, s63, v25
    v_mul_f32 v26, s63, v26
    v_mul_f32 v27, s63, v27
    s_waitcnt lgkmcnt(10)
    s_waitcnt lgkmcnt(9)
    v_mfma_f32_16x16x32_bf16 v[16:19], v[92:95], v[96:99], v[16:19]
    v_and_b32 v28, 0xffff0000, v51
    v_lshlrev_b32 v29, 16, v51
    v_and_b32 v30, 0xffff0000, v50
    v_lshlrev_b32 v31, 16, v50
    s_waitcnt lgkmcnt(7)
    s_waitcnt lgkmcnt(6)
    v_mfma_f32_16x16x32_bf16 v[16:19], v[100:103], v[104:107], v[16:19]
    v_mul_f32 v28, s63, v28
    v_mul_f32 v29, s63, v29
    v_mul_f32 v30, s63, v30
    v_mul_f32 v31, s63, v31
    s_waitcnt lgkmcnt(4)
    s_waitcnt lgkmcnt(3)
    v_mfma_f32_16x16x32_bf16 v[16:19], v[108:111], v[112:115], v[16:19]
    s_waitcnt lgkmcnt(1)
    s_waitcnt lgkmcnt(0)
    v_mfma_f32_16x16x32_bf16 v[16:19], v[116:119], v[120:123], v[16:19]
    v_mfma_f32_16x16x32_bf16 v[20:23], v[60:63], v[72:75], v[20:23]
    v_mfma_f32_16x16x32_bf16 v[20:23], v[68:71], v[80:83], v[20:23]
    v_mfma_f32_16x16x32_bf16 v[20:23], v[76:79], v[88:91], v[20:23]
    v_mfma_f32_16x16x32_bf16 v[20:23], v[84:87], v[96:99], v[20:23]
    v_mfma_f32_16x16x32_bf16 v[20:23], v[92:95], v[104:107], v[20:23]
    v_mfma_f32_16x16x32_bf16 v[20:23], v[100:103], v[112:115], v[20:23]
    v_mfma_f32_16x16x32_bf16 v[20:23], v[108:111], v[120:123], v[20:23]
    v_mfma_f32_16x16x32_bf16 v[24:27], v[60:63], v[80:83], v[24:27]
    ds_read_b64 v[124:125], v1 offset:64
    ds_read_b64 v[126:127], v1 offset:72
    ds_read_b128 v[128:131], v3 offset:64
    v_mfma_f32_16x16x32_bf16 v[24:27], v[68:71], v[88:91], v[24:27]
    ds_read_b128 v[132:135], v3 offset:576
    v_mfma_f32_16x16x32_bf16 v[24:27], v[76:79], v[96:99], v[24:27]
    ds_read_b128 v[136:139], v3 offset:1088
    v_mfma_f32_16x16x32_bf16 v[24:27], v[84:87], v[104:107], v[24:27]
    ds_read_b128 v[140:143], v3 offset:3136
    v_mfma_f32_16x16x32_bf16 v[24:27], v[92:95], v[112:115], v[24:27]
    ds_read_b64 v[144:145], v1 offset:576
    ds_read_b64 v[146:147], v1 offset:584
    v_mfma_f32_16x16x32_bf16 v[24:27], v[100:103], v[120:123], v[24:27]
    v_mfma_f32_16x16x32_bf16 v[28:31], v[60:63], v[112:115], v[28:31]
    ds_read_b128 v[148:151], v3 offset:1600
    v_mfma_f32_16x16x32_bf16 v[28:31], v[68:71], v[120:123], v[28:31]
    ds_read_b128 v[152:155], v3 offset:3648
    s_setprio 0
    s_waitcnt lgkmcnt(8)
    s_waitcnt lgkmcnt(7)
    v_mfma_f32_16x16x32_bf16 v[16:19], v[124:127], v[128:131], v[16:19]
    ds_read_b64 v[156:157], v1 offset:1088
    ds_read_b64 v[158:159], v1 offset:1096
    s_waitcnt lgkmcnt(8)
    v_mfma_f32_16x16x32_bf16 v[20:23], v[124:127], v[132:135], v[20:23]
    s_waitcnt lgkmcnt(7)
    v_mfma_f32_16x16x32_bf16 v[24:27], v[124:127], v[136:139], v[24:27]
    ds_read_b128 v[160:163], v3 offset:2112
    s_waitcnt lgkmcnt(7)
    v_mfma_f32_16x16x32_bf16 v[28:31], v[124:127], v[140:143], v[28:31]
    ds_read_b64 v[164:165], v1 offset:1600
    ds_read_b64 v[166:167], v1 offset:1608
    s_waitcnt lgkmcnt(7)
    v_mfma_f32_16x16x32_bf16 v[16:19], v[144:147], v[132:135], v[16:19]
    v_mfma_f32_16x16x32_bf16 v[20:23], v[144:147], v[136:139], v[20:23]
    ds_read_b128 v[168:171], v3 offset:2624
    s_waitcnt lgkmcnt(7)
    v_mfma_f32_16x16x32_bf16 v[24:27], v[144:147], v[148:151], v[24:27]
    ds_read_b64 v[172:173], v1 offset:2112
    ds_read_b64 v[174:175], v1 offset:2120
    s_waitcnt lgkmcnt(8)
    v_mfma_f32_16x16x32_bf16 v[28:31], v[144:147], v[152:155], v[28:31]
    s_waitcnt lgkmcnt(6)
    v_mfma_f32_16x16x32_bf16 v[16:19], v[156:159], v[136:139], v[16:19]
    v_mfma_f32_16x16x32_bf16 v[20:23], v[156:159], v[148:151], v[20:23]
    ds_read_b64 v[176:177], v1 offset:2624
    ds_read_b64 v[178:179], v1 offset:2632
    s_waitcnt lgkmcnt(7)
    v_mfma_f32_16x16x32_bf16 v[24:27], v[156:159], v[160:163], v[24:27]
    s_waitcnt lgkmcnt(5)
    v_mfma_f32_16x16x32_bf16 v[16:19], v[164:167], v[148:151], v[16:19]
    v_mfma_f32_16x16x32_bf16 v[20:23], v[164:167], v[160:163], v[20:23]
    ds_read_b64 v[180:181], v1 offset:3136
    ds_read_b64 v[182:183], v1 offset:3144
    s_waitcnt lgkmcnt(6)
    v_mfma_f32_16x16x32_bf16 v[24:27], v[164:167], v[168:171], v[24:27]
    s_waitcnt lgkmcnt(4)
    v_mfma_f32_16x16x32_bf16 v[16:19], v[172:175], v[160:163], v[16:19]
    ds_read_b64 v[184:185], v1 offset:3648
    ds_read_b64 v[186:187], v1 offset:3656
    v_mfma_f32_16x16x32_bf16 v[20:23], v[172:175], v[168:171], v[20:23]
    ds_read_b64 v[188:189], v1 offset:128
    ds_read_b64 v[190:191], v1 offset:136
    ds_read_b128 v[192:195], v3 offset:128
    v_mfma_f32_16x16x32_bf16 v[24:27], v[172:175], v[140:143], v[24:27]
    ds_read_b128 v[196:199], v3 offset:640
    s_waitcnt lgkmcnt(8)
    v_mfma_f32_16x16x32_bf16 v[16:19], v[176:179], v[168:171], v[16:19]
    ds_read_b128 v[200:203], v3 offset:1152
    v_mfma_f32_16x16x32_bf16 v[20:23], v[176:179], v[140:143], v[20:23]
    ds_read_b128 v[204:207], v3 offset:3200
    v_mfma_f32_16x16x32_bf16 v[24:27], v[176:179], v[152:155], v[24:27]
    ds_read_b64 v[208:209], v1 offset:640
    ds_read_b64 v[210:211], v1 offset:648
    s_waitcnt lgkmcnt(10)
    v_mfma_f32_16x16x32_bf16 v[16:19], v[180:183], v[140:143], v[16:19]
    v_mfma_f32_16x16x32_bf16 v[20:23], v[180:183], v[152:155], v[20:23]
    ds_read_b128 v[212:215], v3 offset:1664
    s_waitcnt lgkmcnt(9)
    v_mfma_f32_16x16x32_bf16 v[16:19], v[184:187], v[152:155], v[16:19]
    ds_read_b128 v[216:219], v3 offset:3712
    s_waitcnt lgkmcnt(8)
    s_waitcnt lgkmcnt(7)
    v_mfma_f32_16x16x32_bf16 v[16:19], v[188:191], v[192:195], v[16:19]
    ds_read_b64 v[220:221], v1 offset:1152
    ds_read_b64 v[222:223], v1 offset:1160
    s_waitcnt lgkmcnt(8)
    v_mfma_f32_16x16x32_bf16 v[20:23], v[188:191], v[196:199], v[20:23]
    s_waitcnt lgkmcnt(7)
    v_mfma_f32_16x16x32_bf16 v[24:27], v[188:191], v[200:203], v[24:27]
    ds_read_b128 v[224:227], v3 offset:2176
    s_waitcnt lgkmcnt(7)
    v_mfma_f32_16x16x32_bf16 v[28:31], v[188:191], v[204:207], v[28:31]
    ds_read_b64 v[228:229], v1 offset:1664
    ds_read_b64 v[230:231], v1 offset:1672
    s_waitcnt lgkmcnt(7)
    v_mfma_f32_16x16x32_bf16 v[16:19], v[208:211], v[196:199], v[16:19]
    v_mfma_f32_16x16x32_bf16 v[20:23], v[208:211], v[200:203], v[20:23]
    ds_read_b128 v[232:235], v3 offset:2688
    s_waitcnt lgkmcnt(7)
    v_mfma_f32_16x16x32_bf16 v[24:27], v[208:211], v[212:215], v[24:27]
    ds_read_b64 v[236:237], v1 offset:2176
    ds_read_b64 v[238:239], v1 offset:2184
    s_waitcnt lgkmcnt(8)
    v_mfma_f32_16x16x32_bf16 v[28:31], v[208:211], v[216:219], v[28:31]
    s_waitcnt lgkmcnt(6)
    v_mfma_f32_16x16x32_bf16 v[16:19], v[220:223], v[200:203], v[16:19]
    v_mfma_f32_16x16x32_bf16 v[20:23], v[220:223], v[212:215], v[20:23]
    ds_read_b64 v[240:241], v1 offset:2688
    ds_read_b64 v[242:243], v1 offset:2696
    s_waitcnt lgkmcnt(7)
    v_mfma_f32_16x16x32_bf16 v[24:27], v[220:223], v[224:227], v[24:27]
    s_waitcnt lgkmcnt(5)
    v_mfma_f32_16x16x32_bf16 v[16:19], v[228:231], v[212:215], v[16:19]
    v_mfma_f32_16x16x32_bf16 v[20:23], v[228:231], v[224:227], v[20:23]
    ds_read_b64 v[244:245], v1 offset:3200
    ds_read_b64 v[246:247], v1 offset:3208
    s_waitcnt lgkmcnt(6)
    v_mfma_f32_16x16x32_bf16 v[24:27], v[228:231], v[232:235], v[24:27]
    s_waitcnt lgkmcnt(4)
    v_mfma_f32_16x16x32_bf16 v[16:19], v[236:239], v[224:227], v[16:19]
    ds_read_b64 v[64:65], v1 offset:3712
    ds_read_b64 v[66:67], v1 offset:3720
    v_mfma_f32_16x16x32_bf16 v[20:23], v[236:239], v[232:235], v[20:23]
    ds_read_b64 v[116:117], v1 offset:192
    ds_read_b64 v[118:119], v1 offset:200
    ds_read_b128 v[72:75], v3 offset:192
    v_mfma_f32_16x16x32_bf16 v[24:27], v[236:239], v[204:207], v[24:27]
    ds_read_b128 v[108:111], v3 offset:704
    s_waitcnt lgkmcnt(8)
    v_mfma_f32_16x16x32_bf16 v[16:19], v[240:243], v[232:235], v[16:19]
    ds_read_b128 v[80:83], v3 offset:1216
    v_mfma_f32_16x16x32_bf16 v[20:23], v[240:243], v[204:207], v[20:23]
    ds_read_b128 v[88:91], v3 offset:3264
    v_mfma_f32_16x16x32_bf16 v[24:27], v[240:243], v[216:219], v[24:27]
    ds_read_b64 v[76:77], v1 offset:704
    ds_read_b64 v[78:79], v1 offset:712
    s_waitcnt lgkmcnt(10)
    v_mfma_f32_16x16x32_bf16 v[16:19], v[244:247], v[204:207], v[16:19]
    v_mfma_f32_16x16x32_bf16 v[20:23], v[244:247], v[216:219], v[20:23]
    ds_read_b128 v[96:99], v3 offset:1728
    s_waitcnt lgkmcnt(9)
    v_mfma_f32_16x16x32_bf16 v[16:19], v[64:67], v[216:219], v[16:19]
    ds_read_b128 v[84:87], v3 offset:3776
    s_waitcnt lgkmcnt(8)
    s_waitcnt lgkmcnt(7)
    v_mfma_f32_16x16x32_bf16 v[16:19], v[116:119], v[72:75], v[16:19]
    ds_read_b64 v[104:105], v1 offset:1216
    ds_read_b64 v[106:107], v1 offset:1224
    s_waitcnt lgkmcnt(8)
    v_mfma_f32_16x16x32_bf16 v[20:23], v[116:119], v[108:111], v[20:23]
    s_waitcnt lgkmcnt(7)
    v_mfma_f32_16x16x32_bf16 v[24:27], v[116:119], v[80:83], v[24:27]
    ds_read_b128 v[92:95], v3 offset:2240
    s_waitcnt lgkmcnt(7)
    v_mfma_f32_16x16x32_bf16 v[28:31], v[116:119], v[88:91], v[28:31]
    ds_read_b64 v[100:101], v1 offset:1728
    ds_read_b64 v[102:103], v1 offset:1736
    s_waitcnt lgkmcnt(7)
    v_mfma_f32_16x16x32_bf16 v[16:19], v[76:79], v[108:111], v[16:19]
    v_mfma_f32_16x16x32_bf16 v[20:23], v[76:79], v[80:83], v[20:23]
    ds_read_b128 v[60:63], v3 offset:2752
    s_waitcnt lgkmcnt(7)
    v_mfma_f32_16x16x32_bf16 v[24:27], v[76:79], v[96:99], v[24:27]
    ds_read_b64 v[112:113], v1 offset:2240
    ds_read_b64 v[114:115], v1 offset:2248
    s_waitcnt lgkmcnt(8)
    v_mfma_f32_16x16x32_bf16 v[28:31], v[76:79], v[84:87], v[28:31]
    s_waitcnt lgkmcnt(6)
    v_mfma_f32_16x16x32_bf16 v[16:19], v[104:107], v[80:83], v[16:19]
    v_mfma_f32_16x16x32_bf16 v[20:23], v[104:107], v[96:99], v[20:23]
    ds_read_b64 v[68:69], v1 offset:2752
    ds_read_b64 v[70:71], v1 offset:2760
    s_waitcnt lgkmcnt(7)
    v_mfma_f32_16x16x32_bf16 v[24:27], v[104:107], v[92:95], v[24:27]
    s_waitcnt lgkmcnt(5)
    v_mfma_f32_16x16x32_bf16 v[16:19], v[100:103], v[96:99], v[16:19]
    v_mfma_f32_16x16x32_bf16 v[20:23], v[100:103], v[92:95], v[20:23]
    ds_read_b64 v[120:121], v1 offset:3264
    ds_read_b64 v[122:123], v1 offset:3272
    s_waitcnt lgkmcnt(6)
    v_mfma_f32_16x16x32_bf16 v[24:27], v[100:103], v[60:63], v[24:27]
    s_waitcnt lgkmcnt(4)
    v_mfma_f32_16x16x32_bf16 v[16:19], v[112:115], v[92:95], v[16:19]
    ds_read_b64 v[128:129], v1 offset:3776
    ds_read_b64 v[130:131], v1 offset:3784
    v_mfma_f32_16x16x32_bf16 v[20:23], v[112:115], v[60:63], v[20:23]
    ds_read_b64 v[124:125], v1 offset:256
    ds_read_b64 v[126:127], v1 offset:264
    ds_read_b128 v[132:135], v3 offset:256
    v_mfma_f32_16x16x32_bf16 v[24:27], v[112:115], v[88:91], v[24:27]
    ds_read_b128 v[144:147], v3 offset:768
    s_waitcnt lgkmcnt(8)
    v_mfma_f32_16x16x32_bf16 v[16:19], v[68:71], v[60:63], v[16:19]
    ds_read_b128 v[136:139], v3 offset:1280
    v_mfma_f32_16x16x32_bf16 v[20:23], v[68:71], v[88:91], v[20:23]
    ds_read_b128 v[156:159], v3 offset:3328
    v_mfma_f32_16x16x32_bf16 v[24:27], v[68:71], v[84:87], v[24:27]
    ds_read_b64 v[148:149], v1 offset:768
    ds_read_b64 v[150:151], v1 offset:776
    s_waitcnt lgkmcnt(10)
    v_mfma_f32_16x16x32_bf16 v[16:19], v[120:123], v[88:91], v[16:19]
    v_mfma_f32_16x16x32_bf16 v[20:23], v[120:123], v[84:87], v[20:23]
    ds_read_b128 v[164:167], v3 offset:1792
    s_waitcnt lgkmcnt(9)
    v_mfma_f32_16x16x32_bf16 v[16:19], v[128:131], v[84:87], v[16:19]
    ds_read_b128 v[160:163], v3 offset:3840
    s_waitcnt lgkmcnt(8)
    s_waitcnt lgkmcnt(7)
    v_mfma_f32_16x16x32_bf16 v[16:19], v[124:127], v[132:135], v[16:19]
    ds_read_b64 v[172:173], v1 offset:1280
    ds_read_b64 v[174:175], v1 offset:1288
    s_waitcnt lgkmcnt(8)
    v_mfma_f32_16x16x32_bf16 v[20:23], v[124:127], v[144:147], v[20:23]
    s_waitcnt lgkmcnt(7)
    v_mfma_f32_16x16x32_bf16 v[24:27], v[124:127], v[136:139], v[24:27]
    ds_read_b128 v[168:171], v3 offset:2304
    s_waitcnt lgkmcnt(7)
    v_mfma_f32_16x16x32_bf16 v[28:31], v[124:127], v[156:159], v[28:31]
    ds_read_b64 v[176:177], v1 offset:1792
    ds_read_b64 v[178:179], v1 offset:1800
    s_waitcnt lgkmcnt(7)
    v_mfma_f32_16x16x32_bf16 v[16:19], v[148:151], v[144:147], v[16:19]
    v_mfma_f32_16x16x32_bf16 v[20:23], v[148:151], v[136:139], v[20:23]
    ds_read_b128 v[140:143], v3 offset:2816
    s_waitcnt lgkmcnt(7)
    v_mfma_f32_16x16x32_bf16 v[24:27], v[148:151], v[164:167], v[24:27]
    ds_read_b64 v[180:181], v1 offset:2304
    ds_read_b64 v[182:183], v1 offset:2312
    s_waitcnt lgkmcnt(8)
    v_mfma_f32_16x16x32_bf16 v[28:31], v[148:151], v[160:163], v[28:31]
    s_waitcnt lgkmcnt(6)
    v_mfma_f32_16x16x32_bf16 v[16:19], v[172:175], v[136:139], v[16:19]
    v_mfma_f32_16x16x32_bf16 v[20:23], v[172:175], v[164:167], v[20:23]
    ds_read_b64 v[184:185], v1 offset:2816
    ds_read_b64 v[186:187], v1 offset:2824
    s_waitcnt lgkmcnt(7)
    v_mfma_f32_16x16x32_bf16 v[24:27], v[172:175], v[168:171], v[24:27]
    s_waitcnt lgkmcnt(5)
    v_mfma_f32_16x16x32_bf16 v[16:19], v[176:179], v[164:167], v[16:19]
    v_mfma_f32_16x16x32_bf16 v[20:23], v[176:179], v[168:171], v[20:23]
    ds_read_b64 v[152:153], v1 offset:3328
    ds_read_b64 v[154:155], v1 offset:3336
    s_waitcnt lgkmcnt(6)
    v_mfma_f32_16x16x32_bf16 v[24:27], v[176:179], v[140:143], v[24:27]
    s_waitcnt lgkmcnt(4)
    v_mfma_f32_16x16x32_bf16 v[16:19], v[180:183], v[168:171], v[16:19]
    ds_read_b64 v[192:193], v1 offset:3840
    ds_read_b64 v[194:195], v1 offset:3848
    v_mfma_f32_16x16x32_bf16 v[20:23], v[180:183], v[140:143], v[20:23]
    ds_read_b64 v[188:189], v1 offset:320
    ds_read_b64 v[190:191], v1 offset:328
    ds_read_b128 v[196:199], v3 offset:320
    v_mfma_f32_16x16x32_bf16 v[24:27], v[180:183], v[156:159], v[24:27]
    ds_read_b128 v[208:211], v3 offset:832
    s_waitcnt lgkmcnt(8)
    v_mfma_f32_16x16x32_bf16 v[16:19], v[184:187], v[140:143], v[16:19]
    ds_read_b128 v[200:203], v3 offset:1344
    v_mfma_f32_16x16x32_bf16 v[20:23], v[184:187], v[156:159], v[20:23]
    ds_read_b128 v[220:223], v3 offset:3392
    v_mfma_f32_16x16x32_bf16 v[24:27], v[184:187], v[160:163], v[24:27]
    ds_read_b64 v[212:213], v1 offset:832
    ds_read_b64 v[214:215], v1 offset:840
    s_waitcnt lgkmcnt(10)
    v_mfma_f32_16x16x32_bf16 v[16:19], v[152:155], v[156:159], v[16:19]
    v_mfma_f32_16x16x32_bf16 v[20:23], v[152:155], v[160:163], v[20:23]
    ds_read_b128 v[228:231], v3 offset:1856
    s_waitcnt lgkmcnt(9)
    v_mfma_f32_16x16x32_bf16 v[16:19], v[192:195], v[160:163], v[16:19]
    ds_read_b128 v[224:227], v3 offset:3904
    s_waitcnt lgkmcnt(8)
    s_waitcnt lgkmcnt(7)
    v_mfma_f32_16x16x32_bf16 v[16:19], v[188:191], v[196:199], v[16:19]
    ds_read_b64 v[236:237], v1 offset:1344
    ds_read_b64 v[238:239], v1 offset:1352
    s_waitcnt lgkmcnt(8)
    v_mfma_f32_16x16x32_bf16 v[20:23], v[188:191], v[208:211], v[20:23]
    s_waitcnt lgkmcnt(7)
    v_mfma_f32_16x16x32_bf16 v[24:27], v[188:191], v[200:203], v[24:27]
    ds_read_b128 v[232:235], v3 offset:2368
    s_waitcnt lgkmcnt(7)
    v_mfma_f32_16x16x32_bf16 v[28:31], v[188:191], v[220:223], v[28:31]
    ds_read_b64 v[240:241], v1 offset:1856
    ds_read_b64 v[242:243], v1 offset:1864
    s_waitcnt lgkmcnt(7)
    v_mfma_f32_16x16x32_bf16 v[16:19], v[212:215], v[208:211], v[16:19]
    v_mfma_f32_16x16x32_bf16 v[20:23], v[212:215], v[200:203], v[20:23]
    ds_read_b128 v[204:207], v3 offset:2880
    s_waitcnt lgkmcnt(7)
    v_mfma_f32_16x16x32_bf16 v[24:27], v[212:215], v[228:231], v[24:27]
    ds_read_b64 v[244:245], v1 offset:2368
    ds_read_b64 v[246:247], v1 offset:2376
    s_waitcnt lgkmcnt(8)
    v_mfma_f32_16x16x32_bf16 v[28:31], v[212:215], v[224:227], v[28:31]
    s_waitcnt lgkmcnt(6)
    v_mfma_f32_16x16x32_bf16 v[16:19], v[236:239], v[200:203], v[16:19]
    v_mfma_f32_16x16x32_bf16 v[20:23], v[236:239], v[228:231], v[20:23]
    ds_read_b64 v[64:65], v1 offset:2880
    ds_read_b64 v[66:67], v1 offset:2888
    s_waitcnt lgkmcnt(7)
    v_mfma_f32_16x16x32_bf16 v[24:27], v[236:239], v[232:235], v[24:27]
    s_waitcnt lgkmcnt(5)
    v_mfma_f32_16x16x32_bf16 v[16:19], v[240:243], v[228:231], v[16:19]
    v_mfma_f32_16x16x32_bf16 v[20:23], v[240:243], v[232:235], v[20:23]
    ds_read_b64 v[216:217], v1 offset:3392
    ds_read_b64 v[218:219], v1 offset:3400
    s_waitcnt lgkmcnt(6)
    v_mfma_f32_16x16x32_bf16 v[24:27], v[240:243], v[204:207], v[24:27]
    s_waitcnt lgkmcnt(4)
    v_mfma_f32_16x16x32_bf16 v[16:19], v[244:247], v[232:235], v[16:19]
    ds_read_b64 v[72:73], v1 offset:3904
    ds_read_b64 v[74:75], v1 offset:3912
    v_mfma_f32_16x16x32_bf16 v[20:23], v[244:247], v[204:207], v[20:23]
    ds_read_b64 v[116:117], v1 offset:384
    ds_read_b64 v[118:119], v1 offset:392
    ds_read_b128 v[108:111], v3 offset:384
    v_mfma_f32_16x16x32_bf16 v[24:27], v[244:247], v[220:223], v[24:27]
    ds_read_b128 v[76:79], v3 offset:896
    s_waitcnt lgkmcnt(8)
    v_mfma_f32_16x16x32_bf16 v[16:19], v[64:67], v[204:207], v[16:19]
    ds_read_b128 v[80:83], v3 offset:1408
    v_mfma_f32_16x16x32_bf16 v[20:23], v[64:67], v[220:223], v[20:23]
    ds_read_b128 v[104:107], v3 offset:3456
    v_mfma_f32_16x16x32_bf16 v[24:27], v[64:67], v[224:227], v[24:27]
    ds_read_b64 v[96:97], v1 offset:896
    ds_read_b64 v[98:99], v1 offset:904
    s_waitcnt lgkmcnt(10)
    v_mfma_f32_16x16x32_bf16 v[16:19], v[216:219], v[220:223], v[16:19]
    v_mfma_f32_16x16x32_bf16 v[20:23], v[216:219], v[224:227], v[20:23]
    ds_read_b128 v[100:103], v3 offset:1920
    s_waitcnt lgkmcnt(9)
    v_mfma_f32_16x16x32_bf16 v[16:19], v[72:75], v[224:227], v[16:19]
    ds_read_b128 v[92:95], v3 offset:3968
    s_waitcnt lgkmcnt(8)
    s_waitcnt lgkmcnt(7)
    v_mfma_f32_16x16x32_bf16 v[16:19], v[116:119], v[108:111], v[16:19]
    ds_read_b64 v[112:113], v1 offset:1408
    ds_read_b64 v[114:115], v1 offset:1416
    s_waitcnt lgkmcnt(8)
    v_mfma_f32_16x16x32_bf16 v[20:23], v[116:119], v[76:79], v[20:23]
    s_waitcnt lgkmcnt(7)
    v_mfma_f32_16x16x32_bf16 v[24:27], v[116:119], v[80:83], v[24:27]
    ds_read_b128 v[60:63], v3 offset:2432
    s_waitcnt lgkmcnt(7)
    v_mfma_f32_16x16x32_bf16 v[28:31], v[116:119], v[104:107], v[28:31]
    ds_read_b64 v[68:69], v1 offset:1920
    ds_read_b64 v[70:71], v1 offset:1928
    s_waitcnt lgkmcnt(7)
    v_mfma_f32_16x16x32_bf16 v[16:19], v[96:99], v[76:79], v[16:19]
    v_mfma_f32_16x16x32_bf16 v[20:23], v[96:99], v[80:83], v[20:23]
    ds_read_b128 v[88:91], v3 offset:2944
    s_waitcnt lgkmcnt(7)
    v_mfma_f32_16x16x32_bf16 v[24:27], v[96:99], v[100:103], v[24:27]
    ds_read_b64 v[120:121], v1 offset:2432
    ds_read_b64 v[122:123], v1 offset:2440
    s_waitcnt lgkmcnt(8)
    v_mfma_f32_16x16x32_bf16 v[28:31], v[96:99], v[92:95], v[28:31]
    s_waitcnt lgkmcnt(6)
    v_mfma_f32_16x16x32_bf16 v[16:19], v[112:115], v[80:83], v[16:19]
    v_mfma_f32_16x16x32_bf16 v[20:23], v[112:115], v[100:103], v[20:23]
    ds_read_b64 v[128:129], v1 offset:2944
    ds_read_b64 v[130:131], v1 offset:2952
    s_waitcnt lgkmcnt(7)
    v_mfma_f32_16x16x32_bf16 v[24:27], v[112:115], v[60:63], v[24:27]
    s_waitcnt lgkmcnt(5)
    v_mfma_f32_16x16x32_bf16 v[16:19], v[68:71], v[100:103], v[16:19]
    v_mfma_f32_16x16x32_bf16 v[20:23], v[68:71], v[60:63], v[20:23]
    ds_read_b64 v[84:85], v1 offset:3456
    ds_read_b64 v[86:87], v1 offset:3464
    s_waitcnt lgkmcnt(6)
    v_mfma_f32_16x16x32_bf16 v[24:27], v[68:71], v[88:91], v[24:27]
    s_waitcnt lgkmcnt(4)
    v_mfma_f32_16x16x32_bf16 v[16:19], v[120:123], v[60:63], v[16:19]
    ds_read_b64 v[132:133], v1 offset:3968
    ds_read_b64 v[134:135], v1 offset:3976
    v_mfma_f32_16x16x32_bf16 v[20:23], v[120:123], v[88:91], v[20:23]
    ds_read_b64 v[124:125], v1 offset:448
    ds_read_b64 v[126:127], v1 offset:456
    ds_read_b128 v[144:147], v3 offset:448
    v_mfma_f32_16x16x32_bf16 v[24:27], v[120:123], v[104:107], v[24:27]
    ds_read_b128 v[148:151], v3 offset:960
    s_waitcnt lgkmcnt(8)
    v_mfma_f32_16x16x32_bf16 v[16:19], v[128:131], v[88:91], v[16:19]
    ds_read_b128 v[136:139], v3 offset:1472
    v_mfma_f32_16x16x32_bf16 v[20:23], v[128:131], v[104:107], v[20:23]
    ds_read_b128 v[172:175], v3 offset:3520
    v_mfma_f32_16x16x32_bf16 v[24:27], v[128:131], v[92:95], v[24:27]
    ds_read_b64 v[164:165], v1 offset:960
    ds_read_b64 v[166:167], v1 offset:968
    s_waitcnt lgkmcnt(10)
    v_mfma_f32_16x16x32_bf16 v[16:19], v[84:87], v[104:107], v[16:19]
    v_mfma_f32_16x16x32_bf16 v[20:23], v[84:87], v[92:95], v[20:23]
    ds_read_b128 v[176:179], v3 offset:1984
    s_waitcnt lgkmcnt(9)
    v_mfma_f32_16x16x32_bf16 v[16:19], v[132:135], v[92:95], v[16:19]
    ds_read_b128 v[168:171], v3 offset:4032
    s_setprio 1
    s_waitcnt lgkmcnt(8)
    s_waitcnt lgkmcnt(7)
    v_mfma_f32_16x16x32_bf16 v[16:19], v[124:127], v[144:147], v[16:19]
    ds_read_b64 v[180:181], v1 offset:1472
    ds_read_b64 v[182:183], v1 offset:1480
    s_waitcnt lgkmcnt(8)
    v_mfma_f32_16x16x32_bf16 v[20:23], v[124:127], v[148:151], v[20:23]
    s_waitcnt lgkmcnt(7)
    v_mfma_f32_16x16x32_bf16 v[24:27], v[124:127], v[136:139], v[24:27]
    ds_read_b128 v[140:143], v3 offset:2496
    s_waitcnt lgkmcnt(7)
    v_mfma_f32_16x16x32_bf16 v[28:31], v[124:127], v[172:175], v[28:31]
    ds_read_b64 v[184:185], v1 offset:1984
    ds_read_b64 v[186:187], v1 offset:1992
    s_waitcnt lgkmcnt(7)
    v_mfma_f32_16x16x32_bf16 v[16:19], v[164:167], v[148:151], v[16:19]
    v_mfma_f32_16x16x32_bf16 v[20:23], v[164:167], v[136:139], v[20:23]
    ds_read_b128 v[156:159], v3 offset:3008
    s_waitcnt lgkmcnt(7)
    v_mfma_f32_16x16x32_bf16 v[24:27], v[164:167], v[176:179], v[24:27]
    ds_read_b64 v[152:153], v1 offset:2496
    ds_read_b64 v[154:155], v1 offset:2504
    s_waitcnt lgkmcnt(8)
    v_mfma_f32_16x16x32_bf16 v[28:31], v[164:167], v[168:171], v[28:31]
    s_waitcnt lgkmcnt(6)
    v_mfma_f32_16x16x32_bf16 v[16:19], v[180:183], v[136:139], v[16:19]
    v_mfma_f32_16x16x32_bf16 v[20:23], v[180:183], v[176:179], v[20:23]
    ds_read_b64 v[192:193], v1 offset:3008
    ds_read_b64 v[194:195], v1 offset:3016
    s_nop 2
    v_cvt_pk_bf16_f32 v50, v28, v29
    v_cvt_pk_bf16_f32 v51, v30, v31
    v_pk_min_u16 v50, v50, s66
    v_pk_min_u16 v51, v51, s66
    buffer_store_dwordx2 v[50:51], v7, s[44:47], s64 offen offset:512 sc1
    s_waitcnt lgkmcnt(7)
    v_mfma_f32_16x16x32_bf16 v[24:27], v[180:183], v[140:143], v[24:27]
    s_waitcnt lgkmcnt(5)
    v_mfma_f32_16x16x32_bf16 v[16:19], v[184:187], v[176:179], v[16:19]
    v_mfma_f32_16x16x32_bf16 v[20:23], v[184:187], v[140:143], v[20:23]
    ds_read_b64 v[160:161], v1 offset:3520
    ds_read_b64 v[162:163], v1 offset:3528
    s_waitcnt lgkmcnt(6)
    v_mfma_f32_16x16x32_bf16 v[24:27], v[184:187], v[156:159], v[24:27]
    s_waitcnt lgkmcnt(4)
    v_mfma_f32_16x16x32_bf16 v[16:19], v[152:155], v[140:143], v[16:19]
    ds_read_b64 v[196:197], v1 offset:4032
    ds_read_b64 v[198:199], v1 offset:4040
    v_mfma_f32_16x16x32_bf16 v[20:23], v[152:155], v[156:159], v[20:23]
    v_mfma_f32_16x16x32_bf16 v[24:27], v[152:155], v[172:175], v[24:27]
    s_waitcnt lgkmcnt(4)
    v_mfma_f32_16x16x32_bf16 v[16:19], v[192:195], v[156:159], v[16:19]
    v_mfma_f32_16x16x32_bf16 v[20:23], v[192:195], v[172:175], v[20:23]
    v_mfma_f32_16x16x32_bf16 v[24:27], v[192:195], v[168:171], v[24:27]
    s_waitcnt lgkmcnt(2)
    v_mfma_f32_16x16x32_bf16 v[16:19], v[160:163], v[172:175], v[16:19]
    v_mfma_f32_16x16x32_bf16 v[20:23], v[160:163], v[168:171], v[20:23]
    s_nop 4
    v_cvt_pk_bf16_f32 v48, v24, v25
    v_cvt_pk_bf16_f32 v49, v26, v27
    v_pk_min_u16 v48, v48, s66
    v_pk_min_u16 v49, v49, s66
    buffer_store_dwordx2 v[48:49], v7, s[44:47], s64 offen offset:2560 sc1
    s_waitcnt lgkmcnt(0)
    v_mfma_f32_16x16x32_bf16 v[16:19], v[196:199], v[168:171], v[16:19]
    v_cvt_pk_bf16_f32 v46, v20, v21
    v_cvt_pk_bf16_f32 v47, v22, v23
    v_pk_min_u16 v46, v46, s66
    v_pk_min_u16 v47, v47, s66
    buffer_store_dwordx2 v[46:47], v7, s[44:47], s64 offen offset:3072 sc1
    s_nop 2
    v_cvt_pk_bf16_f32 v44, v16, v17
    v_cvt_pk_bf16_f32 v45, v18, v19
    v_pk_min_u16 v44, v44, s66
    v_pk_min_u16 v45, v45, s66
    buffer_store_dwordx2 v[44:45], v7, s[44:47], s64 offen offset:3584 sc1
    s_nop 0
    s_branch K2_CP
K2_CV1:
    ds_read_b64 v[44:45], v6 offset:1536
    ds_read_b64 v[46:47], v6 offset:2048
    ds_read_b64 v[48:49], v6 offset:2560
    ds_read_b64 v[50:51], v6 offset:3584
    ds_read_b64 v[52:53], v6 offset:22784
    ds_read_b64 v[54:55], v6 offset:23296
    ds_read_b64 v[60:61], v2 offset:0
    ds_read_b64 v[62:63], v2 offset:8
    ds_read_b128 v[64:67], v4 offset:1536
    ds_read_b64 v[68:69], v2 offset:512
    ds_read_b64 v[70:71], v2 offset:520
    ds_read_b128 v[72:75], v4 offset:2048
    ds_read_b64 v[76:77], v2 offset:1024
    ds_read_b64 v[78:79], v2 offset:1032
    s_waitcnt lgkmcnt(8)
    v_and_b32 v16, 0xffff0000, v45
    v_lshlrev_b32 v17, 16, v45
    v_and_b32 v18, 0xffff0000, v44
    v_lshlrev_b32 v19, 16, v44
    v_mul_f32 v16, s60, v16
    v_mul_f32 v17, s60, v17
    v_mul_f32 v18, s60, v18
    v_mul_f32 v19, s60, v19
    s_waitcnt lgkmcnt(6)
    s_waitcnt lgkmcnt(5)
    v_mfma_f32_16x16x32_bf16 v[16:19], v[60:63], v[64:67], v[16:19]
    ds_read_b128 v[80:83], v4 offset:2560
    ds_read_b64 v[84:85], v2 offset:1536
    ds_read_b64 v[86:87], v2 offset:1544
    ds_read_b128 v[88:91], v4 offset:3072
    v_and_b32 v20, 0xffff0000, v47
    v_lshlrev_b32 v21, 16, v47
    v_and_b32 v22, 0xffff0000, v46
    v_lshlrev_b32 v23, 16, v46
    s_waitcnt lgkmcnt(7)
    s_waitcnt lgkmcnt(6)
    v_mfma_f32_16x16x32_bf16 v[16:19], v[68:71], v[72:75], v[16:19]
    ds_read_b64 v[92:93], v2 offset:2048
    ds_read_b64 v[94:95], v2 offset:2056
    ds_read_b128 v[96:99], v4 offset:3584
    v_mul_f32 v20, s60, v20
    v_mul_f32 v21, s60, v21
    v_mul_f32 v22, s60, v22
    v_mul_f32 v23, s60, v23
    s_waitcnt lgkmcnt(7)
    s_waitcnt lgkmcnt(6)
    v_mfma_f32_16x16x32_bf16 v[16:19], v[76:79], v[80:83], v[16:19]
    v_and_b32 v24, 0xffff0000, v49
    v_lshlrev_b32 v25, 16, v49
    v_and_b32 v26, 0xffff0000, v48
    v_lshlrev_b32 v27, 16, v48
    s_waitcnt lgkmcnt(4)
    s_waitcnt lgkmcnt(3)
    v_mfma_f32_16x16x32_bf16 v[16:19], v[84:87], v[88:91], v[16:19]
    v_mul_f32 v24, s60, v24
    v_mul_f32 v25, s60, v25
    v_mul_f32 v26, s60, v26
    v_mul_f32 v27, s60, v27
    s_waitcnt lgkmcnt(1)
    s_waitcnt lgkmcnt(0)
    v_mfma_f32_16x16x32_bf16 v[16:19], v[92:95], v[96:99], v[16:19]
    v_and_b32 v28, 0xffff0000, v51
    v_lshlrev_b32 v29, 16, v51
    v_and_b32 v30, 0xffff0000, v50
    v_lshlrev_b32 v31, 16, v50
    v_mfma_f32_16x16x32_bf16 v[20:23], v[60:63], v[72:75], v[20:23]
    ds_read_b64 v[100:101], v2 offset:21248
    ds_read_b64 v[102:103], v2 offset:21256
    ds_read_b128 v[104:107], v4 offset:22784
    v_mul_f32 v28, s60, v28
    v_mul_f32 v29, s60, v29
    v_mul_f32 v30, s60, v30
    v_mul_f32 v31, s60, v31
    v_mfma_f32_16x16x32_bf16 v[20:23], v[68:71], v[80:83], v[20:23]
    ds_read_b64 v[108:109], v2 offset:21760
    ds_read_b64 v[110:111], v2 offset:21768
    ds_read_b128 v[112:115], v4 offset:23296
    v_and_b32 v32, 0xffff0000, v53
    v_lshlrev_b32 v33, 16, v53
    v_and_b32 v34, 0xffff0000, v52
    v_lshlrev_b32 v35, 16, v52
    v_mfma_f32_16x16x32_bf16 v[20:23], v[76:79], v[88:91], v[20:23]
    ds_read_b64 v[116:117], v2 offset:22272
    ds_read_b64 v[118:119], v2 offset:22280
    ds_read_b128 v[120:123], v4 offset:23808
    v_mul_f32 v32, s61, v32
    v_mul_f32 v33, s61, v33
    v_mul_f32 v34, s61, v34
    v_mul_f32 v35, s61, v35
    v_mfma_f32_16x16x32_bf16 v[20:23], v[84:87], v[96:99], v[20:23]
    ds_read_b64 v[124:125], v2 offset:22784
    ds_read_b64 v[126:127], v2 offset:22792
    ds_read_b128 v[128:131], v4 offset:24320
    v_and_b32 v36, 0xffff0000, v55
    v_lshlrev_b32 v37, 16, v55
    v_and_b32 v38, 0xffff0000, v54
    v_lshlrev_b32 v39, 16, v54
    v_mfma_f32_16x16x32_bf16 v[24:27], v[60:63], v[80:83], v[24:27]
    ds_read_b64 v[132:133], v2 offset:23296
    ds_read_b64 v[134:135], v2 offset:23304
    v_mul_f32 v36, s61, v36
    v_mul_f32 v37, s61, v37
    v_mul_f32 v38, s61, v38
    v_mul_f32 v39, s61, v39
    v_mfma_f32_16x16x32_bf16 v[24:27], v[68:71], v[88:91], v[24:27]
    v_mfma_f32_16x16x32_bf16 v[24:27], v[76:79], v[96:99], v[24:27]
    v_mfma_f32_16x16x32_bf16 v[28:31], v[60:63], v[96:99], v[28:31]
    s_waitcnt lgkmcnt(12)
    s_waitcnt lgkmcnt(11)
    v_mfma_f32_16x16x32_bf16 v[32:35], v[100:103], v[104:107], v[32:35]
    ds_read_b128 v[136:139], v4 offset:24832
    s_waitcnt lgkmcnt(10)
    s_waitcnt lgkmcnt(9)
    v_mfma_f32_16x16x32_bf16 v[32:35], v[108:111], v[112:115], v[32:35]
    ds_read_b64 v[140:141], v2 offset:64
    ds_read_b64 v[142:143], v2 offset:72
    ds_read_b128 v[144:147], v4 offset:1600
    s_waitcnt lgkmcnt(10)
    s_waitcnt lgkmcnt(9)
    v_mfma_f32_16x16x32_bf16 v[32:35], v[116:119], v[120:123], v[32:35]
    ds_read_b128 v[148:151], v4 offset:2112
    s_waitcnt lgkmcnt(8)
    s_waitcnt lgkmcnt(7)
    v_mfma_f32_16x16x32_bf16 v[32:35], v[124:127], v[128:131], v[32:35]
    ds_read_b128 v[152:155], v4 offset:2624
    s_waitcnt lgkmcnt(6)
    s_waitcnt lgkmcnt(5)
    v_mfma_f32_16x16x32_bf16 v[32:35], v[132:135], v[136:139], v[32:35]
    ds_read_b128 v[156:159], v4 offset:3648
    v_mfma_f32_16x16x32_bf16 v[36:39], v[100:103], v[112:115], v[36:39]
    ds_read_b64 v[160:161], v2 offset:576
    ds_read_b64 v[162:163], v2 offset:584
    v_mfma_f32_16x16x32_bf16 v[36:39], v[108:111], v[120:123], v[36:39]
    v_mfma_f32_16x16x32_bf16 v[36:39], v[116:119], v[128:131], v[36:39]
    ds_read_b128 v[164:167], v4 offset:3136
    v_mfma_f32_16x16x32_bf16 v[36:39], v[124:127], v[136:139], v[36:39]
    ds_read_b64 v[168:169], v2 offset:1088
    ds_read_b64 v[170:171], v2 offset:1096
    s_setprio 0
    s_waitcnt lgkmcnt(9)
    s_waitcnt lgkmcnt(8)
    v_mfma_f32_16x16x32_bf16 v[16:19], v[140:143], v[144:147], v[16:19]
    s_waitcnt lgkmcnt(7)
    v_mfma_f32_16x16x32_bf16 v[20:23], v[140:143], v[148:151], v[20:23]
    s_waitcnt lgkmcnt(6)
    v_mfma_f32_16x16x32_bf16 v[24:27], v[140:143], v[152:155], v[24:27]
    ds_read_b64 v[172:173], v2 offset:1600
    ds_read_b64 v[174:175], v2 offset:1608
    s_waitcnt lgkmcnt(7)
    v_mfma_f32_16x16x32_bf16 v[28:31], v[140:143], v[156:159], v[28:31]
    s_waitcnt lgkmcnt(5)
    v_mfma_f32_16x16x32_bf16 v[16:19], v[160:163], v[148:151], v[16:19]
    ds_read_b64 v[176:177], v2 offset:2112
    ds_read_b64 v[178:179], v2 offset:2120
    v_mfma_f32_16x16x32_bf16 v[20:23], v[160:163], v[152:155], v[20:23]
    ds_read_b64 v[180:181], v2 offset:21312
    ds_read_b64 v[182:183], v2 offset:21320
    ds_read_b128 v[184:187], v4 offset:22848
    s_waitcnt lgkmcnt(9)
    v_mfma_f32_16x16x32_bf16 v[24:27], v[160:163], v[164:167], v[24:27]
    ds_read_b128 v[188:191], v4 offset:23360
    s_waitcnt lgkmcnt(8)
    v_mfma_f32_16x16x32_bf16 v[16:19], v[168:171], v[152:155], v[16:19]
    ds_read_b64 v[192:193], v2 offset:21824
    ds_read_b64 v[194:195], v2 offset:21832
    v_mfma_f32_16x16x32_bf16 v[20:23], v[168:171], v[164:167], v[20:23]
    ds_read_b128 v[196:199], v4 offset:23872
    v_mfma_f32_16x16x32_bf16 v[24:27], v[168:171], v[156:159], v[24:27]
    ds_read_b64 v[200:201], v2 offset:22336
    ds_read_b64 v[202:203], v2 offset:22344
    s_waitcnt lgkmcnt(11)
    v_mfma_f32_16x16x32_bf16 v[16:19], v[172:175], v[164:167], v[16:19]
    ds_read_b128 v[204:207], v4 offset:24384
    v_mfma_f32_16x16x32_bf16 v[20:23], v[172:175], v[156:159], v[20:23]
    ds_read_b64 v[208:209], v2 offset:22848
    ds_read_b64 v[210:211], v2 offset:22856
    s_waitcnt lgkmcnt(12)
    v_mfma_f32_16x16x32_bf16 v[16:19], v[176:179], v[156:159], v[16:19]
    ds_read_b128 v[212:215], v4 offset:24896
    s_waitcnt lgkmcnt(11)
    s_waitcnt lgkmcnt(10)
    v_mfma_f32_16x16x32_bf16 v[32:35], v[180:183], v[184:187], v[32:35]
    ds_read_b64 v[216:217], v2 offset:23360
    ds_read_b64 v[218:219], v2 offset:23368
    s_waitcnt lgkmcnt(11)
    v_mfma_f32_16x16x32_bf16 v[36:39], v[180:183], v[188:191], v[36:39]
    ds_read_b64 v[220:221], v2 offset:128
    ds_read_b64 v[222:223], v2 offset:136
    s_waitcnt lgkmcnt(11)
    v_mfma_f32_16x16x32_bf16 v[32:35], v[192:195], v[188:191], v[32:35]
    ds_read_b128 v[224:227], v4 offset:1664
    ds_read_b128 v[228:231], v4 offset:2176
    s_waitcnt lgkmcnt(12)
    v_mfma_f32_16x16x32_bf16 v[36:39], v[192:195], v[196:199], v[36:39]
    ds_read_b128 v[232:235], v4 offset:2688
    s_waitcnt lgkmcnt(11)
    v_mfma_f32_16x16x32_bf16 v[32:35], v[200:203], v[196:199], v[32:35]
    ds_read_b128 v[236:239], v4 offset:3712
    s_waitcnt lgkmcnt(11)
    v_mfma_f32_16x16x32_bf16 v[36:39], v[200:203], v[204:207], v[36:39]
    ds_read_b64 v[240:241], v2 offset:640
    ds_read_b64 v[242:243], v2 offset:648
    s_waitcnt lgkmcnt(11)
    v_mfma_f32_16x16x32_bf16 v[32:35], v[208:211], v[204:207], v[32:35]
    s_waitcnt lgkmcnt(10)
    v_mfma_f32_16x16x32_bf16 v[36:39], v[208:211], v[212:215], v[36:39]
    ds_read_b128 v[244:247], v4 offset:3200
    s_waitcnt lgkmcnt(9)
    v_mfma_f32_16x16x32_bf16 v[32:35], v[216:219], v[212:215], v[32:35]
    ds_read_b64 v[64:65], v2 offset:1152
    ds_read_b64 v[66:67], v2 offset:1160
    s_waitcnt lgkmcnt(9)
    s_waitcnt lgkmcnt(8)
    v_mfma_f32_16x16x32_bf16 v[16:19], v[220:223], v[224:227], v[16:19]
    s_waitcnt lgkmcnt(7)
    v_mfma_f32_16x16x32_bf16 v[20:23], v[220:223], v[228:231], v[20:23]
    s_waitcnt lgkmcnt(6)
    v_mfma_f32_16x16x32_bf16 v[24:27], v[220:223], v[232:235], v[24:27]
    ds_read_b64 v[92:93], v2 offset:1664
    ds_read_b64 v[94:95], v2 offset:1672
    s_waitcnt lgkmcnt(7)
    v_mfma_f32_16x16x32_bf16 v[28:31], v[220:223], v[236:239], v[28:31]
    s_waitcnt lgkmcnt(5)
    v_mfma_f32_16x16x32_bf16 v[16:19], v[240:243], v[228:231], v[16:19]
    ds_read_b64 v[72:73], v2 offset:2176
    ds_read_b64 v[74:75], v2 offset:2184
    v_mfma_f32_16x16x32_bf16 v[20:23], v[240:243], v[232:235], v[20:23]
    ds_read_b64 v[84:85], v2 offset:21376
    ds_read_b64 v[86:87], v2 offset:21384
    ds_read_b128 v[80:83], v4 offset:22912
    s_waitcnt lgkmcnt(9)
    v_mfma_f32_16x16x32_bf16 v[24:27], v[240:243], v[244:247], v[24:27]
    ds_read_b128 v[68:71], v4 offset:23424
    s_waitcnt lgkmcnt(8)
    v_mfma_f32_16x16x32_bf16 v[16:19], v[64:67], v[232:235], v[16:19]
    ds_read_b64 v[88:89], v2 offset:21888
    ds_read_b64 v[90:91], v2 offset:21896
    v_mfma_f32_16x16x32_bf16 v[20:23], v[64:67], v[244:247], v[20:23]
    ds_read_b128 v[76:79], v4 offset:23936
    v_mfma_f32_16x16x32_bf16 v[24:27], v[64:67], v[236:239], v[24:27]
    ds_read_b64 v[60:61], v2 offset:22400
    ds_read_b64 v[62:63], v2 offset:22408
    s_waitcnt lgkmcnt(11)
    v_mfma_f32_16x16x32_bf16 v[16:19], v[92:95], v[244:247], v[16:19]
    ds_read_b128 v[96:99], v4 offset:24448
    v_mfma_f32_16x16x32_bf16 v[20:23], v[92:95], v[236:239], v[20:23]
    ds_read_b64 v[104:105], v2 offset:22912
    ds_read_b64 v[106:107], v2 offset:22920
    s_waitcnt lgkmcnt(12)
    v_mfma_f32_16x16x32_bf16 v[16:19], v[72:75], v[236:239], v[16:19]
    ds_read_b128 v[132:135], v4 offset:24960
    s_waitcnt lgkmcnt(11)
    s_waitcnt lgkmcnt(10)
    v_mfma_f32_16x16x32_bf16 v[32:35], v[84:87], v[80:83], v[32:35]
    ds_read_b64 v[100:101], v2 offset:23424
    ds_read_b64 v[102:103], v2 offset:23432
    s_waitcnt lgkmcnt(11)
    v_mfma_f32_16x16x32_bf16 v[36:39], v[84:87], v[68:71], v[36:39]
    ds_read_b64 v[112:113], v2 offset:192
    ds_read_b64 v[114:115], v2 offset:200
    s_waitcnt lgkmcnt(11)
    v_mfma_f32_16x16x32_bf16 v[32:35], v[88:91], v[68:71], v[32:35]
    ds_read_b128 v[108:111], v4 offset:1728
    ds_read_b128 v[120:123], v4 offset:2240
    s_waitcnt lgkmcnt(12)
    v_mfma_f32_16x16x32_bf16 v[36:39], v[88:91], v[76:79], v[36:39]
    ds_read_b128 v[116:119], v4 offset:2752
    s_waitcnt lgkmcnt(11)
    v_mfma_f32_16x16x32_bf16 v[32:35], v[60:63], v[76:79], v[32:35]
    ds_read_b128 v[128:131], v4 offset:3776
    s_waitcnt lgkmcnt(11)
    v_mfma_f32_16x16x32_bf16 v[36:39], v[60:63], v[96:99], v[36:39]
    ds_read_b64 v[124:125], v2 offset:704
    ds_read_b64 v[126:127], v2 offset:712
    s_waitcnt lgkmcnt(11)
    v_mfma_f32_16x16x32_bf16 v[32:35], v[104:107], v[96:99], v[32:35]
    s_waitcnt lgkmcnt(10)
    v_mfma_f32_16x16x32_bf16 v[36:39], v[104:107], v[132:135], v[36:39]
    ds_read_b128 v[136:139], v4 offset:3264
    s_waitcnt lgkmcnt(9)
    v_mfma_f32_16x16x32_bf16 v[32:35], v[100:103], v[132:135], v[32:35]
    ds_read_b64 v[144:145], v2 offset:1216
    ds_read_b64 v[146:147], v2 offset:1224
    s_waitcnt lgkmcnt(9)
    s_waitcnt lgkmcnt(8)
    v_mfma_f32_16x16x32_bf16 v[16:19], v[112:115], v[108:111], v[16:19]
    s_waitcnt lgkmcnt(7)
    v_mfma_f32_16x16x32_bf16 v[20:23], v[112:115], v[120:123], v[20:23]
    s_waitcnt lgkmcnt(6)
    v_mfma_f32_16x16x32_bf16 v[24:27], v[112:115], v[116:119], v[24:27]
    ds_read_b64 v[140:141], v2 offset:1728
    ds_read_b64 v[142:143], v2 offset:1736
    s_waitcnt lgkmcnt(7)
    v_mfma_f32_16x16x32_bf16 v[28:31], v[112:115], v[128:131], v[28:31]
    s_waitcnt lgkmcnt(5)
    v_mfma_f32_16x16x32_bf16 v[16:19], v[124:127], v[120:123], v[16:19]
    ds_read_b64 v[148:149], v2 offset:2240
    ds_read_b64 v[150:151], v2 offset:2248
    v_mfma_f32_16x16x32_bf16 v[20:23], v[124:127], v[116:119], v[20:23]
    ds_read_b64 v[160:161], v2 offset:21440
    ds_read_b64 v[162:163], v2 offset:21448
    ds_read_b128 v[152:155], v4 offset:22976
    s_waitcnt lgkmcnt(9)
    v_mfma_f32_16x16x32_bf16 v[24:27], v[124:127], v[136:139], v[24:27]
    ds_read_b128 v[168:171], v4 offset:23488
    s_waitcnt lgkmcnt(8)
    v_mfma_f32_16x16x32_bf16 v[16:19], v[144:147], v[116:119], v[16:19]
    ds_read_b64 v[164:165], v2 offset:21952
    ds_read_b64 v[166:167], v2 offset:21960
    v_mfma_f32_16x16x32_bf16 v[20:23], v[144:147], v[136:139], v[20:23]
    ds_read_b128 v[172:175], v4 offset:24000
    v_mfma_f32_16x16x32_bf16 v[24:27], v[144:147], v[128:131], v[24:27]
    ds_read_b64 v[176:177], v2 offset:22464
    ds_read_b64 v[178:179], v2 offset:22472
    s_waitcnt lgkmcnt(11)
    v_mfma_f32_16x16x32_bf16 v[16:19], v[140:143], v[136:139], v[16:19]
    ds_read_b128 v[156:159], v4 offset:24512
    v_mfma_f32_16x16x32_bf16 v[20:23], v[140:143], v[128:131], v[20:23]
    ds_read_b64 v[184:185], v2 offset:22976
    ds_read_b64 v[186:187], v2 offset:22984
    s_waitcnt lgkmcnt(12)
    v_mfma_f32_16x16x32_bf16 v[16:19], v[148:151], v[128:131], v[16:19]
    ds_read_b128 v[180:183], v4 offset:25024
    s_waitcnt lgkmcnt(11)
    s_waitcnt lgkmcnt(10)
    v_mfma_f32_16x16x32_bf16 v[32:35], v[160:163], v[152:155], v[32:35]
    ds_read_b64 v[188:189], v2 offset:23488
    ds_read_b64 v[190:191], v2 offset:23496
    s_waitcnt lgkmcnt(11)
    v_mfma_f32_16x16x32_bf16 v[36:39], v[160:163], v[168:171], v[36:39]
    ds_read_b64 v[192:193], v2 offset:256
    ds_read_b64 v[194:195], v2 offset:264
    s_waitcnt lgkmcnt(11)
    v_mfma_f32_16x16x32_bf16 v[32:35], v[164:167], v[168:171], v[32:35]
    ds_read_b128 v[196:199], v4 offset:1792
    ds_read_b128 v[200:203], v4 offset:2304
    s_waitcnt lgkmcnt(12)
    v_mfma_f32_16x16x32_bf16 v[36:39], v[164:167], v[172:175], v[36:39]
    ds_read_b128 v[204:207], v4 offset:2816
    s_waitcnt lgkmcnt(11)
    v_mfma_f32_16x16x32_bf16 v[32:35], v[176:179], v[172:175], v[32:35]
    ds_read_b128 v[208:211], v4 offset:3840
    s_waitcnt lgkmcnt(11)
    v_mfma_f32_16x16x32_bf16 v[36:39], v[176:179], v[156:159], v[36:39]
    ds_read_b64 v[216:217], v2 offset:768
    ds_read_b64 v[218:219], v2 offset:776
    s_waitcnt lgkmcnt(11)
    v_mfma_f32_16x16x32_bf16 v[32:35], v[184:187], v[156:159], v[32:35]
    s_waitcnt lgkmcnt(10)
    v_mfma_f32_16x16x32_bf16 v[36:39], v[184:187], v[180:183], v[36:39]
    ds_read_b128 v[212:215], v4 offset:3328
    s_waitcnt lgkmcnt(9)
    v_mfma_f32_16x16x32_bf16 v[32:35], v[188:191], v[180:183], v[32:35]
    ds_read_b64 v[224:225], v2 offset:1280
    ds_read_b64 v[226:227], v2 offset:1288
    s_waitcnt lgkmcnt(9)
    s_waitcnt lgkmcnt(8)
    v_mfma_f32_16x16x32_bf16 v[16:19], v[192:195], v[196:199], v[16:19]
    s_waitcnt lgkmcnt(7)
    v_mfma_f32_16x16x32_bf16 v[20:23], v[192:195], v[200:203], v[20:23]
    s_waitcnt lgkmcnt(6)
    v_mfma_f32_16x16x32_bf16 v[24:27], v[192:195], v[204:207], v[24:27]
    ds_read_b64 v[220:221], v2 offset:1792
    ds_read_b64 v[222:223], v2 offset:1800
    s_waitcnt lgkmcnt(7)
    v_mfma_f32_16x16x32_bf16 v[28:31], v[192:195], v[208:211], v[28:31]
    s_waitcnt lgkmcnt(5)
    v_mfma_f32_16x16x32_bf16 v[16:19], v[216:219], v[200:203], v[16:19]
    ds_read_b64 v[228:229], v2 offset:2304
    ds_read_b64 v[230:231], v2 offset:2312
    v_mfma_f32_16x16x32_bf16 v[20:23], v[216:219], v[204:207], v[20:23]
    ds_read_b64 v[240:241], v2 offset:21504
    ds_read_b64 v[242:243], v2 offset:21512
    ds_read_b128 v[232:235], v4 offset:23040
    s_waitcnt lgkmcnt(9)
    v_mfma_f32_16x16x32_bf16 v[24:27], v[216:219], v[212:215], v[24:27]
    ds_read_b128 v[64:67], v4 offset:23552
    s_waitcnt lgkmcnt(8)
    v_mfma_f32_16x16x32_bf16 v[16:19], v[224:227], v[204:207], v[16:19]
    ds_read_b64 v[244:245], v2 offset:22016
    ds_read_b64 v[246:247], v2 offset:22024
    v_mfma_f32_16x16x32_bf16 v[20:23], v[224:227], v[212:215], v[20:23]
    ds_read_b128 v[92:95], v4 offset:24064
    v_mfma_f32_16x16x32_bf16 v[24:27], v[224:227], v[208:211], v[24:27]
    ds_read_b64 v[72:73], v2 offset:22528
    ds_read_b64 v[74:75], v2 offset:22536
    s_waitcnt lgkmcnt(11)
    v_mfma_f32_16x16x32_bf16 v[16:19], v[220:223], v[212:215], v[16:19]
    ds_read_b128 v[236:239], v4 offset:24576
    v_mfma_f32_16x16x32_bf16 v[20:23], v[220:223], v[208:211], v[20:23]
    ds_read_b64 v[80:81], v2 offset:23040
    ds_read_b64 v[82:83], v2 offset:23048
    s_waitcnt lgkmcnt(12)
    v_mfma_f32_16x16x32_bf16 v[16:19], v[228:231], v[208:211], v[16:19]
    ds_read_b128 v[84:87], v4 offset:25088
    s_waitcnt lgkmcnt(11)
    s_waitcnt lgkmcnt(10)
    v_mfma_f32_16x16x32_bf16 v[32:35], v[240:243], v[232:235], v[32:35]
    ds_read_b64 v[68:69], v2 offset:23552
    ds_read_b64 v[70:71], v2 offset:23560
    s_waitcnt lgkmcnt(11)
    v_mfma_f32_16x16x32_bf16 v[36:39], v[240:243], v[64:67], v[36:39]
    ds_read_b64 v[88:89], v2 offset:320
    ds_read_b64 v[90:91], v2 offset:328
    s_waitcnt lgkmcnt(11)
    v_mfma_f32_16x16x32_bf16 v[32:35], v[244:247], v[64:67], v[32:35]
    ds_read_b128 v[76:79], v4 offset:1856
    ds_read_b128 v[60:63], v4 offset:2368
    s_waitcnt lgkmcnt(12)
    v_mfma_f32_16x16x32_bf16 v[36:39], v[244:247], v[92:95], v[36:39]
    ds_read_b128 v[96:99], v4 offset:2880
    s_waitcnt lgkmcnt(11)
    v_mfma_f32_16x16x32_bf16 v[32:35], v[72:75], v[92:95], v[32:35]
    ds_read_b128 v[104:107], v4 offset:3904
    s_waitcnt lgkmcnt(11)
    v_mfma_f32_16x16x32_bf16 v[36:39], v[72:75], v[236:239], v[36:39]
    ds_read_b64 v[100:101], v2 offset:832
    ds_read_b64 v[102:103], v2 offset:840
    s_waitcnt lgkmcnt(11)
    v_mfma_f32_16x16x32_bf16 v[32:35], v[80:83], v[236:239], v[32:35]
    s_waitcnt lgkmcnt(10)
    v_mfma_f32_16x16x32_bf16 v[36:39], v[80:83], v[84:87], v[36:39]
    ds_read_b128 v[132:135], v4 offset:3392
    s_waitcnt lgkmcnt(9)
    v_mfma_f32_16x16x32_bf16 v[32:35], v[68:71], v[84:87], v[32:35]
    ds_read_b64 v[108:109], v2 offset:1344
    ds_read_b64 v[110:111], v2 offset:1352
    s_waitcnt lgkmcnt(9)
    s_waitcnt lgkmcnt(8)
    v_mfma_f32_16x16x32_bf16 v[16:19], v[88:91], v[76:79], v[16:19]
    s_waitcnt lgkmcnt(7)
    v_mfma_f32_16x16x32_bf16 v[20:23], v[88:91], v[60:63], v[20:23]
    s_waitcnt lgkmcnt(6)
    v_mfma_f32_16x16x32_bf16 v[24:27], v[88:91], v[96:99], v[24:27]
    ds_read_b64 v[112:113], v2 offset:1856
    ds_read_b64 v[114:115], v2 offset:1864
    s_waitcnt lgkmcnt(7)
    v_mfma_f32_16x16x32_bf16 v[28:31], v[88:91], v[104:107], v[28:31]
    s_waitcnt lgkmcnt(5)
    v_mfma_f32_16x16x32_bf16 v[16:19], v[100:103], v[60:63], v[16:19]
    ds_read_b64 v[120:121], v2 offset:2368
    ds_read_b64 v[122:123], v2 offset:2376
    v_mfma_f32_16x16x32_bf16 v[20:23], v[100:103], v[96:99], v[20:23]
    ds_read_b64 v[124:125], v2 offset:21568
    ds_read_b64 v[126:127], v2 offset:21576
    ds_read_b128 v[116:119], v4 offset:23104
    s_waitcnt lgkmcnt(9)
    v_mfma_f32_16x16x32_bf16 v[24:27], v[100:103], v[132:135], v[24:27]
    ds_read_b128 v[144:147], v4 offset:23616
    s_waitcnt lgkmcnt(8)
    v_mfma_f32_16x16x32_bf16 v[16:19], v[108:111], v[96:99], v[16:19]
    ds_read_b64 v[136:137], v2 offset:22080
    ds_read_b64 v[138:139], v2 offset:22088
    v_mfma_f32_16x16x32_bf16 v[20:23], v[108:111], v[132:135], v[20:23]
    ds_read_b128 v[140:143], v4 offset:24128
    v_mfma_f32_16x16x32_bf16 v[24:27], v[108:111], v[104:107], v[24:27]
    ds_read_b64 v[148:149], v2 offset:22592
    ds_read_b64 v[150:151], v2 offset:22600
    s_waitcnt lgkmcnt(11)
    v_mfma_f32_16x16x32_bf16 v[16:19], v[112:115], v[132:135], v[16:19]
    ds_read_b128 v[128:131], v4 offset:24640
    v_mfma_f32_16x16x32_bf16 v[20:23], v[112:115], v[104:107], v[20:23]
    ds_read_b64 v[152:153], v2 offset:23104
    ds_read_b64 v[154:155], v2 offset:23112
    s_waitcnt lgkmcnt(12)
    v_mfma_f32_16x16x32_bf16 v[16:19], v[120:123], v[104:107], v[16:19]
    ds_read_b128 v[160:163], v4 offset:25152
    s_waitcnt lgkmcnt(11)
    s_waitcnt lgkmcnt(10)
    v_mfma_f32_16x16x32_bf16 v[32:35], v[124:127], v[116:119], v[32:35]
    ds_read_b64 v[168:169], v2 offset:23616
    ds_read_b64 v[170:171], v2 offset:23624
    s_waitcnt lgkmcnt(11)
    v_mfma_f32_16x16x32_bf16 v[36:39], v[124:127], v[144:147], v[36:39]
    ds_read_b64 v[164:165], v2 offset:384
    ds_read_b64 v[166:167], v2 offset:392
    s_waitcnt lgkmcnt(11)
    v_mfma_f32_16x16x32_bf16 v[32:35], v[136:139], v[144:147], v[32:35]
    ds_read_b128 v[172:175], v4 offset:1920
    ds_read_b128 v[176:179], v4 offset:2432
    s_waitcnt lgkmcnt(12)
    v_mfma_f32_16x16x32_bf16 v[36:39], v[136:139], v[140:143], v[36:39]
    ds_read_b128 v[156:159], v4 offset:2944
    s_waitcnt lgkmcnt(11)
    v_mfma_f32_16x16x32_bf16 v[32:35], v[148:151], v[140:143], v[32:35]
    ds_read_b128 v[184:187], v4 offset:3968
    s_waitcnt lgkmcnt(11)
    v_mfma_f32_16x16x32_bf16 v[36:39], v[148:151], v[128:131], v[36:39]
    ds_read_b64 v[188:189], v2 offset:896
    ds_read_b64 v[190:191], v2 offset:904
    s_waitcnt lgkmcnt(11)
    v_mfma_f32_16x16x32_bf16 v[32:35], v[152:155], v[128:131], v[32:35]
    s_waitcnt lgkmcnt(10)
    v_mfma_f32_16x16x32_bf16 v[36:39], v[152:155], v[160:163], v[36:39]
    ds_read_b128 v[180:183], v4 offset:3456
    s_waitcnt lgkmcnt(9)
    v_mfma_f32_16x16x32_bf16 v[32:35], v[168:171], v[160:163], v[32:35]
    ds_read_b64 v[196:197], v2 offset:1408
    ds_read_b64 v[198:199], v2 offset:1416
    s_waitcnt lgkmcnt(9)
    s_waitcnt lgkmcnt(8)
    v_mfma_f32_16x16x32_bf16 v[16:19], v[164:167], v[172:175], v[16:19]
    s_waitcnt lgkmcnt(7)
    v_mfma_f32_16x16x32_bf16 v[20:23], v[164:167], v[176:179], v[20:23]
    s_waitcnt lgkmcnt(6)
    v_mfma_f32_16x16x32_bf16 v[24:27], v[164:167], v[156:159], v[24:27]
    ds_read_b64 v[192:193], v2 offset:1920
    ds_read_b64 v[194:195], v2 offset:1928
    s_waitcnt lgkmcnt(7)
    v_mfma_f32_16x16x32_bf16 v[28:31], v[164:167], v[184:187], v[28:31]
    s_waitcnt lgkmcnt(5)
    v_mfma_f32_16x16x32_bf16 v[16:19], v[188:191], v[176:179], v[16:19]
    ds_read_b64 v[200:201], v2 offset:2432
    ds_read_b64 v[202:203], v2 offset:2440
    v_mfma_f32_16x16x32_bf16 v[20:23], v[188:191], v[156:159], v[20:23]
    ds_read_b64 v[216:217], v2 offset:21632
    ds_read_b64 v[218:219], v2 offset:21640
    ds_read_b128 v[204:207], v4 offset:23168
    s_waitcnt lgkmcnt(9)
    v_mfma_f32_16x16x32_bf16 v[24:27], v[188:191], v[180:183], v[24:27]
    ds_read_b128 v[224:227], v4 offset:23680
    s_waitcnt lgkmcnt(8)
    v_mfma_f32_16x16x32_bf16 v[16:19], v[196:199], v[156:159], v[16:19]
    ds_read_b64 v[212:213], v2 offset:22144
    ds_read_b64 v[214:215], v2 offset:22152
    v_mfma_f32_16x16x32_bf16 v[20:23], v[196:199], v[180:183], v[20:23]
    ds_read_b128 v[220:223], v4 offset:24192
    v_mfma_f32_16x16x32_bf16 v[24:27], v[196:199], v[184:187], v[24:27]
    ds_read_b64 v[228:229], v2 offset:22656
    ds_read_b64 v[230:231], v2 offset:22664
    s_waitcnt lgkmcnt(11)
    v_mfma_f32_16x16x32_bf16 v[16:19], v[192:195], v[180:183], v[16:19]
    ds_read_b128 v[208:211], v4 offset:24704
    v_mfma_f32_16x16x32_bf16 v[20:23], v[192:195], v[184:187], v[20:23]
    ds_read_b64 v[232:233], v2 offset:23168
    ds_read_b64 v[234:235], v2 offset:23176
    s_waitcnt lgkmcnt(12)
    v_mfma_f32_16x16x32_bf16 v[16:19], v[200:203], v[184:187], v[16:19]
    ds_read_b128 v[240:243], v4 offset:25216
    s_waitcnt lgkmcnt(11)
    s_waitcnt lgkmcnt(10)
    v_mfma_f32_16x16x32_bf16 v[32:35], v[216:219], v[204:207], v[32:35]
    ds_read_b64 v[64:65], v2 offset:23680
    ds_read_b64 v[66:67], v2 offset:23688
    s_waitcnt lgkmcnt(11)
    v_mfma_f32_16x16x32_bf16 v[36:39], v[216:219], v[224:227], v[36:39]
    ds_read_b64 v[244:245], v2 offset:448
    ds_read_b64 v[246:247], v2 offset:456
    s_waitcnt lgkmcnt(11)
    v_mfma_f32_16x16x32_bf16 v[32:35], v[212:215], v[224:227], v[32:35]
    ds_read_b128 v[92:95], v4 offset:1984
    ds_read_b128 v[72:75], v4 offset:2496
    s_waitcnt lgkmcnt(12)
    v_mfma_f32_16x16x32_bf16 v[36:39], v[212:215], v[220:223], v[36:39]
    ds_read_b128 v[236:239], v4 offset:3008
    s_waitcnt lgkmcnt(11)
    v_mfma_f32_16x16x32_bf16 v[32:35], v[228:231], v[220:223], v[32:35]
    ds_read_b128 v[80:83], v4 offset:4032
    s_waitcnt lgkmcnt(11)
    v_mfma_f32_16x16x32_bf16 v[36:39], v[228:231], v[208:211], v[36:39]
    ds_read_b64 v[68:69], v2 offset:960
    ds_read_b64 v[70:71], v2 offset:968
    s_waitcnt lgkmcnt(11)
    v_mfma_f32_16x16x32_bf16 v[32:35], v[232:235], v[208:211], v[32:35]
    s_waitcnt lgkmcnt(10)
    v_mfma_f32_16x16x32_bf16 v[36:39], v[232:235], v[240:243], v[36:39]
    ds_read_b128 v[84:87], v4 offset:3520
    s_waitcnt lgkmcnt(9)
    v_mfma_f32_16x16x32_bf16 v[32:35], v[64:67], v[240:243], v[32:35]
    ds_read_b64 v[76:77], v2 offset:1472
    ds_read_b64 v[78:79], v2 offset:1480
    s_setprio 1
    s_waitcnt lgkmcnt(9)
    s_waitcnt lgkmcnt(8)
    v_mfma_f32_16x16x32_bf16 v[16:19], v[244:247], v[92:95], v[16:19]
    s_waitcnt lgkmcnt(7)
    v_mfma_f32_16x16x32_bf16 v[20:23], v[244:247], v[72:75], v[20:23]
    s_waitcnt lgkmcnt(6)
    v_mfma_f32_16x16x32_bf16 v[24:27], v[244:247], v[236:239], v[24:27]
    ds_read_b64 v[88:89], v2 offset:1984
    ds_read_b64 v[90:91], v2 offset:1992
    s_waitcnt lgkmcnt(7)
    v_mfma_f32_16x16x32_bf16 v[28:31], v[244:247], v[80:83], v[28:31]
    s_waitcnt lgkmcnt(5)
    v_mfma_f32_16x16x32_bf16 v[16:19], v[68:71], v[72:75], v[16:19]
    ds_read_b64 v[60:61], v2 offset:2496
    ds_read_b64 v[62:63], v2 offset:2504
    v_mfma_f32_16x16x32_bf16 v[20:23], v[68:71], v[236:239], v[20:23]
    ds_read_b64 v[100:101], v2 offset:21696
    ds_read_b64 v[102:103], v2 offset:21704
    ds_read_b128 v[96:99], v4 offset:23232
    v_cvt_pk_bf16_f32 v50, v28, v29
    v_cvt_pk_bf16_f32 v51, v30, v31
    v_pk_min_u16 v50, v50, s66
    v_pk_min_u16 v51, v51, s66
    buffer_store_dwordx2 v[50:51], v7, s[44:47], s56 offen offset:0 sc1
    s_waitcnt lgkmcnt(9)
    v_mfma_f32_16x16x32_bf16 v[24:27], v[68:71], v[84:87], v[24:27]
    ds_read_b128 v[108:111], v4 offset:23744
    s_waitcnt lgkmcnt(8)
    v_mfma_f32_16x16x32_bf16 v[16:19], v[76:79], v[236:239], v[16:19]
    ds_read_b64 v[132:133], v2 offset:22208
    ds_read_b64 v[134:135], v2 offset:22216
    v_mfma_f32_16x16x32_bf16 v[20:23], v[76:79], v[84:87], v[20:23]
    ds_read_b128 v[112:115], v4 offset:24256
    v_mfma_f32_16x16x32_bf16 v[24:27], v[76:79], v[80:83], v[24:27]
    ds_read_b64 v[120:121], v2 offset:22720
    ds_read_b64 v[122:123], v2 offset:22728
    s_waitcnt lgkmcnt(11)
    v_mfma_f32_16x16x32_bf16 v[16:19], v[88:91], v[84:87], v[16:19]
    ds_read_b128 v[104:107], v4 offset:24768
    v_mfma_f32_16x16x32_bf16 v[20:23], v[88:91], v[80:83], v[20:23]
    ds_read_b64 v[116:117], v2 offset:23232
    ds_read_b64 v[118:119], v2 offset:23240
    v_cvt_pk_bf16_f32 v48, v24, v25
    v_cvt_pk_bf16_f32 v49, v26, v27
    v_pk_min_u16 v48, v48, s66
    v_pk_min_u16 v49, v49, s66
    buffer_store_dwordx2 v[48:49], v7, s[44:47], s56 offen offset:1024 sc1
    s_waitcnt lgkmcnt(12)
    v_mfma_f32_16x16x32_bf16 v[16:19], v[60:63], v[80:83], v[16:19]
    ds_read_b128 v[124:127], v4 offset:25280
    s_waitcnt lgkmcnt(11)
    s_waitcnt lgkmcnt(10)
    v_mfma_f32_16x16x32_bf16 v[32:35], v[100:103], v[96:99], v[32:35]
    ds_read_b64 v[144:145], v2 offset:23744
    ds_read_b64 v[146:147], v2 offset:23752
    v_cvt_pk_bf16_f32 v46, v20, v21
    v_cvt_pk_bf16_f32 v47, v22, v23
    v_pk_min_u16 v46, v46, s66
    v_pk_min_u16 v47, v47, s66
    buffer_store_dwordx2 v[46:47], v7, s[44:47], s56 offen offset:1536 sc1
    s_waitcnt lgkmcnt(11)
    v_mfma_f32_16x16x32_bf16 v[36:39], v[100:103], v[108:111], v[36:39]
    v_cvt_pk_bf16_f32 v44, v16, v17
    v_cvt_pk_bf16_f32 v45, v18, v19
    v_pk_min_u16 v44, v44, s66
    v_pk_min_u16 v45, v45, s66
    buffer_store_dwordx2 v[44:45], v7, s[44:47], s56 offen offset:2048 sc1
    s_waitcnt lgkmcnt(9)
    v_mfma_f32_16x16x32_bf16 v[32:35], v[132:135], v[108:111], v[32:35]
    s_waitcnt lgkmcnt(8)
    v_mfma_f32_16x16x32_bf16 v[36:39], v[132:135], v[112:115], v[36:39]
    s_waitcnt lgkmcnt(6)
    v_mfma_f32_16x16x32_bf16 v[32:35], v[120:123], v[112:115], v[32:35]
    s_waitcnt lgkmcnt(5)
    v_mfma_f32_16x16x32_bf16 v[36:39], v[120:123], v[104:107], v[36:39]
    s_waitcnt lgkmcnt(3)
    v_mfma_f32_16x16x32_bf16 v[32:35], v[116:119], v[104:107], v[32:35]
    s_waitcnt lgkmcnt(2)
    v_mfma_f32_16x16x32_bf16 v[36:39], v[116:119], v[124:127], v[36:39]
    s_waitcnt lgkmcnt(0)
    v_mfma_f32_16x16x32_bf16 v[32:35], v[144:147], v[124:127], v[32:35]
    s_nop 5
    v_cvt_pk_bf16_f32 v54, v36, v37
    v_cvt_pk_bf16_f32 v55, v38, v39
    v_pk_min_u16 v54, v54, s66
    v_pk_min_u16 v55, v55, s66
    buffer_store_dwordx2 v[54:55], v7, s[44:47], s57 offen offset:1536 sc1
    v_cvt_pk_bf16_f32 v52, v32, v33
    v_cvt_pk_bf16_f32 v53, v34, v35
    v_pk_min_u16 v52, v52, s66
    v_pk_min_u16 v53, v53, s66
    buffer_store_dwordx2 v[52:53], v7, s[44:47], s57 offen offset:2048 sc1
    s_nop 0
    s_branch K2_CP
K2_CV2:
    ds_read_b64 v[44:45], v6 offset:42496
    ds_read_b64 v[46:47], v6 offset:43008
    ds_read_b64 v[48:49], v6 offset:45056
    ds_read_b64 v[50:51], v6 offset:23808
    ds_read_b64 v[52:53], v6 offset:24832
    ds_read_b64 v[60:61], v2 offset:42496
    ds_read_b64 v[62:63], v2 offset:42504
    ds_read_b128 v[64:67], v4 offset:42496
    ds_read_b64 v[68:69], v2 offset:43008
    ds_read_b64 v[70:71], v2 offset:43016
    ds_read_b128 v[72:75], v4 offset:43008
    ds_read_b64 v[76:77], v2 offset:43520
    ds_read_b64 v[78:79], v2 offset:43528
    s_waitcnt lgkmcnt(8)
    v_and_b32 v16, 0xffff0000, v45
    v_lshlrev_b32 v17, 16, v45
    v_and_b32 v18, 0xffff0000, v44
    v_lshlrev_b32 v19, 16, v44
    v_mul_f32 v16, s62, v16
    v_mul_f32 v17, s62, v17
    v_mul_f32 v18, s62, v18
    v_mul_f32 v19, s62, v19
    s_waitcnt lgkmcnt(6)
    s_waitcnt lgkmcnt(5)
    v_mfma_f32_16x16x32_bf16 v[16:19], v[60:63], v[64:67], v[16:19]
    ds_read_b128 v[80:83], v4 offset:43520
    ds_read_b64 v[84:85], v2 offset:44032
    ds_read_b64 v[86:87], v2 offset:44040
    ds_read_b128 v[88:91], v4 offset:44032
    v_and_b32 v20, 0xffff0000, v47
    v_lshlrev_b32 v21, 16, v47
    v_and_b32 v22, 0xffff0000, v46
    v_lshlrev_b32 v23, 16, v46
    s_waitcnt lgkmcnt(7)
    s_waitcnt lgkmcnt(6)
    v_mfma_f32_16x16x32_bf16 v[16:19], v[68:71], v[72:75], v[16:19]
    ds_read_b64 v[92:93], v2 offset:44544
    ds_read_b64 v[94:95], v2 offset:44552
    ds_read_b128 v[96:99], v4 offset:44544
    ds_read_b64 v[100:101], v2 offset:45056
    ds_read_b64 v[102:103], v2 offset:45064
    v_mul_f32 v20, s62, v20
    v_mul_f32 v21, s62, v21
    v_mul_f32 v22, s62, v22
    v_mul_f32 v23, s62, v23
    s_waitcnt lgkmcnt(9)
    s_waitcnt lgkmcnt(8)
    v_mfma_f32_16x16x32_bf16 v[16:19], v[76:79], v[80:83], v[16:19]
    ds_read_b128 v[104:107], v4 offset:45056
    ds_read_b64 v[108:109], v2 offset:45568
    ds_read_b64 v[110:111], v2 offset:45576
    ds_read_b128 v[112:115], v4 offset:45568
    v_and_b32 v24, 0xffff0000, v49
    v_lshlrev_b32 v25, 16, v49
    v_and_b32 v26, 0xffff0000, v48
    v_lshlrev_b32 v27, 16, v48
    s_waitcnt lgkmcnt(10)
    s_waitcnt lgkmcnt(9)
    v_mfma_f32_16x16x32_bf16 v[16:19], v[84:87], v[88:91], v[16:19]
    ds_read_b64 v[116:117], v2 offset:46080
    ds_read_b64 v[118:119], v2 offset:46088
    ds_read_b128 v[120:123], v4 offset:46080
    v_mul_f32 v24, s62, v24
    v_mul_f32 v25, s62, v25
    v_mul_f32 v26, s62, v26
    v_mul_f32 v27, s62, v27
    s_waitcnt lgkmcnt(10)
    s_waitcnt lgkmcnt(9)
    v_mfma_f32_16x16x32_bf16 v[16:19], v[92:95], v[96:99], v[16:19]
    v_and_b32 v28, 0xffff0000, v51
    v_lshlrev_b32 v29, 16, v51
    v_and_b32 v30, 0xffff0000, v50
    v_lshlrev_b32 v31, 16, v50
    s_waitcnt lgkmcnt(7)
    s_waitcnt lgkmcnt(6)
    v_mfma_f32_16x16x32_bf16 v[16:19], v[100:103], v[104:107], v[16:19]
    v_mul_f32 v28, s61, v28
    v_mul_f32 v29, s61, v29
    v_mul_f32 v30, s61, v30
    v_mul_f32 v31, s61, v31
    s_waitcnt lgkmcnt(4)
    s_waitcnt lgkmcnt(3)
    v_mfma_f32_16x16x32_bf16 v[16:19], v[108:111], v[112:115], v[16:19]
    v_and_b32 v32, 0xffff0000, v53
    v_lshlrev_b32 v33, 16, v53
    v_and_b32 v34, 0xffff0000, v52
    v_lshlrev_b32 v35, 16, v52
    s_waitcnt lgkmcnt(1)
    s_waitcnt lgkmcnt(0)
    v_mfma_f32_16x16x32_bf16 v[16:19], v[116:119], v[120:123], v[16:19]
    v_mul_f32 v32, s61, v32
    v_mul_f32 v33, s61, v33
    v_mul_f32 v34, s61, v34
    v_mul_f32 v35, s61, v35
    v_mfma_f32_16x16x32_bf16 v[20:23], v[60:63], v[72:75], v[20:23]
    v_mfma_f32_16x16x32_bf16 v[20:23], v[68:71], v[80:83], v[20:23]
    v_mfma_f32_16x16x32_bf16 v[20:23], v[76:79], v[88:91], v[20:23]
    ds_read_b64 v[124:125], v2 offset:21248
    ds_read_b64 v[126:127], v2 offset:21256
    ds_read_b128 v[128:131], v4 offset:23808
    v_mfma_f32_16x16x32_bf16 v[20:23], v[84:87], v[96:99], v[20:23]
    ds_read_b64 v[132:133], v2 offset:21760
    ds_read_b64 v[134:135], v2 offset:21768
    ds_read_b128 v[136:139], v4 offset:24320
    v_mfma_f32_16x16x32_bf16 v[20:23], v[92:95], v[104:107], v[20:23]
    ds_read_b64 v[140:141], v2 offset:22272
    ds_read_b64 v[142:143], v2 offset:22280
    ds_read_b128 v[144:147], v4 offset:24832
    v_mfma_f32_16x16x32_bf16 v[20:23], v[100:103], v[112:115], v[20:23]
    v_mfma_f32_16x16x32_bf16 v[20:23], v[108:111], v[120:123], v[20:23]
    ds_read_b64 v[148:149], v2 offset:42560
    ds_read_b64 v[150:151], v2 offset:42568
    ds_read_b128 v[152:155], v4 offset:42560
    v_mfma_f32_16x16x32_bf16 v[24:27], v[60:63], v[104:107], v[24:27]
    ds_read_b128 v[156:159], v4 offset:43072
    v_mfma_f32_16x16x32_bf16 v[24:27], v[68:71], v[112:115], v[24:27]
    v_mfma_f32_16x16x32_bf16 v[24:27], v[76:79], v[120:123], v[24:27]
    s_waitcnt lgkmcnt(11)
    s_waitcnt lgkmcnt(10)
    v_mfma_f32_16x16x32_bf16 v[28:31], v[124:127], v[128:131], v[28:31]
    ds_read_b128 v[160:163], v4 offset:45120
    ds_read_b64 v[164:165], v2 offset:43072
    ds_read_b64 v[166:167], v2 offset:43080
    s_waitcnt lgkmcnt(11)
    s_waitcnt lgkmcnt(10)
    v_mfma_f32_16x16x32_bf16 v[28:31], v[132:135], v[136:139], v[28:31]
    ds_read_b128 v[168:171], v4 offset:43584
    ds_read_b128 v[172:175], v4 offset:45632
    s_waitcnt lgkmcnt(10)
    s_waitcnt lgkmcnt(9)
    v_mfma_f32_16x16x32_bf16 v[28:31], v[140:143], v[144:147], v[28:31]
    ds_read_b64 v[176:177], v2 offset:43584
    ds_read_b64 v[178:179], v2 offset:43592
    v_mfma_f32_16x16x32_bf16 v[32:35], v[124:127], v[144:147], v[32:35]
    ds_read_b128 v[180:183], v4 offset:44096
    s_setprio 0
    s_waitcnt lgkmcnt(10)
    s_waitcnt lgkmcnt(9)
    v_mfma_f32_16x16x32_bf16 v[16:19], v[148:151], v[152:155], v[16:19]
    ds_read_b128 v[184:187], v4 offset:46144
    s_waitcnt lgkmcnt(9)
    v_mfma_f32_16x16x32_bf16 v[20:23], v[148:151], v[156:159], v[20:23]
    ds_read_b64 v[188:189], v2 offset:44096
    ds_read_b64 v[190:191], v2 offset:44104
    s_waitcnt lgkmcnt(10)
    v_mfma_f32_16x16x32_bf16 v[24:27], v[148:151], v[160:163], v[24:27]
    ds_read_b128 v[192:195], v4 offset:44608
    s_waitcnt lgkmcnt(9)
    v_mfma_f32_16x16x32_bf16 v[16:19], v[164:167], v[156:159], v[16:19]
    ds_read_b64 v[196:197], v2 offset:44608
    ds_read_b64 v[198:199], v2 offset:44616
    s_waitcnt lgkmcnt(10)
    v_mfma_f32_16x16x32_bf16 v[20:23], v[164:167], v[168:171], v[20:23]
    s_waitcnt lgkmcnt(9)
    v_mfma_f32_16x16x32_bf16 v[24:27], v[164:167], v[172:175], v[24:27]
    ds_read_b64 v[200:201], v2 offset:45120
    ds_read_b64 v[202:203], v2 offset:45128
    s_waitcnt lgkmcnt(9)
    v_mfma_f32_16x16x32_bf16 v[16:19], v[176:179], v[168:171], v[16:19]
    s_waitcnt lgkmcnt(8)
    v_mfma_f32_16x16x32_bf16 v[20:23], v[176:179], v[180:183], v[20:23]
    ds_read_b64 v[204:205], v2 offset:45632
    ds_read_b64 v[206:207], v2 offset:45640
    s_waitcnt lgkmcnt(9)
    v_mfma_f32_16x16x32_bf16 v[24:27], v[176:179], v[184:187], v[24:27]
    s_waitcnt lgkmcnt(7)
    v_mfma_f32_16x16x32_bf16 v[16:19], v[188:191], v[180:183], v[16:19]
    ds_read_b64 v[208:209], v2 offset:46144
    ds_read_b64 v[210:211], v2 offset:46152
    s_waitcnt lgkmcnt(8)
    v_mfma_f32_16x16x32_bf16 v[20:23], v[188:191], v[192:195], v[20:23]
    ds_read_b64 v[212:213], v2 offset:21312
    ds_read_b64 v[214:215], v2 offset:21320
    ds_read_b128 v[216:219], v4 offset:23872
    s_waitcnt lgkmcnt(9)
    v_mfma_f32_16x16x32_bf16 v[16:19], v[196:199], v[192:195], v[16:19]
    ds_read_b128 v[220:223], v4 offset:24896
    v_mfma_f32_16x16x32_bf16 v[20:23], v[196:199], v[160:163], v[20:23]
    ds_read_b64 v[224:225], v2 offset:21824
    ds_read_b64 v[226:227], v2 offset:21832
    ds_read_b128 v[228:231], v4 offset:24384
    s_waitcnt lgkmcnt(11)
    v_mfma_f32_16x16x32_bf16 v[16:19], v[200:203], v[160:163], v[16:19]
    ds_read_b64 v[232:233], v2 offset:22336
    ds_read_b64 v[234:235], v2 offset:22344
    v_mfma_f32_16x16x32_bf16 v[20:23], v[200:203], v[172:175], v[20:23]
    s_waitcnt lgkmcnt(11)
    v_mfma_f32_16x16x32_bf16 v[16:19], v[204:207], v[172:175], v[16:19]
    ds_read_b64 v[236:237], v2 offset:42624
    ds_read_b64 v[238:239], v2 offset:42632
    v_mfma_f32_16x16x32_bf16 v[20:23], v[204:207], v[184:187], v[20:23]
    s_waitcnt lgkmcnt(11)
    v_mfma_f32_16x16x32_bf16 v[16:19], v[208:211], v[184:187], v[16:19]
    ds_read_b128 v[240:243], v4 offset:42624
    ds_read_b128 v[244:247], v4 offset:43136
    s_waitcnt lgkmcnt(11)
    s_waitcnt lgkmcnt(10)
    v_mfma_f32_16x16x32_bf16 v[28:31], v[212:215], v[216:219], v[28:31]
    ds_read_b128 v[64:67], v4 offset:45184
    ds_read_b64 v[116:117], v2 offset:43136
    ds_read_b64 v[118:119], v2 offset:43144
    s_waitcnt lgkmcnt(12)
    v_mfma_f32_16x16x32_bf16 v[32:35], v[212:215], v[220:223], v[32:35]
    ds_read_b128 v[72:75], v4 offset:43648
    s_waitcnt lgkmcnt(11)
    s_waitcnt lgkmcnt(10)
    v_mfma_f32_16x16x32_bf16 v[28:31], v[224:227], v[228:231], v[28:31]
    ds_read_b128 v[80:83], v4 offset:45696
    ds_read_b64 v[88:89], v2 offset:43648
    ds_read_b64 v[90:91], v2 offset:43656
    s_waitcnt lgkmcnt(11)
    v_mfma_f32_16x16x32_bf16 v[28:31], v[232:235], v[220:223], v[28:31]
    ds_read_b128 v[84:87], v4 offset:44160
    s_waitcnt lgkmcnt(10)
    s_waitcnt lgkmcnt(9)
    v_mfma_f32_16x16x32_bf16 v[16:19], v[236:239], v[240:243], v[16:19]
    ds_read_b128 v[96:99], v4 offset:46208
    s_waitcnt lgkmcnt(9)
    v_mfma_f32_16x16x32_bf16 v[20:23], v[236:239], v[244:247], v[20:23]
    ds_read_b64 v[92:93], v2 offset:44160
    ds_read_b64 v[94:95], v2 offset:44168
    s_waitcnt lgkmcnt(10)
    v_mfma_f32_16x16x32_bf16 v[24:27], v[236:239], v[64:67], v[24:27]
    ds_read_b128 v[100:103], v4 offset:44672
    s_waitcnt lgkmcnt(9)
    v_mfma_f32_16x16x32_bf16 v[16:19], v[116:119], v[244:247], v[16:19]
    ds_read_b64 v[108:109], v2 offset:44672
    ds_read_b64 v[110:111], v2 offset:44680
    s_waitcnt lgkmcnt(10)
    v_mfma_f32_16x16x32_bf16 v[20:23], v[116:119], v[72:75], v[20:23]
    s_waitcnt lgkmcnt(9)
    v_mfma_f32_16x16x32_bf16 v[24:27], v[116:119], v[80:83], v[24:27]
    ds_read_b64 v[60:61], v2 offset:45184
    ds_read_b64 v[62:63], v2 offset:45192
    s_waitcnt lgkmcnt(9)
    v_mfma_f32_16x16x32_bf16 v[16:19], v[88:91], v[72:75], v[16:19]
    s_waitcnt lgkmcnt(8)
    v_mfma_f32_16x16x32_bf16 v[20:23], v[88:91], v[84:87], v[20:23]
    ds_read_b64 v[104:105], v2 offset:45696
    ds_read_b64 v[106:107], v2 offset:45704
    s_waitcnt lgkmcnt(9)
    v_mfma_f32_16x16x32_bf16 v[24:27], v[88:91], v[96:99], v[24:27]
    s_waitcnt lgkmcnt(7)
    v_mfma_f32_16x16x32_bf16 v[16:19], v[92:95], v[84:87], v[16:19]
    ds_read_b64 v[68:69], v2 offset:46208
    ds_read_b64 v[70:71], v2 offset:46216
    s_waitcnt lgkmcnt(8)
    v_mfma_f32_16x16x32_bf16 v[20:23], v[92:95], v[100:103], v[20:23]
    ds_read_b64 v[112:113], v2 offset:21376
    ds_read_b64 v[114:115], v2 offset:21384
    ds_read_b128 v[76:79], v4 offset:23936
    s_waitcnt lgkmcnt(9)
    v_mfma_f32_16x16x32_bf16 v[16:19], v[108:111], v[100:103], v[16:19]
    ds_read_b128 v[120:123], v4 offset:24960
    v_mfma_f32_16x16x32_bf16 v[20:23], v[108:111], v[64:67], v[20:23]
    ds_read_b64 v[128:129], v2 offset:21888
    ds_read_b64 v[130:131], v2 offset:21896
    ds_read_b128 v[132:135], v4 offset:24448
    s_waitcnt lgkmcnt(11)
    v_mfma_f32_16x16x32_bf16 v[16:19], v[60:63], v[64:67], v[16:19]
    ds_read_b64 v[136:137], v2 offset:22400
    ds_read_b64 v[138:139], v2 offset:22408
    v_mfma_f32_16x16x32_bf16 v[20:23], v[60:63], v[80:83], v[20:23]
    s_waitcnt lgkmcnt(11)
    v_mfma_f32_16x16x32_bf16 v[16:19], v[104:107], v[80:83], v[16:19]
    ds_read_b64 v[140:141], v2 offset:42688
    ds_read_b64 v[142:143], v2 offset:42696
    v_mfma_f32_16x16x32_bf16 v[20:23], v[104:107], v[96:99], v[20:23]
    s_waitcnt lgkmcnt(11)
    v_mfma_f32_16x16x32_bf16 v[16:19], v[68:71], v[96:99], v[16:19]
    ds_read_b128 v[124:127], v4 offset:42688
    ds_read_b128 v[144:147], v4 offset:43200
    s_waitcnt lgkmcnt(11)
    s_waitcnt lgkmcnt(10)
    v_mfma_f32_16x16x32_bf16 v[28:31], v[112:115], v[76:79], v[28:31]
    ds_read_b128 v[152:155], v4 offset:45248
    ds_read_b64 v[148:149], v2 offset:43200
    ds_read_b64 v[150:151], v2 offset:43208
    s_waitcnt lgkmcnt(12)
    v_mfma_f32_16x16x32_bf16 v[32:35], v[112:115], v[120:123], v[32:35]
    ds_read_b128 v[156:159], v4 offset:43712
    s_waitcnt lgkmcnt(11)
    s_waitcnt lgkmcnt(10)
    v_mfma_f32_16x16x32_bf16 v[28:31], v[128:131], v[132:135], v[28:31]
    ds_read_b128 v[164:167], v4 offset:45760
    ds_read_b64 v[168:169], v2 offset:43712
    ds_read_b64 v[170:171], v2 offset:43720
    s_waitcnt lgkmcnt(11)
    v_mfma_f32_16x16x32_bf16 v[28:31], v[136:139], v[120:123], v[28:31]
    ds_read_b128 v[176:179], v4 offset:44224
    s_waitcnt lgkmcnt(10)
    s_waitcnt lgkmcnt(9)
    v_mfma_f32_16x16x32_bf16 v[16:19], v[140:143], v[124:127], v[16:19]
    ds_read_b128 v[180:183], v4 offset:46272
    s_waitcnt lgkmcnt(9)
    v_mfma_f32_16x16x32_bf16 v[20:23], v[140:143], v[144:147], v[20:23]
    ds_read_b64 v[188:189], v2 offset:44224
    ds_read_b64 v[190:191], v2 offset:44232
    s_waitcnt lgkmcnt(10)
    v_mfma_f32_16x16x32_bf16 v[24:27], v[140:143], v[152:155], v[24:27]
    ds_read_b128 v[192:195], v4 offset:44736
    s_waitcnt lgkmcnt(9)
    v_mfma_f32_16x16x32_bf16 v[16:19], v[148:151], v[144:147], v[16:19]
    ds_read_b64 v[196:197], v2 offset:44736
    ds_read_b64 v[198:199], v2 offset:44744
    s_waitcnt lgkmcnt(10)
    v_mfma_f32_16x16x32_bf16 v[20:23], v[148:151], v[156:159], v[20:23]
    s_waitcnt lgkmcnt(9)
    v_mfma_f32_16x16x32_bf16 v[24:27], v[148:151], v[164:167], v[24:27]
    ds_read_b64 v[160:161], v2 offset:45248
    ds_read_b64 v[162:163], v2 offset:45256
    s_waitcnt lgkmcnt(9)
    v_mfma_f32_16x16x32_bf16 v[16:19], v[168:171], v[156:159], v[16:19]
    s_waitcnt lgkmcnt(8)
    v_mfma_f32_16x16x32_bf16 v[20:23], v[168:171], v[176:179], v[20:23]
    ds_read_b64 v[200:201], v2 offset:45760
    ds_read_b64 v[202:203], v2 offset:45768
    s_waitcnt lgkmcnt(9)
    v_mfma_f32_16x16x32_bf16 v[24:27], v[168:171], v[180:183], v[24:27]
    s_waitcnt lgkmcnt(7)
    v_mfma_f32_16x16x32_bf16 v[16:19], v[188:191], v[176:179], v[16:19]
    ds_read_b64 v[172:173], v2 offset:46272
    ds_read_b64 v[174:175], v2 offset:46280
    s_waitcnt lgkmcnt(8)
    v_mfma_f32_16x16x32_bf16 v[20:23], v[188:191], v[192:195], v[20:23]
    ds_read_b64 v[204:205], v2 offset:21440
    ds_read_b64 v[206:207], v2 offset:21448
    ds_read_b128 v[208:211], v4 offset:24000
    s_waitcnt lgkmcnt(9)
    v_mfma_f32_16x16x32_bf16 v[16:19], v[196:199], v[192:195], v[16:19]
    ds_read_b128 v[184:187], v4 offset:25024
    v_mfma_f32_16x16x32_bf16 v[20:23], v[196:199], v[152:155], v[20:23]
    ds_read_b64 v[216:217], v2 offset:21952
    ds_read_b64 v[218:219], v2 offset:21960
    ds_read_b128 v[212:215], v4 offset:24512
    s_waitcnt lgkmcnt(11)
    v_mfma_f32_16x16x32_bf16 v[16:19], v[160:163], v[152:155], v[16:19]
    ds_read_b64 v[224:225], v2 offset:22464
    ds_read_b64 v[226:227], v2 offset:22472
    v_mfma_f32_16x16x32_bf16 v[20:23], v[160:163], v[164:167], v[20:23]
    s_waitcnt lgkmcnt(11)
    v_mfma_f32_16x16x32_bf16 v[16:19], v[200:203], v[164:167], v[16:19]
    ds_read_b64 v[228:229], v2 offset:42752
    ds_read_b64 v[230:231], v2 offset:42760
    v_mfma_f32_16x16x32_bf16 v[20:23], v[200:203], v[180:183], v[20:23]
    s_waitcnt lgkmcnt(11)
    v_mfma_f32_16x16x32_bf16 v[16:19], v[172:175], v[180:183], v[16:19]
    ds_read_b128 v[232:235], v4 offset:42752
    ds_read_b128 v[220:223], v4 offset:43264
    s_waitcnt lgkmcnt(11)
    s_waitcnt lgkmcnt(10)
    v_mfma_f32_16x16x32_bf16 v[28:31], v[204:207], v[208:211], v[28:31]
    ds_read_b128 v[240:243], v4 offset:45312
    ds_read_b64 v[236:237], v2 offset:43264
    ds_read_b64 v[238:239], v2 offset:43272
    s_waitcnt lgkmcnt(12)
    v_mfma_f32_16x16x32_bf16 v[32:35], v[204:207], v[184:187], v[32:35]
    ds_read_b128 v[244:247], v4 offset:43776
    s_waitcnt lgkmcnt(11)
    s_waitcnt lgkmcnt(10)
    v_mfma_f32_16x16x32_bf16 v[28:31], v[216:219], v[212:215], v[28:31]
    ds_read_b128 v[116:119], v4 offset:45824
    ds_read_b64 v[72:73], v2 offset:43776
    ds_read_b64 v[74:75], v2 offset:43784
    s_waitcnt lgkmcnt(11)
    v_mfma_f32_16x16x32_bf16 v[28:31], v[224:227], v[184:187], v[28:31]
    ds_read_b128 v[88:91], v4 offset:44288
    s_waitcnt lgkmcnt(10)
    s_waitcnt lgkmcnt(9)
    v_mfma_f32_16x16x32_bf16 v[16:19], v[228:231], v[232:235], v[16:19]
    ds_read_b128 v[84:87], v4 offset:46336
    s_waitcnt lgkmcnt(9)
    v_mfma_f32_16x16x32_bf16 v[20:23], v[228:231], v[220:223], v[20:23]
    ds_read_b64 v[92:93], v2 offset:44288
    ds_read_b64 v[94:95], v2 offset:44296
    s_waitcnt lgkmcnt(10)
    v_mfma_f32_16x16x32_bf16 v[24:27], v[228:231], v[240:243], v[24:27]
    ds_read_b128 v[100:103], v4 offset:44800
    s_waitcnt lgkmcnt(9)
    v_mfma_f32_16x16x32_bf16 v[16:19], v[236:239], v[220:223], v[16:19]
    ds_read_b64 v[108:109], v2 offset:44800
    ds_read_b64 v[110:111], v2 offset:44808
    s_waitcnt lgkmcnt(10)
    v_mfma_f32_16x16x32_bf16 v[20:23], v[236:239], v[244:247], v[20:23]
    s_waitcnt lgkmcnt(9)
    v_mfma_f32_16x16x32_bf16 v[24:27], v[236:239], v[116:119], v[24:27]
    ds_read_b64 v[64:65], v2 offset:45312
    ds_read_b64 v[66:67], v2 offset:45320
    s_waitcnt lgkmcnt(9)
    v_mfma_f32_16x16x32_bf16 v[16:19], v[72:75], v[244:247], v[16:19]
    s_waitcnt lgkmcnt(8)
    v_mfma_f32_16x16x32_bf16 v[20:23], v[72:75], v[88:91], v[20:23]
    ds_read_b64 v[60:61], v2 offset:45824
    ds_read_b64 v[62:63], v2 offset:45832
    s_waitcnt lgkmcnt(9)
    v_mfma_f32_16x16x32_bf16 v[24:27], v[72:75], v[84:87], v[24:27]
    s_waitcnt lgkmcnt(7)
    v_mfma_f32_16x16x32_bf16 v[16:19], v[92:95], v[88:91], v[16:19]
    ds_read_b64 v[80:81], v2 offset:46336
    ds_read_b64 v[82:83], v2 offset:46344
    s_waitcnt lgkmcnt(8)
    v_mfma_f32_16x16x32_bf16 v[20:23], v[92:95], v[100:103], v[20:23]
    ds_read_b64 v[104:105], v2 offset:21504
    ds_read_b64 v[106:107], v2 offset:21512
    ds_read_b128 v[68:71], v4 offset:24064
    s_waitcnt lgkmcnt(9)
    v_mfma_f32_16x16x32_bf16 v[16:19], v[108:111], v[100:103], v[16:19]
    ds_read_b128 v[96:99], v4 offset:25088
    v_mfma_f32_16x16x32_bf16 v[20:23], v[108:111], v[240:243], v[20:23]
    ds_read_b64 v[76:77], v2 offset:22016
    ds_read_b64 v[78:79], v2 offset:22024
    ds_read_b128 v[112:115], v4 offset:24576
    s_waitcnt lgkmcnt(11)
    v_mfma_f32_16x16x32_bf16 v[16:19], v[64:67], v[240:243], v[16:19]
    ds_read_b64 v[128:129], v2 offset:22528
    ds_read_b64 v[130:131], v2 offset:22536
    v_mfma_f32_16x16x32_bf16 v[20:23], v[64:67], v[116:119], v[20:23]
    s_waitcnt lgkmcnt(11)
    v_mfma_f32_16x16x32_bf16 v[16:19], v[60:63], v[116:119], v[16:19]
    ds_read_b64 v[132:133], v2 offset:42816
    ds_read_b64 v[134:135], v2 offset:42824
    v_mfma_f32_16x16x32_bf16 v[20:23], v[60:63], v[84:87], v[20:23]
    s_waitcnt lgkmcnt(11)
    v_mfma_f32_16x16x32_bf16 v[16:19], v[80:83], v[84:87], v[16:19]
    ds_read_b128 v[136:139], v4 offset:42816
    ds_read_b128 v[120:123], v4 offset:43328
    s_waitcnt lgkmcnt(11)
    s_waitcnt lgkmcnt(10)
    v_mfma_f32_16x16x32_bf16 v[28:31], v[104:107], v[68:71], v[28:31]
    ds_read_b128 v[124:127], v4 offset:45376
    ds_read_b64 v[140:141], v2 offset:43328
    ds_read_b64 v[142:143], v2 offset:43336
    s_waitcnt lgkmcnt(12)
    v_mfma_f32_16x16x32_bf16 v[32:35], v[104:107], v[96:99], v[32:35]
    ds_read_b128 v[144:147], v4 offset:43840
    s_waitcnt lgkmcnt(11)
    s_waitcnt lgkmcnt(10)
    v_mfma_f32_16x16x32_bf16 v[28:31], v[76:79], v[112:115], v[28:31]
    ds_read_b128 v[148:151], v4 offset:45888
    ds_read_b64 v[156:157], v2 offset:43840
    ds_read_b64 v[158:159], v2 offset:43848
    s_waitcnt lgkmcnt(11)
    v_mfma_f32_16x16x32_bf16 v[28:31], v[128:131], v[96:99], v[28:31]
    ds_read_b128 v[168:171], v4 offset:44352
    s_waitcnt lgkmcnt(10)
    s_waitcnt lgkmcnt(9)
    v_mfma_f32_16x16x32_bf16 v[16:19], v[132:135], v[136:139], v[16:19]
    ds_read_b128 v[176:179], v4 offset:46400
    s_waitcnt lgkmcnt(9)
    v_mfma_f32_16x16x32_bf16 v[20:23], v[132:135], v[120:123], v[20:23]
    ds_read_b64 v[188:189], v2 offset:44352
    ds_read_b64 v[190:191], v2 offset:44360
    s_waitcnt lgkmcnt(10)
    v_mfma_f32_16x16x32_bf16 v[24:27], v[132:135], v[124:127], v[24:27]
    ds_read_b128 v[192:195], v4 offset:44864
    s_waitcnt lgkmcnt(9)
    v_mfma_f32_16x16x32_bf16 v[16:19], v[140:143], v[120:123], v[16:19]
    ds_read_b64 v[196:197], v2 offset:44864
    ds_read_b64 v[198:199], v2 offset:44872
    s_waitcnt lgkmcnt(10)
    v_mfma_f32_16x16x32_bf16 v[20:23], v[140:143], v[144:147], v[20:23]
    s_waitcnt lgkmcnt(9)
    v_mfma_f32_16x16x32_bf16 v[24:27], v[140:143], v[148:151], v[24:27]
    ds_read_b64 v[152:153], v2 offset:45376
    ds_read_b64 v[154:155], v2 offset:45384
    s_waitcnt lgkmcnt(9)
    v_mfma_f32_16x16x32_bf16 v[16:19], v[156:159], v[144:147], v[16:19]
    s_waitcnt lgkmcnt(8)
    v_mfma_f32_16x16x32_bf16 v[20:23], v[156:159], v[168:171], v[20:23]
    ds_read_b64 v[160:161], v2 offset:45888
    ds_read_b64 v[162:163], v2 offset:45896
    s_waitcnt lgkmcnt(9)
    v_mfma_f32_16x16x32_bf16 v[24:27], v[156:159], v[176:179], v[24:27]
    s_waitcnt lgkmcnt(7)
    v_mfma_f32_16x16x32_bf16 v[16:19], v[188:191], v[168:171], v[16:19]
    ds_read_b64 v[164:165], v2 offset:46400
    ds_read_b64 v[166:167], v2 offset:46408
    s_waitcnt lgkmcnt(8)
    v_mfma_f32_16x16x32_bf16 v[20:23], v[188:191], v[192:195], v[20:23]
    ds_read_b64 v[200:201], v2 offset:21568
    ds_read_b64 v[202:203], v2 offset:21576
    ds_read_b128 v[172:175], v4 offset:24128
    s_waitcnt lgkmcnt(9)
    v_mfma_f32_16x16x32_bf16 v[16:19], v[196:199], v[192:195], v[16:19]
    ds_read_b128 v[180:183], v4 offset:25152
    v_mfma_f32_16x16x32_bf16 v[20:23], v[196:199], v[124:127], v[20:23]
    ds_read_b64 v[208:209], v2 offset:22080
    ds_read_b64 v[210:211], v2 offset:22088
    ds_read_b128 v[204:207], v4 offset:24640
    s_waitcnt lgkmcnt(11)
    v_mfma_f32_16x16x32_bf16 v[16:19], v[152:155], v[124:127], v[16:19]
    ds_read_b64 v[216:217], v2 offset:22592
    ds_read_b64 v[218:219], v2 offset:22600
    v_mfma_f32_16x16x32_bf16 v[20:23], v[152:155], v[148:151], v[20:23]
    s_waitcnt lgkmcnt(11)
    v_mfma_f32_16x16x32_bf16 v[16:19], v[160:163], v[148:151], v[16:19]
    ds_read_b64 v[212:213], v2 offset:42880
    ds_read_b64 v[214:215], v2 offset:42888
    v_mfma_f32_16x16x32_bf16 v[20:23], v[160:163], v[176:179], v[20:23]
    s_waitcnt lgkmcnt(11)
    v_mfma_f32_16x16x32_bf16 v[16:19], v[164:167], v[176:179], v[16:19]
    ds_read_b128 v[224:227], v4 offset:42880
    ds_read_b128 v[184:187], v4 offset:43392
    s_waitcnt lgkmcnt(11)
    s_waitcnt lgkmcnt(10)
    v_mfma_f32_16x16x32_bf16 v[28:31], v[200:203], v[172:175], v[28:31]
    ds_read_b128 v[232:235], v4 offset:45440
    ds_read_b64 v[228:229], v2 offset:43392
    ds_read_b64 v[230:231], v2 offset:43400
    s_waitcnt lgkmcnt(12)
    v_mfma_f32_16x16x32_bf16 v[32:35], v[200:203], v[180:183], v[32:35]
    ds_read_b128 v[220:223], v4 offset:43904
    s_waitcnt lgkmcnt(11)
    s_waitcnt lgkmcnt(10)
    v_mfma_f32_16x16x32_bf16 v[28:31], v[208:211], v[204:207], v[28:31]
    ds_read_b128 v[236:239], v4 offset:45952
    ds_read_b64 v[244:245], v2 offset:43904
    ds_read_b64 v[246:247], v2 offset:43912
    s_waitcnt lgkmcnt(11)
    v_mfma_f32_16x16x32_bf16 v[28:31], v[216:219], v[180:183], v[28:31]
    ds_read_b128 v[72:75], v4 offset:44416
    s_waitcnt lgkmcnt(10)
    s_waitcnt lgkmcnt(9)
    v_mfma_f32_16x16x32_bf16 v[16:19], v[212:215], v[224:227], v[16:19]
    ds_read_b128 v[88:91], v4 offset:46464
    s_waitcnt lgkmcnt(9)
    v_mfma_f32_16x16x32_bf16 v[20:23], v[212:215], v[184:187], v[20:23]
    ds_read_b64 v[92:93], v2 offset:44416
    ds_read_b64 v[94:95], v2 offset:44424
    s_waitcnt lgkmcnt(10)
    v_mfma_f32_16x16x32_bf16 v[24:27], v[212:215], v[232:235], v[24:27]
    ds_read_b128 v[100:103], v4 offset:44928
    s_waitcnt lgkmcnt(9)
    v_mfma_f32_16x16x32_bf16 v[16:19], v[228:231], v[184:187], v[16:19]
    ds_read_b64 v[108:109], v2 offset:44928
    ds_read_b64 v[110:111], v2 offset:44936
    s_waitcnt lgkmcnt(10)
    v_mfma_f32_16x16x32_bf16 v[20:23], v[228:231], v[220:223], v[20:23]
    s_waitcnt lgkmcnt(9)
    v_mfma_f32_16x16x32_bf16 v[24:27], v[228:231], v[236:239], v[24:27]
    ds_read_b64 v[240:241], v2 offset:45440
    ds_read_b64 v[242:243], v2 offset:45448
    s_waitcnt lgkmcnt(9)
    v_mfma_f32_16x16x32_bf16 v[16:19], v[244:247], v[220:223], v[16:19]
    s_waitcnt lgkmcnt(8)
    v_mfma_f32_16x16x32_bf16 v[20:23], v[244:247], v[72:75], v[20:23]
    ds_read_b64 v[64:65], v2 offset:45952
    ds_read_b64 v[66:67], v2 offset:45960
    s_waitcnt lgkmcnt(9)
    v_mfma_f32_16x16x32_bf16 v[24:27], v[244:247], v[88:91], v[24:27]
    s_waitcnt lgkmcnt(7)
    v_mfma_f32_16x16x32_bf16 v[16:19], v[92:95], v[72:75], v[16:19]
    ds_read_b64 v[116:117], v2 offset:46464
    ds_read_b64 v[118:119], v2 offset:46472
    s_waitcnt lgkmcnt(8)
    v_mfma_f32_16x16x32_bf16 v[20:23], v[92:95], v[100:103], v[20:23]
    ds_read_b64 v[60:61], v2 offset:21632
    ds_read_b64 v[62:63], v2 offset:21640
    ds_read_b128 v[80:83], v4 offset:24192
    s_waitcnt lgkmcnt(9)
    v_mfma_f32_16x16x32_bf16 v[16:19], v[108:111], v[100:103], v[16:19]
    ds_read_b128 v[84:87], v4 offset:25216
    v_mfma_f32_16x16x32_bf16 v[20:23], v[108:111], v[232:235], v[20:23]
    ds_read_b64 v[68:69], v2 offset:22144
    ds_read_b64 v[70:71], v2 offset:22152
    ds_read_b128 v[104:107], v4 offset:24704
    s_waitcnt lgkmcnt(11)
    v_mfma_f32_16x16x32_bf16 v[16:19], v[240:243], v[232:235], v[16:19]
    ds_read_b64 v[76:77], v2 offset:22656
    ds_read_b64 v[78:79], v2 offset:22664
    v_mfma_f32_16x16x32_bf16 v[20:23], v[240:243], v[236:239], v[20:23]
    s_waitcnt lgkmcnt(11)
    v_mfma_f32_16x16x32_bf16 v[16:19], v[64:67], v[236:239], v[16:19]
    ds_read_b64 v[112:113], v2 offset:42944
    ds_read_b64 v[114:115], v2 offset:42952
    v_mfma_f32_16x16x32_bf16 v[20:23], v[64:67], v[88:91], v[20:23]
    s_waitcnt lgkmcnt(11)
    v_mfma_f32_16x16x32_bf16 v[16:19], v[116:119], v[88:91], v[16:19]
    ds_read_b128 v[128:131], v4 offset:42944
    ds_read_b128 v[96:99], v4 offset:43456
    s_waitcnt lgkmcnt(11)
    s_waitcnt lgkmcnt(10)
    v_mfma_f32_16x16x32_bf16 v[28:31], v[60:63], v[80:83], v[28:31]
    ds_read_b128 v[136:139], v4 offset:45504
    ds_read_b64 v[132:133], v2 offset:43456
    ds_read_b64 v[134:135], v2 offset:43464
    s_waitcnt lgkmcnt(12)
    v_mfma_f32_16x16x32_bf16 v[32:35], v[60:63], v[84:87], v[32:35]
    ds_read_b128 v[120:123], v4 offset:43968
    s_waitcnt lgkmcnt(11)
    s_waitcnt lgkmcnt(10)
    v_mfma_f32_16x16x32_bf16 v[28:31], v[68:71], v[104:107], v[28:31]
    ds_read_b128 v[140:143], v4 offset:46016
    ds_read_b64 v[144:145], v2 offset:43968
    ds_read_b64 v[146:147], v2 offset:43976
    s_waitcnt lgkmcnt(11)
    v_mfma_f32_16x16x32_bf16 v[28:31], v[76:79], v[84:87], v[28:31]
    ds_read_b128 v[156:159], v4 offset:44480
    s_setprio 1
    s_waitcnt lgkmcnt(10)
    s_waitcnt lgkmcnt(9)
    v_mfma_f32_16x16x32_bf16 v[16:19], v[112:115], v[128:131], v[16:19]
    ds_read_b128 v[168:171], v4 offset:46528
    s_waitcnt lgkmcnt(9)
    v_mfma_f32_16x16x32_bf16 v[20:23], v[112:115], v[96:99], v[20:23]
    ds_read_b64 v[188:189], v2 offset:44480
    ds_read_b64 v[190:191], v2 offset:44488
    s_waitcnt lgkmcnt(10)
    v_mfma_f32_16x16x32_bf16 v[24:27], v[112:115], v[136:139], v[24:27]
    ds_read_b128 v[192:195], v4 offset:44992
    s_waitcnt lgkmcnt(9)
    v_mfma_f32_16x16x32_bf16 v[16:19], v[132:135], v[96:99], v[16:19]
    ds_read_b64 v[196:197], v2 offset:44992
    ds_read_b64 v[198:199], v2 offset:45000
    s_waitcnt lgkmcnt(10)
    v_mfma_f32_16x16x32_bf16 v[20:23], v[132:135], v[120:123], v[20:23]
    s_waitcnt lgkmcnt(9)
    v_mfma_f32_16x16x32_bf16 v[24:27], v[132:135], v[140:143], v[24:27]
    ds_read_b64 v[124:125], v2 offset:45504
    ds_read_b64 v[126:127], v2 offset:45512
    s_waitcnt lgkmcnt(9)
    v_mfma_f32_16x16x32_bf16 v[16:19], v[144:147], v[120:123], v[16:19]
    s_waitcnt lgkmcnt(8)
    v_mfma_f32_16x16x32_bf16 v[20:23], v[144:147], v[156:159], v[20:23]
    ds_read_b64 v[152:153], v2 offset:46016
    ds_read_b64 v[154:155], v2 offset:46024
    s_waitcnt lgkmcnt(9)
    v_mfma_f32_16x16x32_bf16 v[24:27], v[144:147], v[168:171], v[24:27]
    s_waitcnt lgkmcnt(7)
    v_mfma_f32_16x16x32_bf16 v[16:19], v[188:191], v[156:159], v[16:19]
    ds_read_b64 v[148:149], v2 offset:46528
    ds_read_b64 v[150:151], v2 offset:46536
    s_waitcnt lgkmcnt(8)
    v_mfma_f32_16x16x32_bf16 v[20:23], v[188:191], v[192:195], v[20:23]
    ds_read_b64 v[160:161], v2 offset:21696
    ds_read_b64 v[162:163], v2 offset:21704
    ds_read_b128 v[164:167], v4 offset:24256
    v_cvt_pk_bf16_f32 v48, v24, v25
    v_cvt_pk_bf16_f32 v49, v26, v27
    v_pk_min_u16 v48, v48, s66
    v_pk_min_u16 v49, v49, s66
    buffer_store_dwordx2 v[48:49], v7, s[44:47], s65 offen offset:1024 sc1
    s_waitcnt lgkmcnt(9)
    v_mfma_f32_16x16x32_bf16 v[16:19], v[196:199], v[192:195], v[16:19]
    ds_read_b128 v[176:179], v4 offset:25280
    v_mfma_f32_16x16x32_bf16 v[20:23], v[196:199], v[136:139], v[20:23]
    ds_read_b64 v[172:173], v2 offset:22208
    ds_read_b64 v[174:175], v2 offset:22216
    ds_read_b128 v[200:203], v4 offset:24768
    s_waitcnt lgkmcnt(11)
    v_mfma_f32_16x16x32_bf16 v[16:19], v[124:127], v[136:139], v[16:19]
    ds_read_b64 v[208:209], v2 offset:22720
    ds_read_b64 v[210:211], v2 offset:22728
    v_mfma_f32_16x16x32_bf16 v[20:23], v[124:127], v[140:143], v[20:23]
    s_waitcnt lgkmcnt(11)
    v_mfma_f32_16x16x32_bf16 v[16:19], v[152:155], v[140:143], v[16:19]
    v_mfma_f32_16x16x32_bf16 v[20:23], v[152:155], v[168:171], v[20:23]
    s_waitcnt lgkmcnt(9)
    v_mfma_f32_16x16x32_bf16 v[16:19], v[148:151], v[168:171], v[16:19]
    s_waitcnt lgkmcnt(7)
    s_waitcnt lgkmcnt(6)
    v_mfma_f32_16x16x32_bf16 v[28:31], v[160:163], v[164:167], v[28:31]
    s_nop 2
    v_cvt_pk_bf16_f32 v46, v20, v21
    v_cvt_pk_bf16_f32 v47, v22, v23
    v_pk_min_u16 v46, v46, s66
    v_pk_min_u16 v47, v47, s66
    buffer_store_dwordx2 v[46:47], v7, s[44:47], s65 offen offset:3072 sc1
    s_waitcnt lgkmcnt(5)
    v_mfma_f32_16x16x32_bf16 v[32:35], v[160:163], v[176:179], v[32:35]
    v_cvt_pk_bf16_f32 v44, v16, v17
    v_cvt_pk_bf16_f32 v45, v18, v19
    v_pk_min_u16 v44, v44, s66
    v_pk_min_u16 v45, v45, s66
    buffer_store_dwordx2 v[44:45], v7, s[44:47], s65 offen offset:3584 sc1
    s_waitcnt lgkmcnt(3)
    s_waitcnt lgkmcnt(2)
    v_mfma_f32_16x16x32_bf16 v[28:31], v[172:175], v[200:203], v[28:31]
    s_waitcnt lgkmcnt(0)
    v_mfma_f32_16x16x32_bf16 v[28:31], v[208:211], v[176:179], v[28:31]
    v_cvt_pk_bf16_f32 v52, v32, v33
    v_cvt_pk_bf16_f32 v53, v34, v35
    v_pk_min_u16 v52, v52, s66
    v_pk_min_u16 v53, v53, s66
    buffer_store_dwordx2 v[52:53], v7, s[44:47], s57 offen offset:0 sc1
    s_nop 2
    v_cvt_pk_bf16_f32 v50, v28, v29
    v_cvt_pk_bf16_f32 v51, v30, v31
    v_pk_min_u16 v50, v50, s66
    v_pk_min_u16 v51, v51, s66
    buffer_store_dwordx2 v[50:51], v7, s[44:47], s57 offen offset:1024 sc1
    s_nop 0
    s_branch K2_CP
K2_CV3:
    ds_read_b64 v[44:45], v6 offset:43520
    ds_read_b64 v[46:47], v6 offset:44032
    ds_read_b64 v[48:49], v6 offset:44544
    ds_read_b64 v[50:51], v6 offset:45568
    ds_read_b64 v[52:53], v6 offset:46080
    ds_read_b64 v[54:55], v6 offset:23808
    ds_read_b64 v[56:57], v6 offset:24832
    ds_read_b64 v[60:61], v2 offset:42496
    ds_read_b64 v[62:63], v2 offset:42504
    ds_read_b128 v[64:67], v4 offset:43520
    ds_read_b64 v[68:69], v2 offset:43008
    ds_read_b64 v[70:71], v2 offset:43016
    ds_read_b128 v[72:75], v4 offset:44032
    s_waitcnt lgkmcnt(6)
    v_and_b32 v16, 0xffff0000, v45
    v_lshlrev_b32 v17, 16, v45
    v_and_b32 v18, 0xffff0000, v44
    v_lshlrev_b32 v19, 16, v44
    v_mul_f32 v16, s62, v16
    v_mul_f32 v17, s62, v17
    v_mul_f32 v18, s62, v18
    v_mul_f32 v19, s62, v19
    s_waitcnt lgkmcnt(4)
    s_waitcnt lgkmcnt(3)
    v_mfma_f32_16x16x32_bf16 v[16:19], v[60:63], v[64:67], v[16:19]
    ds_read_b64 v[76:77], v2 offset:43520
    ds_read_b64 v[78:79], v2 offset:43528
    ds_read_b128 v[80:83], v4 offset:44544
    ds_read_b64 v[84:85], v2 offset:44032
    ds_read_b64 v[86:87], v2 offset:44040
    v_and_b32 v20, 0xffff0000, v47
    v_lshlrev_b32 v21, 16, v47
    v_and_b32 v22, 0xffff0000, v46
    v_lshlrev_b32 v23, 16, v46
    s_waitcnt lgkmcnt(6)
    s_waitcnt lgkmcnt(5)
    v_mfma_f32_16x16x32_bf16 v[16:19], v[68:71], v[72:75], v[16:19]
    ds_read_b128 v[88:91], v4 offset:45056
    ds_read_b64 v[92:93], v2 offset:44544
    ds_read_b64 v[94:95], v2 offset:44552
    ds_read_b128 v[96:99], v4 offset:45568
    v_mul_f32 v20, s62, v20
    v_mul_f32 v21, s62, v21
    v_mul_f32 v22, s62, v22
    v_mul_f32 v23, s62, v23
    s_waitcnt lgkmcnt(7)
    s_waitcnt lgkmcnt(6)
    v_mfma_f32_16x16x32_bf16 v[16:19], v[76:79], v[80:83], v[16:19]
    ds_read_b64 v[100:101], v2 offset:45056
    ds_read_b64 v[102:103], v2 offset:45064
    ds_read_b128 v[104:107], v4 offset:46080
    v_and_b32 v24, 0xffff0000, v49
    v_lshlrev_b32 v25, 16, v49
    v_and_b32 v26, 0xffff0000, v48
    v_lshlrev_b32 v27, 16, v48
    s_waitcnt lgkmcnt(7)
    s_waitcnt lgkmcnt(6)
    v_mfma_f32_16x16x32_bf16 v[16:19], v[84:87], v[88:91], v[16:19]
    v_mul_f32 v24, s62, v24
    v_mul_f32 v25, s62, v25
    v_mul_f32 v26, s62, v26
    v_mul_f32 v27, s62, v27
    s_waitcnt lgkmcnt(4)
    s_waitcnt lgkmcnt(3)
    v_mfma_f32_16x16x32_bf16 v[16:19], v[92:95], v[96:99], v[16:19]
    v_and_b32 v28, 0xffff0000, v51
    v_lshlrev_b32 v29, 16, v51
    v_and_b32 v30, 0xffff0000, v50
    v_lshlrev_b32 v31, 16, v50
    s_waitcnt lgkmcnt(1)
    s_waitcnt lgkmcnt(0)
    v_mfma_f32_16x16x32_bf16 v[16:19], v[100:103], v[104:107], v[16:19]
    v_mul_f32 v28, s62, v28
    v_mul_f32 v29, s62, v29
    v_mul_f32 v30, s62, v30
    v_mul_f32 v31, s62, v31
    v_mfma_f32_16x16x32_bf16 v[20:23], v[60:63], v[72:75], v[20:23]
    v_and_b32 v32, 0xffff0000, v53
    v_lshlrev_b32 v33, 16, v53
    v_and_b32 v34, 0xffff0000, v52
    v_lshlrev_b32 v35, 16, v52
    v_mfma_f32_16x16x32_bf16 v[20:23], v[68:71], v[80:83], v[20:23]
    v_mul_f32 v32, s62, v32
    v_mul_f32 v33, s62, v33
    v_mul_f32 v34, s62, v34
    v_mul_f32 v35, s62, v35
    v_mfma_f32_16x16x32_bf16 v[20:23], v[76:79], v[88:91], v[20:23]
    v_and_b32 v36, 0xffff0000, v55
    v_lshlrev_b32 v37, 16, v55
    v_and_b32 v38, 0xffff0000, v54
    v_lshlrev_b32 v39, 16, v54
    v_mfma_f32_16x16x32_bf16 v[20:23], v[84:87], v[96:99], v[20:23]
    v_mul_f32 v36, s61, v36
    v_mul_f32 v37, s61, v37
    v_mul_f32 v38, s61, v38
    v_mul_f32 v39, s61, v39
    v_mfma_f32_16x16x32_bf16 v[20:23], v[92:95], v[104:107], v[20:23]
    ds_read_b64 v[108:109], v2 offset:21248
    ds_read_b64 v[110:111], v2 offset:21256
    ds_read_b128 v[112:115], v4 offset:23808
    v_and_b32 v40, 0xffff0000, v57
    v_lshlrev_b32 v41, 16, v57
    v_and_b32 v42, 0xffff0000, v56
    v_lshlrev_b32 v43, 16, v56
    v_mfma_f32_16x16x32_bf16 v[24:27], v[60:63], v[80:83], v[24:27]
    ds_read_b64 v[116:117], v2 offset:21760
    ds_read_b64 v[118:119], v2 offset:21768
    ds_read_b128 v[120:123], v4 offset:24320
    v_mul_f32 v40, s61, v40
    v_mul_f32 v41, s61, v41
    v_mul_f32 v42, s61, v42
    v_mul_f32 v43, s61, v43
    v_mfma_f32_16x16x32_bf16 v[24:27], v[68:71], v[88:91], v[24:27]
    ds_read_b64 v[124:125], v2 offset:22272
    ds_read_b64 v[126:127], v2 offset:22280
    ds_read_b128 v[128:131], v4 offset:24832
    v_mfma_f32_16x16x32_bf16 v[24:27], v[76:79], v[96:99], v[24:27]
    v_mfma_f32_16x16x32_bf16 v[24:27], v[84:87], v[104:107], v[24:27]
    ds_read_b64 v[132:133], v2 offset:42560
    ds_read_b64 v[134:135], v2 offset:42568
    ds_read_b128 v[136:139], v4 offset:43584
    v_mfma_f32_16x16x32_bf16 v[28:31], v[60:63], v[96:99], v[28:31]
    ds_read_b128 v[140:143], v4 offset:44096
    v_mfma_f32_16x16x32_bf16 v[28:31], v[68:71], v[104:107], v[28:31]
    v_mfma_f32_16x16x32_bf16 v[32:35], v[60:63], v[104:107], v[32:35]
    s_waitcnt lgkmcnt(11)
    s_waitcnt lgkmcnt(10)
    v_mfma_f32_16x16x32_bf16 v[36:39], v[108:111], v[112:115], v[36:39]
    ds_read_b128 v[144:147], v4 offset:44608
    ds_read_b128 v[148:151], v4 offset:45632
    ds_read_b128 v[152:155], v4 offset:46144
    s_waitcnt lgkmcnt(11)
    s_waitcnt lgkmcnt(10)
    v_mfma_f32_16x16x32_bf16 v[36:39], v[116:119], v[120:123], v[36:39]
    ds_read_b64 v[156:157], v2 offset:43072
    ds_read_b64 v[158:159], v2 offset:43080
    s_waitcnt lgkmcnt(10)
    s_waitcnt lgkmcnt(9)
    v_mfma_f32_16x16x32_bf16 v[36:39], v[124:127], v[128:131], v[36:39]
    v_mfma_f32_16x16x32_bf16 v[40:43], v[108:111], v[128:131], v[40:43]
    ds_read_b128 v[160:163], v4 offset:45120
    s_setprio 0
    s_waitcnt lgkmcnt(8)
    s_waitcnt lgkmcnt(7)
    v_mfma_f32_16x16x32_bf16 v[16:19], v[132:135], v[136:139], v[16:19]
    s_waitcnt lgkmcnt(6)
    v_mfma_f32_16x16x32_bf16 v[20:23], v[132:135], v[140:143], v[20:23]
    ds_read_b64 v[164:165], v2 offset:43584
    ds_read_b64 v[166:167], v2 offset:43592
    s_waitcnt lgkmcnt(7)
    v_mfma_f32_16x16x32_bf16 v[24:27], v[132:135], v[144:147], v[24:27]
    s_waitcnt lgkmcnt(6)
    v_mfma_f32_16x16x32_bf16 v[28:31], v[132:135], v[148:151], v[28:31]
    s_waitcnt lgkmcnt(5)
    v_mfma_f32_16x16x32_bf16 v[32:35], v[132:135], v[152:155], v[32:35]
    ds_read_b64 v[168:169], v2 offset:44096
    ds_read_b64 v[170:171], v2 offset:44104
    s_waitcnt lgkmcnt(5)
    v_mfma_f32_16x16x32_bf16 v[16:19], v[156:159], v[140:143], v[16:19]
    v_mfma_f32_16x16x32_bf16 v[20:23], v[156:159], v[144:147], v[20:23]
    s_waitcnt lgkmcnt(4)
    v_mfma_f32_16x16x32_bf16 v[24:27], v[156:159], v[160:163], v[24:27]
    ds_read_b64 v[172:173], v2 offset:44608
    ds_read_b64 v[174:175], v2 offset:44616
    v_mfma_f32_16x16x32_bf16 v[28:31], v[156:159], v[152:155], v[28:31]
    s_waitcnt lgkmcnt(4)
    v_mfma_f32_16x16x32_bf16 v[16:19], v[164:167], v[144:147], v[16:19]
    ds_read_b64 v[176:177], v2 offset:45120
    ds_read_b64 v[178:179], v2 offset:45128
    v_mfma_f32_16x16x32_bf16 v[20:23], v[164:167], v[160:163], v[20:23]
    ds_read_b64 v[180:181], v2 offset:21312
    ds_read_b64 v[182:183], v2 offset:21320
    ds_read_b128 v[184:187], v4 offset:23872
    v_mfma_f32_16x16x32_bf16 v[24:27], v[164:167], v[148:151], v[24:27]
    ds_read_b128 v[188:191], v4 offset:24896
    s_waitcnt lgkmcnt(8)
    v_mfma_f32_16x16x32_bf16 v[16:19], v[168:171], v[160:163], v[16:19]
    ds_read_b64 v[192:193], v2 offset:21824
    ds_read_b64 v[194:195], v2 offset:21832
    ds_read_b128 v[196:199], v4 offset:24384
    v_mfma_f32_16x16x32_bf16 v[20:23], v[168:171], v[148:151], v[20:23]
    ds_read_b64 v[200:201], v2 offset:22336
    ds_read_b64 v[202:203], v2 offset:22344
    v_mfma_f32_16x16x32_bf16 v[24:27], v[168:171], v[152:155], v[24:27]
    s_waitcnt lgkmcnt(11)
    v_mfma_f32_16x16x32_bf16 v[16:19], v[172:175], v[148:151], v[16:19]
    ds_read_b64 v[204:205], v2 offset:42624
    ds_read_b64 v[206:207], v2 offset:42632
    v_mfma_f32_16x16x32_bf16 v[20:23], v[172:175], v[152:155], v[20:23]
    s_waitcnt lgkmcnt(11)
    v_mfma_f32_16x16x32_bf16 v[16:19], v[176:179], v[152:155], v[16:19]
    ds_read_b128 v[208:211], v4 offset:43648
    ds_read_b128 v[212:215], v4 offset:44160
    s_waitcnt lgkmcnt(11)
    s_waitcnt lgkmcnt(10)
    v_mfma_f32_16x16x32_bf16 v[36:39], v[180:183], v[184:187], v[36:39]
    ds_read_b128 v[216:219], v4 offset:44672
    ds_read_b128 v[220:223], v4 offset:45696
    ds_read_b128 v[224:227], v4 offset:46208
    s_waitcnt lgkmcnt(12)
    v_mfma_f32_16x16x32_bf16 v[40:43], v[180:183], v[188:191], v[40:43]
    ds_read_b64 v[228:229], v2 offset:43136
    ds_read_b64 v[230:231], v2 offset:43144
    s_waitcnt lgkmcnt(12)
    s_waitcnt lgkmcnt(11)
    v_mfma_f32_16x16x32_bf16 v[36:39], v[192:195], v[196:199], v[36:39]
    s_waitcnt lgkmcnt(9)
    v_mfma_f32_16x16x32_bf16 v[36:39], v[200:203], v[188:191], v[36:39]
    ds_read_b128 v[232:235], v4 offset:45184
    s_waitcnt lgkmcnt(8)
    s_waitcnt lgkmcnt(7)
    v_mfma_f32_16x16x32_bf16 v[16:19], v[204:207], v[208:211], v[16:19]
    s_waitcnt lgkmcnt(6)
    v_mfma_f32_16x16x32_bf16 v[20:23], v[204:207], v[212:215], v[20:23]
    ds_read_b64 v[236:237], v2 offset:43648
    ds_read_b64 v[238:239], v2 offset:43656
    s_waitcnt lgkmcnt(7)
    v_mfma_f32_16x16x32_bf16 v[24:27], v[204:207], v[216:219], v[24:27]
    s_waitcnt lgkmcnt(6)
    v_mfma_f32_16x16x32_bf16 v[28:31], v[204:207], v[220:223], v[28:31]
    s_waitcnt lgkmcnt(5)
    v_mfma_f32_16x16x32_bf16 v[32:35], v[204:207], v[224:227], v[32:35]
    ds_read_b64 v[240:241], v2 offset:44160
    ds_read_b64 v[242:243], v2 offset:44168
    s_waitcnt lgkmcnt(5)
    v_mfma_f32_16x16x32_bf16 v[16:19], v[228:231], v[212:215], v[16:19]
    v_mfma_f32_16x16x32_bf16 v[20:23], v[228:231], v[216:219], v[20:23]
    s_waitcnt lgkmcnt(4)
    v_mfma_f32_16x16x32_bf16 v[24:27], v[228:231], v[232:235], v[24:27]
    ds_read_b64 v[244:245], v2 offset:44672
    ds_read_b64 v[246:247], v2 offset:44680
    v_mfma_f32_16x16x32_bf16 v[28:31], v[228:231], v[224:227], v[28:31]
    s_waitcnt lgkmcnt(4)
    v_mfma_f32_16x16x32_bf16 v[16:19], v[236:239], v[216:219], v[16:19]
    ds_read_b64 v[64:65], v2 offset:45184
    ds_read_b64 v[66:67], v2 offset:45192
    v_mfma_f32_16x16x32_bf16 v[20:23], v[236:239], v[232:235], v[20:23]
    ds_read_b64 v[100:101], v2 offset:21376
    ds_read_b64 v[102:103], v2 offset:21384
    ds_read_b128 v[72:75], v4 offset:23936
    v_mfma_f32_16x16x32_bf16 v[24:27], v[236:239], v[220:223], v[24:27]
    ds_read_b128 v[92:95], v4 offset:24960
    s_waitcnt lgkmcnt(8)
    v_mfma_f32_16x16x32_bf16 v[16:19], v[240:243], v[232:235], v[16:19]
    ds_read_b64 v[80:81], v2 offset:21888
    ds_read_b64 v[82:83], v2 offset:21896
    ds_read_b128 v[88:91], v4 offset:24448
    v_mfma_f32_16x16x32_bf16 v[20:23], v[240:243], v[220:223], v[20:23]
    ds_read_b64 v[76:77], v2 offset:22400
    ds_read_b64 v[78:79], v2 offset:22408
    v_mfma_f32_16x16x32_bf16 v[24:27], v[240:243], v[224:227], v[24:27]
    s_waitcnt lgkmcnt(11)
    v_mfma_f32_16x16x32_bf16 v[16:19], v[244:247], v[220:223], v[16:19]
    ds_read_b64 v[84:85], v2 offset:42688
    ds_read_b64 v[86:87], v2 offset:42696
    v_mfma_f32_16x16x32_bf16 v[20:23], v[244:247], v[224:227], v[20:23]
    s_waitcnt lgkmcnt(11)
    v_mfma_f32_16x16x32_bf16 v[16:19], v[64:67], v[224:227], v[16:19]
    ds_read_b128 v[96:99], v4 offset:43712
    ds_read_b128 v[68:71], v4 offset:44224
    s_waitcnt lgkmcnt(11)
    s_waitcnt lgkmcnt(10)
    v_mfma_f32_16x16x32_bf16 v[36:39], v[100:103], v[72:75], v[36:39]
    ds_read_b128 v[60:63], v4 offset:44736
    ds_read_b128 v[104:107], v4 offset:45760
    ds_read_b128 v[112:115], v4 offset:46272
    s_waitcnt lgkmcnt(12)
    v_mfma_f32_16x16x32_bf16 v[40:43], v[100:103], v[92:95], v[40:43]
    ds_read_b64 v[116:117], v2 offset:43200
    ds_read_b64 v[118:119], v2 offset:43208
    s_waitcnt lgkmcnt(12)
    s_waitcnt lgkmcnt(11)
    v_mfma_f32_16x16x32_bf16 v[36:39], v[80:83], v[88:91], v[36:39]
    s_waitcnt lgkmcnt(9)
    v_mfma_f32_16x16x32_bf16 v[36:39], v[76:79], v[92:95], v[36:39]
    ds_read_b128 v[120:123], v4 offset:45248
    s_waitcnt lgkmcnt(8)
    s_waitcnt lgkmcnt(7)
    v_mfma_f32_16x16x32_bf16 v[16:19], v[84:87], v[96:99], v[16:19]
    s_waitcnt lgkmcnt(6)
    v_mfma_f32_16x16x32_bf16 v[20:23], v[84:87], v[68:71], v[20:23]
    ds_read_b64 v[124:125], v2 offset:43712
    ds_read_b64 v[126:127], v2 offset:43720
    s_waitcnt lgkmcnt(7)
    v_mfma_f32_16x16x32_bf16 v[24:27], v[84:87], v[60:63], v[24:27]
    s_waitcnt lgkmcnt(6)
    v_mfma_f32_16x16x32_bf16 v[28:31], v[84:87], v[104:107], v[28:31]
    s_waitcnt lgkmcnt(5)
    v_mfma_f32_16x16x32_bf16 v[32:35], v[84:87], v[112:115], v[32:35]
    ds_read_b64 v[108:109], v2 offset:44224
    ds_read_b64 v[110:111], v2 offset:44232
    s_waitcnt lgkmcnt(5)
    v_mfma_f32_16x16x32_bf16 v[16:19], v[116:119], v[68:71], v[16:19]
    v_mfma_f32_16x16x32_bf16 v[20:23], v[116:119], v[60:63], v[20:23]
    s_waitcnt lgkmcnt(4)
    v_mfma_f32_16x16x32_bf16 v[24:27], v[116:119], v[120:123], v[24:27]
    ds_read_b64 v[128:129], v2 offset:44736
    ds_read_b64 v[130:131], v2 offset:44744
    v_mfma_f32_16x16x32_bf16 v[28:31], v[116:119], v[112:115], v[28:31]
    s_waitcnt lgkmcnt(4)
    v_mfma_f32_16x16x32_bf16 v[16:19], v[124:127], v[60:63], v[16:19]
    ds_read_b64 v[136:137], v2 offset:45248
    ds_read_b64 v[138:139], v2 offset:45256
    v_mfma_f32_16x16x32_bf16 v[20:23], v[124:127], v[120:123], v[20:23]
    ds_read_b64 v[132:133], v2 offset:21440
    ds_read_b64 v[134:135], v2 offset:21448
    ds_read_b128 v[140:143], v4 offset:24000
    v_mfma_f32_16x16x32_bf16 v[24:27], v[124:127], v[104:107], v[24:27]
    ds_read_b128 v[156:159], v4 offset:25024
    s_waitcnt lgkmcnt(8)
    v_mfma_f32_16x16x32_bf16 v[16:19], v[108:111], v[120:123], v[16:19]
    ds_read_b64 v[144:145], v2 offset:21952
    ds_read_b64 v[146:147], v2 offset:21960
    ds_read_b128 v[164:167], v4 offset:24512
    v_mfma_f32_16x16x32_bf16 v[20:23], v[108:111], v[104:107], v[20:23]
    ds_read_b64 v[160:161], v2 offset:22464
    ds_read_b64 v[162:163], v2 offset:22472
    v_mfma_f32_16x16x32_bf16 v[24:27], v[108:111], v[112:115], v[24:27]
    s_waitcnt lgkmcnt(11)
    v_mfma_f32_16x16x32_bf16 v[16:19], v[128:131], v[104:107], v[16:19]
    ds_read_b64 v[168:169], v2 offset:42752
    ds_read_b64 v[170:171], v2 offset:42760
    v_mfma_f32_16x16x32_bf16 v[20:23], v[128:131], v[112:115], v[20:23]
    s_waitcnt lgkmcnt(11)
    v_mfma_f32_16x16x32_bf16 v[16:19], v[136:139], v[112:115], v[16:19]
    ds_read_b128 v[148:151], v4 offset:43776
    ds_read_b128 v[172:175], v4 offset:44288
    s_waitcnt lgkmcnt(11)
    s_waitcnt lgkmcnt(10)
    v_mfma_f32_16x16x32_bf16 v[36:39], v[132:135], v[140:143], v[36:39]
    ds_read_b128 v[176:179], v4 offset:44800
    ds_read_b128 v[152:155], v4 offset:45824
    ds_read_b128 v[184:187], v4 offset:46336
    s_waitcnt lgkmcnt(12)
    v_mfma_f32_16x16x32_bf16 v[40:43], v[132:135], v[156:159], v[40:43]
    ds_read_b64 v[180:181], v2 offset:43264
    ds_read_b64 v[182:183], v2 offset:43272
    s_waitcnt lgkmcnt(12)
    s_waitcnt lgkmcnt(11)
    v_mfma_f32_16x16x32_bf16 v[36:39], v[144:147], v[164:167], v[36:39]
    s_waitcnt lgkmcnt(9)
    v_mfma_f32_16x16x32_bf16 v[36:39], v[160:163], v[156:159], v[36:39]
    ds_read_b128 v[192:195], v4 offset:45312
    s_waitcnt lgkmcnt(8)
    s_waitcnt lgkmcnt(7)
    v_mfma_f32_16x16x32_bf16 v[16:19], v[168:171], v[148:151], v[16:19]
    s_waitcnt lgkmcnt(6)
    v_mfma_f32_16x16x32_bf16 v[20:23], v[168:171], v[172:175], v[20:23]
    ds_read_b64 v[196:197], v2 offset:43776
    ds_read_b64 v[198:199], v2 offset:43784
    s_waitcnt lgkmcnt(7)
    v_mfma_f32_16x16x32_bf16 v[24:27], v[168:171], v[176:179], v[24:27]
    s_waitcnt lgkmcnt(6)
    v_mfma_f32_16x16x32_bf16 v[28:31], v[168:171], v[152:155], v[28:31]
    s_waitcnt lgkmcnt(5)
    v_mfma_f32_16x16x32_bf16 v[32:35], v[168:171], v[184:187], v[32:35]
    ds_read_b64 v[200:201], v2 offset:44288
    ds_read_b64 v[202:203], v2 offset:44296
    s_waitcnt lgkmcnt(5)
    v_mfma_f32_16x16x32_bf16 v[16:19], v[180:183], v[172:175], v[16:19]
    v_mfma_f32_16x16x32_bf16 v[20:23], v[180:183], v[176:179], v[20:23]
    s_waitcnt lgkmcnt(4)
    v_mfma_f32_16x16x32_bf16 v[24:27], v[180:183], v[192:195], v[24:27]
    ds_read_b64 v[188:189], v2 offset:44800
    ds_read_b64 v[190:191], v2 offset:44808
    v_mfma_f32_16x16x32_bf16 v[28:31], v[180:183], v[184:187], v[28:31]
    s_waitcnt lgkmcnt(4)
    v_mfma_f32_16x16x32_bf16 v[16:19], v[196:199], v[176:179], v[16:19]
    ds_read_b64 v[208:209], v2 offset:45312
    ds_read_b64 v[210:211], v2 offset:45320
    v_mfma_f32_16x16x32_bf16 v[20:23], v[196:199], v[192:195], v[20:23]
    ds_read_b64 v[204:205], v2 offset:21504
    ds_read_b64 v[206:207], v2 offset:21512
    ds_read_b128 v[212:215], v4 offset:24064
    v_mfma_f32_16x16x32_bf16 v[24:27], v[196:199], v[152:155], v[24:27]
    ds_read_b128 v[228:231], v4 offset:25088
    s_waitcnt lgkmcnt(8)
    v_mfma_f32_16x16x32_bf16 v[16:19], v[200:203], v[192:195], v[16:19]
    ds_read_b64 v[216:217], v2 offset:22016
    ds_read_b64 v[218:219], v2 offset:22024
    ds_read_b128 v[236:239], v4 offset:24576
    v_mfma_f32_16x16x32_bf16 v[20:23], v[200:203], v[152:155], v[20:23]
    ds_read_b64 v[232:233], v2 offset:22528
    ds_read_b64 v[234:235], v2 offset:22536
    v_mfma_f32_16x16x32_bf16 v[24:27], v[200:203], v[184:187], v[24:27]
    s_waitcnt lgkmcnt(11)
    v_mfma_f32_16x16x32_bf16 v[16:19], v[188:191], v[152:155], v[16:19]
    ds_read_b64 v[240:241], v2 offset:42816
    ds_read_b64 v[242:243], v2 offset:42824
    v_mfma_f32_16x16x32_bf16 v[20:23], v[188:191], v[184:187], v[20:23]
    s_waitcnt lgkmcnt(11)
    v_mfma_f32_16x16x32_bf16 v[16:19], v[208:211], v[184:187], v[16:19]
    ds_read_b128 v[220:223], v4 offset:43840
    ds_read_b128 v[244:247], v4 offset:44352
    s_waitcnt lgkmcnt(11)
    s_waitcnt lgkmcnt(10)
    v_mfma_f32_16x16x32_bf16 v[36:39], v[204:207], v[212:215], v[36:39]
    ds_read_b128 v[64:67], v4 offset:44864
    ds_read_b128 v[224:227], v4 offset:45888
    ds_read_b128 v[72:75], v4 offset:46400
    s_waitcnt lgkmcnt(12)
    v_mfma_f32_16x16x32_bf16 v[40:43], v[204:207], v[228:231], v[40:43]
    ds_read_b64 v[100:101], v2 offset:43328
    ds_read_b64 v[102:103], v2 offset:43336
    s_waitcnt lgkmcnt(12)
    s_waitcnt lgkmcnt(11)
    v_mfma_f32_16x16x32_bf16 v[36:39], v[216:219], v[236:239], v[36:39]
    s_waitcnt lgkmcnt(9)
    v_mfma_f32_16x16x32_bf16 v[36:39], v[232:235], v[228:231], v[36:39]
    ds_read_b128 v[80:83], v4 offset:45376
    s_waitcnt lgkmcnt(8)
    s_waitcnt lgkmcnt(7)
    v_mfma_f32_16x16x32_bf16 v[16:19], v[240:243], v[220:223], v[16:19]
    s_waitcnt lgkmcnt(6)
    v_mfma_f32_16x16x32_bf16 v[20:23], v[240:243], v[244:247], v[20:23]
    ds_read_b64 v[88:89], v2 offset:43840
    ds_read_b64 v[90:91], v2 offset:43848
    s_waitcnt lgkmcnt(7)
    v_mfma_f32_16x16x32_bf16 v[24:27], v[240:243], v[64:67], v[24:27]
    s_waitcnt lgkmcnt(6)
    v_mfma_f32_16x16x32_bf16 v[28:31], v[240:243], v[224:227], v[28:31]
    s_waitcnt lgkmcnt(5)
    v_mfma_f32_16x16x32_bf16 v[32:35], v[240:243], v[72:75], v[32:35]
    ds_read_b64 v[76:77], v2 offset:44352
    ds_read_b64 v[78:79], v2 offset:44360
    s_waitcnt lgkmcnt(5)
    v_mfma_f32_16x16x32_bf16 v[16:19], v[100:103], v[244:247], v[16:19]
    v_mfma_f32_16x16x32_bf16 v[20:23], v[100:103], v[64:67], v[20:23]
    s_waitcnt lgkmcnt(4)
    v_mfma_f32_16x16x32_bf16 v[24:27], v[100:103], v[80:83], v[24:27]
    ds_read_b64 v[92:93], v2 offset:44864
    ds_read_b64 v[94:95], v2 offset:44872
    v_mfma_f32_16x16x32_bf16 v[28:31], v[100:103], v[72:75], v[28:31]
    s_waitcnt lgkmcnt(4)
    v_mfma_f32_16x16x32_bf16 v[16:19], v[88:91], v[64:67], v[16:19]
    ds_read_b64 v[96:97], v2 offset:45376
    ds_read_b64 v[98:99], v2 offset:45384
    v_mfma_f32_16x16x32_bf16 v[20:23], v[88:91], v[80:83], v[20:23]
    ds_read_b64 v[84:85], v2 offset:21568
    ds_read_b64 v[86:87], v2 offset:21576
    ds_read_b128 v[68:71], v4 offset:24128
    v_mfma_f32_16x16x32_bf16 v[24:27], v[88:91], v[224:227], v[24:27]
    ds_read_b128 v[116:119], v4 offset:25152
    s_waitcnt lgkmcnt(8)
    v_mfma_f32_16x16x32_bf16 v[16:19], v[76:79], v[80:83], v[16:19]
    ds_read_b64 v[60:61], v2 offset:22080
    ds_read_b64 v[62:63], v2 offset:22088
    ds_read_b128 v[124:127], v4 offset:24640
    v_mfma_f32_16x16x32_bf16 v[20:23], v[76:79], v[224:227], v[20:23]
    ds_read_b64 v[120:121], v2 offset:22592
    ds_read_b64 v[122:123], v2 offset:22600
    v_mfma_f32_16x16x32_bf16 v[24:27], v[76:79], v[72:75], v[24:27]
    s_waitcnt lgkmcnt(11)
    v_mfma_f32_16x16x32_bf16 v[16:19], v[92:95], v[224:227], v[16:19]
    ds_read_b64 v[108:109], v2 offset:42880
    ds_read_b64 v[110:111], v2 offset:42888
    v_mfma_f32_16x16x32_bf16 v[20:23], v[92:95], v[72:75], v[20:23]
    s_waitcnt lgkmcnt(11)
    v_mfma_f32_16x16x32_bf16 v[16:19], v[96:99], v[72:75], v[16:19]
    ds_read_b128 v[104:107], v4 offset:43904
    ds_read_b128 v[128:131], v4 offset:44416
    s_waitcnt lgkmcnt(11)
    s_waitcnt lgkmcnt(10)
    v_mfma_f32_16x16x32_bf16 v[36:39], v[84:87], v[68:71], v[36:39]
    ds_read_b128 v[136:139], v4 offset:44928
    ds_read_b128 v[112:115], v4 offset:45952
    ds_read_b128 v[140:143], v4 offset:46464
    s_waitcnt lgkmcnt(12)
    v_mfma_f32_16x16x32_bf16 v[40:43], v[84:87], v[116:119], v[40:43]
    ds_read_b64 v[132:133], v2 offset:43392
    ds_read_b64 v[134:135], v2 offset:43400
    s_waitcnt lgkmcnt(12)
    s_waitcnt lgkmcnt(11)
    v_mfma_f32_16x16x32_bf16 v[36:39], v[60:63], v[124:127], v[36:39]
    s_waitcnt lgkmcnt(9)
    v_mfma_f32_16x16x32_bf16 v[36:39], v[120:123], v[116:119], v[36:39]
    ds_read_b128 v[144:147], v4 offset:45440
    s_waitcnt lgkmcnt(8)
    s_waitcnt lgkmcnt(7)
    v_mfma_f32_16x16x32_bf16 v[16:19], v[108:111], v[104:107], v[16:19]
    s_waitcnt lgkmcnt(6)
    v_mfma_f32_16x16x32_bf16 v[20:23], v[108:111], v[128:131], v[20:23]
    ds_read_b64 v[164:165], v2 offset:43904
    ds_read_b64 v[166:167], v2 offset:43912
    s_waitcnt lgkmcnt(7)
    v_mfma_f32_16x16x32_bf16 v[24:27], v[108:111], v[136:139], v[24:27]
    s_waitcnt lgkmcnt(6)
    v_mfma_f32_16x16x32_bf16 v[28:31], v[108:111], v[112:115], v[28:31]
    s_waitcnt lgkmcnt(5)
    v_mfma_f32_16x16x32_bf16 v[32:35], v[108:111], v[140:143], v[32:35]
    ds_read_b64 v[160:161], v2 offset:44416
    ds_read_b64 v[162:163], v2 offset:44424
    s_waitcnt lgkmcnt(5)
    v_mfma_f32_16x16x32_bf16 v[16:19], v[132:135], v[128:131], v[16:19]
    v_mfma_f32_16x16x32_bf16 v[20:23], v[132:135], v[136:139], v[20:23]
    s_waitcnt lgkmcnt(4)
    v_mfma_f32_16x16x32_bf16 v[24:27], v[132:135], v[144:147], v[24:27]
    ds_read_b64 v[156:157], v2 offset:44928
    ds_read_b64 v[158:159], v2 offset:44936
    v_mfma_f32_16x16x32_bf16 v[28:31], v[132:135], v[140:143], v[28:31]
    s_waitcnt lgkmcnt(4)
    v_mfma_f32_16x16x32_bf16 v[16:19], v[164:167], v[136:139], v[16:19]
    ds_read_b64 v[148:149], v2 offset:45440
    ds_read_b64 v[150:151], v2 offset:45448
    v_mfma_f32_16x16x32_bf16 v[20:23], v[164:167], v[144:147], v[20:23]
    ds_read_b64 v[168:169], v2 offset:21632
    ds_read_b64 v[170:171], v2 offset:21640
    ds_read_b128 v[172:175], v4 offset:24192
    v_mfma_f32_16x16x32_bf16 v[24:27], v[164:167], v[112:115], v[24:27]
    ds_read_b128 v[180:183], v4 offset:25216
    s_waitcnt lgkmcnt(8)
    v_mfma_f32_16x16x32_bf16 v[16:19], v[160:163], v[144:147], v[16:19]
    ds_read_b64 v[176:177], v2 offset:22144
    ds_read_b64 v[178:179], v2 offset:22152
    ds_read_b128 v[196:199], v4 offset:24704
    v_mfma_f32_16x16x32_bf16 v[20:23], v[160:163], v[112:115], v[20:23]
    ds_read_b64 v[192:193], v2 offset:22656
    ds_read_b64 v[194:195], v2 offset:22664
    v_mfma_f32_16x16x32_bf16 v[24:27], v[160:163], v[140:143], v[24:27]
    s_waitcnt lgkmcnt(11)
    v_mfma_f32_16x16x32_bf16 v[16:19], v[156:159], v[112:115], v[16:19]
    ds_read_b64 v[200:201], v2 offset:42944
    ds_read_b64 v[202:203], v2 offset:42952
    v_mfma_f32_16x16x32_bf16 v[20:23], v[156:159], v[140:143], v[20:23]
    s_waitcnt lgkmcnt(11)
    v_mfma_f32_16x16x32_bf16 v[16:19], v[148:151], v[140:143], v[16:19]
    ds_read_b128 v[152:155], v4 offset:43968
    ds_read_b128 v[188:191], v4 offset:44480
    s_waitcnt lgkmcnt(11)
    s_waitcnt lgkmcnt(10)
    v_mfma_f32_16x16x32_bf16 v[36:39], v[168:171], v[172:175], v[36:39]
    ds_read_b128 v[208:211], v4 offset:44992
    ds_read_b128 v[184:187], v4 offset:46016
    ds_read_b128 v[212:215], v4 offset:46528
    s_waitcnt lgkmcnt(12)
    v_mfma_f32_16x16x32_bf16 v[40:43], v[168:171], v[180:183], v[40:43]
    ds_read_b64 v[204:205], v2 offset:43456
    ds_read_b64 v[206:207], v2 offset:43464
    s_waitcnt lgkmcnt(12)
    s_waitcnt lgkmcnt(11)
    v_mfma_f32_16x16x32_bf16 v[36:39], v[176:179], v[196:199], v[36:39]
    s_waitcnt lgkmcnt(9)
    v_mfma_f32_16x16x32_bf16 v[36:39], v[192:195], v[180:183], v[36:39]
    ds_read_b128 v[216:219], v4 offset:45504
    s_setprio 1
    s_waitcnt lgkmcnt(8)
    s_waitcnt lgkmcnt(7)
    v_mfma_f32_16x16x32_bf16 v[16:19], v[200:203], v[152:155], v[16:19]
    s_waitcnt lgkmcnt(6)
    v_mfma_f32_16x16x32_bf16 v[20:23], v[200:203], v[188:191], v[20:23]
    ds_read_b64 v[236:237], v2 offset:43968
    ds_read_b64 v[238:239], v2 offset:43976
    s_waitcnt lgkmcnt(7)
    v_mfma_f32_16x16x32_bf16 v[24:27], v[200:203], v[208:211], v[24:27]
    s_waitcnt lgkmcnt(6)
    v_mfma_f32_16x16x32_bf16 v[28:31], v[200:203], v[184:187], v[28:31]
    s_waitcnt lgkmcnt(5)
    v_mfma_f32_16x16x32_bf16 v[32:35], v[200:203], v[212:215], v[32:35]
    ds_read_b64 v[232:233], v2 offset:44480
    ds_read_b64 v[234:235], v2 offset:44488
    s_waitcnt lgkmcnt(5)
    v_mfma_f32_16x16x32_bf16 v[16:19], v[204:207], v[188:191], v[16:19]
    v_mfma_f32_16x16x32_bf16 v[20:23], v[204:207], v[208:211], v[20:23]
    s_nop 2
    v_cvt_pk_bf16_f32 v52, v32, v33
    v_cvt_pk_bf16_f32 v53, v34, v35
    v_pk_min_u16 v52, v52, s66
    v_pk_min_u16 v53, v53, s66
    buffer_store_dwordx2 v[52:53], v7, s[44:47], s65 offen offset:0 sc1
    s_waitcnt lgkmcnt(4)
    v_mfma_f32_16x16x32_bf16 v[24:27], v[204:207], v[216:219], v[24:27]
    ds_read_b64 v[228:229], v2 offset:44992
    ds_read_b64 v[230:231], v2 offset:45000
    v_mfma_f32_16x16x32_bf16 v[28:31], v[204:207], v[212:215], v[28:31]
    s_waitcnt lgkmcnt(4)
    v_mfma_f32_16x16x32_bf16 v[16:19], v[236:239], v[208:211], v[16:19]
    ds_read_b64 v[220:221], v2 offset:45504
    ds_read_b64 v[222:223], v2 offset:45512
    v_mfma_f32_16x16x32_bf16 v[20:23], v[236:239], v[216:219], v[20:23]
    ds_read_b64 v[240:241], v2 offset:21696
    ds_read_b64 v[242:243], v2 offset:21704
    ds_read_b128 v[244:247], v4 offset:24256
    v_cvt_pk_bf16_f32 v50, v28, v29
    v_cvt_pk_bf16_f32 v51, v30, v31
    v_pk_min_u16 v50, v50, s66
    v_pk_min_u16 v51, v51, s66
    buffer_store_dwordx2 v[50:51], v7, s[44:47], s65 offen offset:512 sc1
    v_mfma_f32_16x16x32_bf16 v[24:27], v[236:239], v[184:187], v[24:27]
    ds_read_b128 v[100:103], v4 offset:25280
    s_waitcnt lgkmcnt(8)
    v_mfma_f32_16x16x32_bf16 v[16:19], v[232:235], v[216:219], v[16:19]
    ds_read_b64 v[64:65], v2 offset:22208
    ds_read_b64 v[66:67], v2 offset:22216
    ds_read_b128 v[88:91], v4 offset:24768
    v_mfma_f32_16x16x32_bf16 v[20:23], v[232:235], v[184:187], v[20:23]
    ds_read_b64 v[80:81], v2 offset:22720
    ds_read_b64 v[82:83], v2 offset:22728
    v_mfma_f32_16x16x32_bf16 v[24:27], v[232:235], v[212:215], v[24:27]
    s_waitcnt lgkmcnt(11)
    v_mfma_f32_16x16x32_bf16 v[16:19], v[228:231], v[184:187], v[16:19]
    v_mfma_f32_16x16x32_bf16 v[20:23], v[228:231], v[212:215], v[20:23]
    s_nop 4
    v_cvt_pk_bf16_f32 v48, v24, v25
    v_cvt_pk_bf16_f32 v49, v26, v27
    v_pk_min_u16 v48, v48, s66
    v_pk_min_u16 v49, v49, s66
    buffer_store_dwordx2 v[48:49], v7, s[44:47], s65 offen offset:1536 sc1
    s_waitcnt lgkmcnt(9)
    v_mfma_f32_16x16x32_bf16 v[16:19], v[220:223], v[212:215], v[16:19]
    s_waitcnt lgkmcnt(7)
    s_waitcnt lgkmcnt(6)
    v_mfma_f32_16x16x32_bf16 v[36:39], v[240:243], v[244:247], v[36:39]
    v_cvt_pk_bf16_f32 v46, v20, v21
    v_cvt_pk_bf16_f32 v47, v22, v23
    v_pk_min_u16 v46, v46, s66
    v_pk_min_u16 v47, v47, s66
    buffer_store_dwordx2 v[46:47], v7, s[44:47], s65 offen offset:2048 sc1
    s_waitcnt lgkmcnt(5)
    v_mfma_f32_16x16x32_bf16 v[40:43], v[240:243], v[100:103], v[40:43]
    v_cvt_pk_bf16_f32 v44, v16, v17
    v_cvt_pk_bf16_f32 v45, v18, v19
    v_pk_min_u16 v44, v44, s66
    v_pk_min_u16 v45, v45, s66
    buffer_store_dwordx2 v[44:45], v7, s[44:47], s65 offen offset:2560 sc1
    s_waitcnt lgkmcnt(3)
    s_waitcnt lgkmcnt(2)
    v_mfma_f32_16x16x32_bf16 v[36:39], v[64:67], v[88:91], v[36:39]
    s_waitcnt lgkmcnt(0)
    v_mfma_f32_16x16x32_bf16 v[36:39], v[80:83], v[100:103], v[36:39]
    v_cvt_pk_bf16_f32 v56, v40, v41
    v_cvt_pk_bf16_f32 v57, v42, v43
    v_pk_min_u16 v56, v56, s66
    v_pk_min_u16 v57, v57, s66
    buffer_store_dwordx2 v[56:57], v7, s[44:47], s57 offen offset:0 sc1
    s_nop 2
    v_cvt_pk_bf16_f32 v54, v36, v37
    v_cvt_pk_bf16_f32 v55, v38, v39
    v_pk_min_u16 v54, v54, s66
    v_pk_min_u16 v55, v55, s66
    buffer_store_dwordx2 v[54:55], v7, s[44:47], s57 offen offset:1024 sc1
    s_nop 0
K2_CP:
    s_sub_u32 s8, s3, 4
    s_mul_i32 s14, s8, 40
    s_and_b32 s58, s14, 0xfffffff0
    s_sub_u32 s67, s14, s58
    s_mul_i32 s14, s7, 160
    s_add_u32 s58, s58, s14
    s_mul_i32 s14, s6, 81920
    s_add_u32 s58, s58, s14
    s_mul_i32 s68, s8, 3072
    s_add_u32 s68, s68, 63744
    s_mov_b32 s59, s68
    v_add_u32 v8, 0, v0
    v_mul_u32_u24 v9, 0x5556, v8
    v_lshrrev_b32 v9, 16, v9
    v_mul_u32_u24 v10, 3, v9
    v_sub_u32 v10, v8, v10
    v_mul_u32_u24 v9, 0x500, v9
    v_lshl_add_u32 v104, v10, 4, v9
    v_add_u32 v8, 64, v0
    v_mul_u32_u24 v9, 0x5556, v8
    v_lshrrev_b32 v9, 16, v9
    v_mul_u32_u24 v10, 3, v9
    v_sub_u32 v10, v8, v10
    v_mul_u32_u24 v9, 0x500, v9
    v_lshl_add_u32 v105, v10, 4, v9
    v_add_u32 v8, 128, v0
    v_mul_u32_u24 v9, 0x5556, v8
    v_lshrrev_b32 v9, 16, v9
    v_mul_u32_u24 v10, 3, v9
    v_sub_u32 v10, v8, v10
    v_mul_u32_u24 v9, 0x500, v9
    v_lshl_add_u32 v106, v10, 4, v9
    s_lshl_b32 s75, s6, 9
    s_add_u32 s75, s75, 0xf00000
    v_lshlrev_b32 v107, 3, v0
    v_lshrrev_b32 v8, 3, v0
    v_lshlrev_b32 v8, 12, v8
    v_and_b32 v9, 7, v0
    v_lshl_add_u32 v8, v9, 4, v8
    s_mul_i32 s14, s7, 80
    s_mul_i32 s15, s8, 20
    s_add_u32 s14, s14, s15
    s_lshl_b32 s14, s14, 12
    s_lshl_b32 s15, s6, 7
    s_add_u32 s14, s14, s15
    s_add_u32 s72, s14, 0xc00000
    s_add_u32 s73, s72, 0x8000
    s_add_u32 s74, s72, 0x10000
    s_mul_i32 s69, s8, 5120
    s_add_u32 s69, s69, 137472
    v_bfe_u32 v9, v0, 2, 2
    v_lshlrev_b32 v9, 7, v9
    v_lshrrev_b32 v10, 4, v0
    v_lshl_add_u32 v9, v10, 5, v9
    v_and_b32 v10, 3, v0
    v_lshl_add_u32 v9, v10, 3, v9
    v_add_u32 v9, s69, v9
    v_add_u32 v12, s69, v13
    v_mul_u32_u24 v10, 48, v0
    s_add_u32 s68, s68, s67
    v_add_u32 v10, s68, v10
    s_setprio 0
    s_mov_b32 s70, 0x100000
K2_GS:
    ds_read_b32 v248, v249 offset:4
    s_waitcnt lgkmcnt(0)
    v_readfirstlane_b32 s71, v248
    s_cmp_eq_u32 s71, 1
    s_cbranch_scc1 K2_GS_OK
    s_nop 15
    s_sub_u32 s70, s70, 1
    s_cbranch_scc0 K2_GS
K2_GS_OK:
    s_setprio 1
    s_add_u32 m0, s59, 0
    s_nop 0
    buffer_load_dwordx4 v104, s[48:51], s58 offen lds
    s_add_u32 m0, s59, 1024
    s_nop 0
    buffer_load_dwordx4 v105, s[48:51], s58 offen lds
    s_add_u32 m0, s59, 2048
    s_nop 0
    buffer_load_dwordx4 v106, s[48:51], s58 offen lds
    buffer_load_dwordx2 v[250:251], v107, s[44:47], s75 offen
    s_add_u32 m0, s69, 0
    s_nop 0
    buffer_load_dwordx4 v8, s[44:47], s72 offen sc1 lds
    s_add_u32 m0, s69, 1024
    s_nop 0
    buffer_load_dwordx4 v8, s[44:47], s73 offen sc1 lds
    s_add_u32 m0, s69, 2048
    s_mov_b32 exec_hi, 0
    buffer_load_dwordx4 v8, s[44:47], s74 offen sc1 lds
    s_mov_b32 exec_hi, -1
    s_waitcnt vmcnt(3)
    ds_read_b64 v[16:17], v10 offset:0
    ds_read_b64 v[18:19], v10 offset:8
    ds_read_b64 v[20:21], v10 offset:16
    ds_read_b64 v[22:23], v10 offset:24
    ds_read_b64 v[24:25], v10 offset:32
    v_rcp_f32 v251, v251
    s_waitcnt lgkmcnt(0)
    v_lshlrev_b32 v32, 16, v16
    v_and_b32 v33, 0xffff0000, v16
    v_lshlrev_b32 v34, 16, v17
    v_and_b32 v35, 0xffff0000, v17
    v_lshlrev_b32 v36, 16, v18
    v_and_b32 v37, 0xffff0000, v18
    v_lshlrev_b32 v38, 16, v19
    v_and_b32 v39, 0xffff0000, v19
    v_lshlrev_b32 v40, 16, v20
    v_and_b32 v41, 0xffff0000, v20
    v_lshlrev_b32 v42, 16, v21
    v_and_b32 v43, 0xffff0000, v21
    v_lshlrev_b32 v44, 16, v22
    v_and_b32 v45, 0xffff0000, v22
    v_lshlrev_b32 v46, 16, v23
    v_and_b32 v47, 0xffff0000, v23
    v_lshlrev_b32 v48, 16, v24
    v_and_b32 v49, 0xffff0000, v24
    v_lshlrev_b32 v50, 16, v25
    v_and_b32 v51, 0xffff0000, v25
    v_sub_f32 v56, v32, v250
    v_sub_f32 v57, v33, v250
    v_sub_f32 v58, v34, v250
    v_sub_f32 v59, v35, v250
    v_sub_f32 v60, v36, v250
    v_sub_f32 v61, v37, v250
    v_sub_f32 v62, v38, v250
    v_sub_f32 v63, v39, v250
    v_sub_f32 v64, v40, v250
    v_sub_f32 v65, v41, v250
    v_sub_f32 v66, v42, v250
    v_sub_f32 v67, v43, v250
    v_sub_f32 v68, v44, v250
    v_sub_f32 v69, v45, v250
    v_sub_f32 v70, v46, v250
    v_sub_f32 v71, v47, v250
    v_sub_f32 v72, v48, v250
    v_sub_f32 v73, v49, v250
    v_sub_f32 v74, v50, v250
    v_sub_f32 v75, v51, v250
    v_mul_f32 v56, v56, v251
    v_mul_f32 v57, v57, v251
    v_mul_f32 v58, v58, v251
    v_mul_f32 v59, v59, v251
    v_mul_f32 v60, v60, v251
    v_mul_f32 v61, v61, v251
    v_mul_f32 v62, v62, v251
    v_mul_f32 v63, v63, v251
    v_mul_f32 v64, v64, v251
    v_mul_f32 v65, v65, v251
    v_mul_f32 v66, v66, v251
    v_mul_f32 v67, v67, v251
    v_mul_f32 v68, v68, v251
    v_mul_f32 v69, v69, v251
    v_mul_f32 v70, v70, v251
    v_mul_f32 v71, v71, v251
    v_mul_f32 v72, v72, v251
    v_mul_f32 v73, v73, v251
    v_mul_f32 v74, v74, v251
    v_mul_f32 v75, v75, v251
    s_mov_b32 s70, 0x40000
K2_POLL:
    s_waitcnt vmcnt(0)
    ds_read_b64_tr_b16 v[80:81], v9 offset:0
    ds_read_b64_tr_b16 v[82:83], v9 offset:512
    ds_read_b64_tr_b16 v[84:85], v9 offset:1024
    ds_read_b64_tr_b16 v[86:87], v9 offset:1536
    ds_read_b64_tr_b16 v[88:89], v9 offset:2048
    s_waitcnt lgkmcnt(0)
    v_pk_max_u16 v14, v80, v81
    v_pk_max_u16 v15, v82, v83
    v_pk_max_u16 v14, v14, v84
    v_pk_max_u16 v15, v15, v85
    v_pk_max_u16 v14, v14, v86
    v_pk_max_u16 v15, v15, v87
    v_pk_max_u16 v14, v14, v88
    v_pk_max_u16 v15, v15, v89
    v_pk_max_u16 v14, v14, v15
    v_lshlrev_b32 v15, 16, v14
    v_max_u32 v14, v14, v15
    v_cmp_le_u32 vcc, 0xffff0000, v14
    s_nop 1
    s_cbranch_vccz K2_POLL_OK
    s_sub_u32 s70, s70, 1
    s_cbranch_scc1 K2_POLL_OK
    s_add_u32 m0, s69, 0
    s_nop 0
    buffer_load_dwordx4 v8, s[44:47], s72 offen sc1 lds
    s_add_u32 m0, s69, 1024
    s_nop 0
    buffer_load_dwordx4 v8, s[44:47], s73 offen sc1 lds
    s_add_u32 m0, s69, 2048
    s_mov_b32 exec_hi, 0
    buffer_load_dwordx4 v8, s[44:47], s74 offen sc1 lds
    s_mov_b32 exec_hi, -1
    s_branch K2_POLL
K2_POLL_OK:
    v_lshlrev_b32 v96, 16, v80
    v_and_b32 v97, 0xffff0000, v80
    v_lshlrev_b32 v98, 16, v81
    v_and_b32 v99, 0xffff0000, v81
    v_fma_f32 v96, v96, v56, v32
    v_fma_f32 v97, v97, v57, v33
    v_fma_f32 v98, v98, v58, v34
    v_fma_f32 v99, v99, v59, v35
    ds_write_b128 v12, v[96:99] offset:0
    v_lshlrev_b32 v100, 16, v82
    v_and_b32 v101, 0xffff0000, v82
    v_lshlrev_b32 v102, 16, v83
    v_and_b32 v103, 0xffff0000, v83
    v_fma_f32 v100, v100, v60, v36
    v_fma_f32 v101, v101, v61, v37
    v_fma_f32 v102, v102, v62, v38
    v_fma_f32 v103, v103, v63, v39
    ds_write_b128 v12, v[100:103] offset:1024
    v_lshlrev_b32 v104, 16, v84
    v_and_b32 v105, 0xffff0000, v84
    v_lshlrev_b32 v106, 16, v85
    v_and_b32 v107, 0xffff0000, v85
    v_fma_f32 v104, v104, v64, v40
    v_fma_f32 v105, v105, v65, v41
    v_fma_f32 v106, v106, v66, v42
    v_fma_f32 v107, v107, v67, v43
    ds_write_b128 v12, v[104:107] offset:2048
    v_lshlrev_b32 v108, 16, v86
    v_and_b32 v109, 0xffff0000, v86
    v_lshlrev_b32 v110, 16, v87
    v_and_b32 v111, 0xffff0000, v87
    v_fma_f32 v108, v108, v68, v44
    v_fma_f32 v109, v109, v69, v45
    v_fma_f32 v110, v110, v70, v46
    v_fma_f32 v111, v111, v71, v47
    ds_write_b128 v12, v[108:111] offset:3072
    v_lshlrev_b32 v112, 16, v88
    v_and_b32 v113, 0xffff0000, v88
    v_lshlrev_b32 v114, 16, v89
    v_and_b32 v115, 0xffff0000, v89
    v_fma_f32 v112, v112, v72, v48
    v_fma_f32 v113, v113, v73, v49
    v_fma_f32 v114, v114, v74, v50
    v_fma_f32 v115, v115, v75, v51
    ds_write_b128 v12, v[112:115] offset:4096
    s_waitcnt lgkmcnt(0)
    s_barrier
K2_END:
    s_endpgm

.section .rodata,"a"
.p2align 6
.amdhsa_kernel k1_kernel
  .amdhsa_next_free_vgpr 256
  .amdhsa_next_free_sgpr 102
  .amdhsa_accum_offset 256
  .amdhsa_group_segment_fixed_size 0
  .amdhsa_kernarg_size 104
  .amdhsa_user_sgpr_count 2
  .amdhsa_user_sgpr_kernarg_segment_ptr 1
  .amdhsa_system_sgpr_workgroup_id_x 1
.end_amdhsa_kernel

.p2align 6
.amdhsa_kernel k2_kernel
  .amdhsa_next_free_vgpr 256
  .amdhsa_next_free_sgpr 102
  .amdhsa_accum_offset 256
  .amdhsa_group_segment_fixed_size 0
  .amdhsa_kernarg_size 104
  .amdhsa_user_sgpr_count 2
  .amdhsa_user_sgpr_kernarg_segment_ptr 1
  .amdhsa_system_sgpr_workgroup_id_x 1
.end_amdhsa_kernel
```
